```python
import torch

def _softmax(x, axis=-1):
    return torch.softmax(x, dim=axis)

def _gelu(x):
    return torch.nn.functional.gelu(x, approximate='tanh')

def _silu(x):
    return torch.nn.functional.silu(x)

def _sigmoid(x):
    return torch.sigmoid(x)

def _layernorm(x, axis=-1, eps=1e-05):
    m = x.mean(dim=axis, keepdim=True)
    v = x.var(dim=axis, keepdim=True, unbiased=False)
    return (x - m) / torch.sqrt(v + eps)

def _scatter_add(tgt, idx, src, axis=0):
    return tgt.clone().index_add_(axis, idx, src)

def _segment_sum(src, seg, n):
    out = torch.zeros((n,) + src.shape[1:], dtype=src.dtype)
    return out.index_add_(0, seg, src)

def _pad(x, pw):
    flat = tuple((v for pair in reversed(pw) for v in pair))
    return torch.nn.functional.pad(x, flat)
kernel_name = 'adaLN_cond__gqa_block_cached__moe_arch_mod__prompt'

def setup_inputs():

    _w = lambda a: (lambda t: t.to(torch.bfloat16) if t.is_floating_point() else t)(torch.as_tensor(a))

    def _A_setup():
        B, Sq, D = (1, 2048, 448)
        Hq, Hkv, Sk, Dh = (16, 8, 2048, 256)
        assert Hq % Hkv == 0, (Hq, Hkv)
        return {'x': _w((lambda *s: torch.randn(*s, dtype=torch.bfloat16) * 0.05)(B, Sq, D)), 'k_cache': _w((lambda *s: torch.randn(*s, dtype=torch.bfloat16) * 3.2)(B, Hkv, Sk, Dh)), 'v_cache': _w((lambda *s: torch.randn(*s, dtype=torch.bfloat16) * 0.4)(B, Hkv, Sk, Dh)), 'wq': _w((lambda *s: torch.randn(*s, dtype=torch.bfloat16) * 3.2)(D, Hq * Dh) * D ** (-0.5)), 'wo': _w((lambda *s: torch.randn(*s, dtype=torch.bfloat16) * 0.4)(Hq * Dh, D) * (Hq * Dh) ** (-0.5))}
    _A_in = _A_setup()

    def _B_setup():
        B, S, D, F, C = (1, 2048, 448, 1792, 1)
        return {'x': _w((lambda *s: torch.randn(*s, dtype=torch.bfloat16) * 0.05)(B, S, D)), 'w_r': _w((lambda *s: torch.randn(*s, dtype=torch.bfloat16) * 3.2)(D)), 'w_gate': _w((lambda *s: torch.randn(*s, dtype=torch.bfloat16) * 0.1)(D, F)), 'w_up': _w((lambda *s: torch.randn(*s, dtype=torch.bfloat16) * 0.1)(D, F)), 'w_down': _w((lambda *s: torch.randn(*s, dtype=torch.bfloat16) * 0.1)(F, D))}
    _B_in = _B_setup()
    return {'A_x': _A_in['x'], 'A_k_cache': _A_in['k_cache'], 'A_v_cache': _A_in['v_cache'], 'A_wq': _A_in['wq'], 'A_wo': _A_in['wo'], 'B_x': _B_in['x'], 'B_w_r': _B_in['w_r'], 'B_w_gate': _B_in['w_gate'], 'B_w_up': _B_in['w_up'], 'B_w_down': _B_in['w_down'], 'c': _w((lambda *s: torch.randn(*s, dtype=torch.bfloat16) * 0.1)(1, 448) * 8.0), 'w_mod': _w((lambda *s: torch.randn(*s, dtype=torch.bfloat16) * 0.1)(448, 6 * 448) * 448 ** (-0.5) * 8.0)}

def reference(A_x, A_k_cache, A_v_cache, A_wq, A_wo, B_x, B_w_r, B_w_gate, B_w_up, B_w_down, c, w_mod):

    def _A_ref(x, k_cache, v_cache, wq, wo):
        B, Sq, D = x.shape
        Hq, Dh = (16, 256)
        Hkv = k_cache.shape[1]
        rep = Hq // Hkv
        q = (lambda x, *d: x.permute(*d))((x @ wq).reshape(B, Sq, Hq, Dh), 0, 2, 1, 3)
        k = (lambda x, n, axis: torch.repeat_interleave(x, n, dim=axis))(k_cache, rep, axis=1)
        v = (lambda x, n, axis: torch.repeat_interleave(x, n, dim=axis))(v_cache, rep, axis=1)
        scores = torch.einsum('bhqd,bhkd->bhqk', q, k) * Dh ** (-0.5)
        p = _softmax(scores, axis=-1)
        o = torch.einsum('bhqk,bhkd->bhqd', p, v)
        return (lambda x, *d: x.permute(*d))(o, 0, 2, 1, 3).reshape(B, Sq, Hq * Dh) @ wo

    def _B_ref(x, w_r, w_gate, w_up, w_down):
        B, S, D = x.shape
        C = 1
        r = x @ w_r
        idx = torch.argsort(-r, axis=-1)[:, :C]
        idx_e = (lambda x, n, axis: torch.repeat_interleave(x, n, dim=axis))(idx.reshape(B, C, 1), D, axis=2)
        x_sel = (lambda x, i, axis: torch.take_along_dim(x, i, dim=axis))(x, idx_e, axis=1)
        g = _silu(x_sel @ w_gate)
        u = x_sel @ w_up
        y = g * u @ w_down
        r_sel = _sigmoid((lambda x, i, axis: torch.take_along_dim(x, i, dim=axis))(r, idx, axis=1))
        y = y * r_sel.reshape(B, C, 1)
        b_off = (torch.arange(B) * S).reshape(B, 1)
        flat_idx = (idx + b_off).reshape(B * C)
        zero = (x * 0.0).reshape(B * S, D)
        upd = _scatter_add(zero, flat_idx, y.reshape(B * C, D), axis=0)
        return x + upd.reshape(B, S, D)
    x = A_x
    mod = (_silu(c) @ w_mod).reshape(c.shape[0], 6, 1, -1)
    sa, ca, ga, sb, cb, gb = (mod[:, 0].clone(), mod[:, 1].clone(), mod[:, 2].clone(), mod[:, 3].clone(), mod[:, 4].clone(), mod[:, 5].clone())
    h = _layernorm(x, axis=-1) * (1 + ca) + sa
    x = x + ga * _A_ref(h, A_k_cache, A_v_cache, A_wq, A_wo)
    h = _layernorm(x, axis=-1) * (1 + cb) + sb
    x = x + gb * _B_ref(h, B_w_r, B_w_gate, B_w_up, B_w_down)
    return x
```

```asm
; @launch kernel=k1_kernel grid=(1076,1,1) block=(256,1,1) lds=16640
; @launch kernel=k3_kernel grid=(256,1,1) block=(256,1,1) lds=163840
; @launch kernel=k5_kernel grid=(512,1,1) block=(256,1,1) lds=64
; @launch kernel=k6_kernel grid=(56,1,1) block=(256,1,1) lds=16384
.amdgcn_target "amdgcn-amd-amdhsa--gfx950"
.text
    .globl k1_kernel
    .p2align 8
    .type k1_kernel,@function
k1_kernel:
    s_cmp_ge_u32 s2, 564
    s_cbranch_scc1 K1_LN
    s_load_dwordx4 s[4:7], s[0:1], 24
    s_load_dwordx4 s[8:11], s[0:1], 80
    s_load_dwordx4 s[36:39], s[0:1], 104
    s_waitcnt lgkmcnt(0)
    s_mov_b32 s12, s38
    s_mov_b32 s13, s39
    s_mov_b32 s30, 0x05040100
    s_mov_b32 s31, 0x07060302
    s_cmp_ge_u32 s2, 84
    s_cbranch_scc1 K1_W
    s_mov_b32 s16, s8
    s_mov_b32 s17, s9
    s_mov_b32 s18, 0x380
    s_mov_b32 s19, 0x00020000
    s_mov_b32 s20, s10
    s_mov_b32 s21, s11
    s_mov_b32 s22, 0x24c000
    s_mov_b32 s23, 0x00020000
    s_mov_b32 s24, s12
    s_mov_b32 s25, s13
    s_mov_b32 s26, 0x2a00
    s_mov_b32 s27, 0x00020000
    s_mov_b32 s40, s36
    s_mov_b32 s41, s37
    s_mov_b32 s42, 0x100
    s_mov_b32 s43, 0x00020000
    v_lshlrev_b32 v1, 1, v0
    buffer_load_ushort v2, v1, s[16:19], 0 offen
    buffer_load_ushort v3, v1, s[16:19], 0 offen offset:512
    v_and_b32 v4, 15, v0
    v_lshrrev_b32 v5, 4, v0
    v_mul_u32_u24 v6, 150528, v5
    v_lshl_add_u32 v6, v4, 2, v6
    s_lshl_b32 s3, s2, 6
    s_add_u32 s14, s3, 0
    buffer_load_dword v16, v6, s[20:23], s14 offen
    s_add_u32 s14, s3, 5376
    buffer_load_dword v17, v6, s[20:23], s14 offen
    s_add_u32 s14, s3, 10752
    buffer_load_dword v18, v6, s[20:23], s14 offen
    s_add_u32 s14, s3, 16128
    buffer_load_dword v19, v6, s[20:23], s14 offen
    s_add_u32 s14, s3, 21504
    buffer_load_dword v20, v6, s[20:23], s14 offen
    s_add_u32 s14, s3, 26880
    buffer_load_dword v21, v6, s[20:23], s14 offen
    s_add_u32 s14, s3, 32256
    buffer_load_dword v22, v6, s[20:23], s14 offen
    s_add_u32 s14, s3, 37632
    buffer_load_dword v23, v6, s[20:23], s14 offen
    s_add_u32 s14, s3, 43008
    buffer_load_dword v24, v6, s[20:23], s14 offen
    s_add_u32 s14, s3, 48384
    buffer_load_dword v25, v6, s[20:23], s14 offen
    s_add_u32 s14, s3, 53760
    buffer_load_dword v26, v6, s[20:23], s14 offen
    s_add_u32 s14, s3, 59136
    buffer_load_dword v27, v6, s[20:23], s14 offen
    s_add_u32 s14, s3, 64512
    buffer_load_dword v28, v6, s[20:23], s14 offen
    s_add_u32 s14, s3, 69888
    buffer_load_dword v29, v6, s[20:23], s14 offen
    s_add_u32 s14, s3, 75264
    buffer_load_dword v30, v6, s[20:23], s14 offen
    s_add_u32 s14, s3, 80640
    buffer_load_dword v31, v6, s[20:23], s14 offen
    s_add_u32 s14, s3, 86016
    buffer_load_dword v32, v6, s[20:23], s14 offen
    s_add_u32 s14, s3, 91392
    buffer_load_dword v33, v6, s[20:23], s14 offen
    s_add_u32 s14, s3, 96768
    buffer_load_dword v34, v6, s[20:23], s14 offen
    s_add_u32 s14, s3, 102144
    buffer_load_dword v35, v6, s[20:23], s14 offen
    s_add_u32 s14, s3, 107520
    buffer_load_dword v36, v6, s[20:23], s14 offen
    s_add_u32 s14, s3, 112896
    buffer_load_dword v37, v6, s[20:23], s14 offen
    s_add_u32 s14, s3, 118272
    buffer_load_dword v38, v6, s[20:23], s14 offen
    s_add_u32 s14, s3, 123648
    buffer_load_dword v39, v6, s[20:23], s14 offen
    s_add_u32 s14, s3, 129024
    buffer_load_dword v40, v6, s[20:23], s14 offen
    s_add_u32 s14, s3, 134400
    buffer_load_dword v41, v6, s[20:23], s14 offen
    s_add_u32 s14, s3, 139776
    buffer_load_dword v42, v6, s[20:23], s14 offen
    s_add_u32 s14, s3, 145152
    buffer_load_dword v43, v6, s[20:23], s14 offen
    s_waitcnt vmcnt(28)
    v_lshlrev_b32 v2, 16, v2
    v_mul_f32 v7, 0xbfb8aa3b, v2
    v_exp_f32 v7, v7
    s_nop 0
    v_add_f32 v7, 1.0, v7
    v_rcp_f32 v7, v7
    s_nop 0
    v_mul_f32 v2, v2, v7
    v_cvt_pk_bf16_f32 v2, 0, v2
    v_lshlrev_b32 v3, 16, v3
    v_mul_f32 v7, 0xbfb8aa3b, v3
    v_exp_f32 v7, v7
    s_nop 0
    v_add_f32 v7, 1.0, v7
    v_rcp_f32 v7, v7
    s_nop 0
    v_mul_f32 v3, v3, v7
    v_cvt_pk_bf16_f32 v3, 0, v3
    v_lshlrev_b32 v7, 2, v0
    ds_write_b32 v7, v2
    ds_write_b32 v7, v3 offset:1024
    s_waitcnt lgkmcnt(0)
    s_barrier
    v_mul_u32_u24 v7, 112, v5
    ds_read_b128 v[44:47], v7 offset:0
    ds_read_b128 v[48:51], v7 offset:16
    ds_read_b128 v[52:55], v7 offset:32
    ds_read_b128 v[56:59], v7 offset:48
    ds_read_b128 v[60:63], v7 offset:64
    ds_read_b128 v[64:67], v7 offset:80
    ds_read_b128 v[68:71], v7 offset:96
    v_mov_b32 v8, 0
    v_mov_b32 v9, 0
    s_waitcnt vmcnt(0) lgkmcnt(0)
    v_lshlrev_b32 v10, 16, v16
    v_and_b32 v11, 0xffff0000, v16
    v_fmac_f32 v8, v10, v44
    v_fmac_f32 v9, v11, v44
    v_lshlrev_b32 v10, 16, v17
    v_and_b32 v11, 0xffff0000, v17
    v_fmac_f32 v8, v10, v45
    v_fmac_f32 v9, v11, v45
    v_lshlrev_b32 v10, 16, v18
    v_and_b32 v11, 0xffff0000, v18
    v_fmac_f32 v8, v10, v46
    v_fmac_f32 v9, v11, v46
    v_lshlrev_b32 v10, 16, v19
    v_and_b32 v11, 0xffff0000, v19
    v_fmac_f32 v8, v10, v47
    v_fmac_f32 v9, v11, v47
    v_lshlrev_b32 v10, 16, v20
    v_and_b32 v11, 0xffff0000, v20
    v_fmac_f32 v8, v10, v48
    v_fmac_f32 v9, v11, v48
    v_lshlrev_b32 v10, 16, v21
    v_and_b32 v11, 0xffff0000, v21
    v_fmac_f32 v8, v10, v49
    v_fmac_f32 v9, v11, v49
    v_lshlrev_b32 v10, 16, v22
    v_and_b32 v11, 0xffff0000, v22
    v_fmac_f32 v8, v10, v50
    v_fmac_f32 v9, v11, v50
    v_lshlrev_b32 v10, 16, v23
    v_and_b32 v11, 0xffff0000, v23
    v_fmac_f32 v8, v10, v51
    v_fmac_f32 v9, v11, v51
    v_lshlrev_b32 v10, 16, v24
    v_and_b32 v11, 0xffff0000, v24
    v_fmac_f32 v8, v10, v52
    v_fmac_f32 v9, v11, v52
    v_lshlrev_b32 v10, 16, v25
    v_and_b32 v11, 0xffff0000, v25
    v_fmac_f32 v8, v10, v53
    v_fmac_f32 v9, v11, v53
    v_lshlrev_b32 v10, 16, v26
    v_and_b32 v11, 0xffff0000, v26
    v_fmac_f32 v8, v10, v54
    v_fmac_f32 v9, v11, v54
    v_lshlrev_b32 v10, 16, v27
    v_and_b32 v11, 0xffff0000, v27
    v_fmac_f32 v8, v10, v55
    v_fmac_f32 v9, v11, v55
    v_lshlrev_b32 v10, 16, v28
    v_and_b32 v11, 0xffff0000, v28
    v_fmac_f32 v8, v10, v56
    v_fmac_f32 v9, v11, v56
    v_lshlrev_b32 v10, 16, v29
    v_and_b32 v11, 0xffff0000, v29
    v_fmac_f32 v8, v10, v57
    v_fmac_f32 v9, v11, v57
    v_lshlrev_b32 v10, 16, v30
    v_and_b32 v11, 0xffff0000, v30
    v_fmac_f32 v8, v10, v58
    v_fmac_f32 v9, v11, v58
    v_lshlrev_b32 v10, 16, v31
    v_and_b32 v11, 0xffff0000, v31
    v_fmac_f32 v8, v10, v59
    v_fmac_f32 v9, v11, v59
    v_lshlrev_b32 v10, 16, v32
    v_and_b32 v11, 0xffff0000, v32
    v_fmac_f32 v8, v10, v60
    v_fmac_f32 v9, v11, v60
    v_lshlrev_b32 v10, 16, v33
    v_and_b32 v11, 0xffff0000, v33
    v_fmac_f32 v8, v10, v61
    v_fmac_f32 v9, v11, v61
    v_lshlrev_b32 v10, 16, v34
    v_and_b32 v11, 0xffff0000, v34
    v_fmac_f32 v8, v10, v62
    v_fmac_f32 v9, v11, v62
    v_lshlrev_b32 v10, 16, v35
    v_and_b32 v11, 0xffff0000, v35
    v_fmac_f32 v8, v10, v63
    v_fmac_f32 v9, v11, v63
    v_lshlrev_b32 v10, 16, v36
    v_and_b32 v11, 0xffff0000, v36
    v_fmac_f32 v8, v10, v64
    v_fmac_f32 v9, v11, v64
    v_lshlrev_b32 v10, 16, v37
    v_and_b32 v11, 0xffff0000, v37
    v_fmac_f32 v8, v10, v65
    v_fmac_f32 v9, v11, v65
    v_lshlrev_b32 v10, 16, v38
    v_and_b32 v11, 0xffff0000, v38
    v_fmac_f32 v8, v10, v66
    v_fmac_f32 v9, v11, v66
    v_lshlrev_b32 v10, 16, v39
    v_and_b32 v11, 0xffff0000, v39
    v_fmac_f32 v8, v10, v67
    v_fmac_f32 v9, v11, v67
    v_lshlrev_b32 v10, 16, v40
    v_and_b32 v11, 0xffff0000, v40
    v_fmac_f32 v8, v10, v68
    v_fmac_f32 v9, v11, v68
    v_lshlrev_b32 v10, 16, v41
    v_and_b32 v11, 0xffff0000, v41
    v_fmac_f32 v8, v10, v69
    v_fmac_f32 v9, v11, v69
    v_lshlrev_b32 v10, 16, v42
    v_and_b32 v11, 0xffff0000, v42
    v_fmac_f32 v8, v10, v70
    v_fmac_f32 v9, v11, v70
    v_lshlrev_b32 v10, 16, v43
    v_and_b32 v11, 0xffff0000, v43
    v_fmac_f32 v8, v10, v71
    v_fmac_f32 v9, v11, v71
    v_lshlrev_b32 v7, 3, v0
    ds_write_b64 v7, v[8:9] offset:4096
    s_waitcnt lgkmcnt(0)
    s_barrier
    v_cmp_gt_u32 vcc, 32, v0
    s_and_saveexec_b64 s[14:15], vcc
    s_cbranch_execz K1_END
    v_lshlrev_b32 v7, 2, v0
    ds_read_b32 v16, v7 offset:4096
    ds_read_b32 v17, v7 offset:4224
    ds_read_b32 v18, v7 offset:4352
    ds_read_b32 v19, v7 offset:4480
    ds_read_b32 v20, v7 offset:4608
    ds_read_b32 v21, v7 offset:4736
    ds_read_b32 v22, v7 offset:4864
    ds_read_b32 v23, v7 offset:4992
    ds_read_b32 v24, v7 offset:5120
    ds_read_b32 v25, v7 offset:5248
    ds_read_b32 v26, v7 offset:5376
    ds_read_b32 v27, v7 offset:5504
    ds_read_b32 v28, v7 offset:5632
    ds_read_b32 v29, v7 offset:5760
    ds_read_b32 v30, v7 offset:5888
    ds_read_b32 v31, v7 offset:6016
    s_waitcnt lgkmcnt(0)
    v_add_f32 v16, v16, v17
    v_add_f32 v16, v16, v18
    v_add_f32 v16, v16, v19
    v_add_f32 v16, v16, v20
    v_add_f32 v16, v16, v21
    v_add_f32 v16, v16, v22
    v_add_f32 v16, v16, v23
    v_add_f32 v16, v16, v24
    v_add_f32 v16, v16, v25
    v_add_f32 v16, v16, v26
    v_add_f32 v16, v16, v27
    v_add_f32 v16, v16, v28
    v_add_f32 v16, v16, v29
    v_add_f32 v16, v16, v30
    v_add_f32 v16, v16, v31
    v_cvt_pk_bf16_f32 v16, 0, v16
    s_sub_u32 s3, s2, 14
    s_cmp_lt_u32 s3, 14
    s_cbranch_scc0 K1_NOCA
    v_add_f32 v16, 1.0, v16
    v_cvt_pk_bf16_f32 v16, 0, v16
K1_NOCA:
    s_lshl_b32 s3, s2, 7
    buffer_store_dword v16, v7, s[24:27], s3 offen
    s_endpgm
K1_W:
    s_cmp_ge_u32 s2, 308
    s_cbranch_scc1 K1_WO
    s_mov_b32 s16, s4
    s_mov_b32 s17, s5
    s_mov_b32 s18, 0x380000
    s_mov_b32 s19, 0x00020000
    s_add_u32 s20, s12, 0x10000
    s_addc_u32 s21, s13, 0
    s_mov_b32 s22, 0x380000
    s_mov_b32 s23, 0x00020000
    v_lshrrev_b32 v1, 6, v0
    s_sub_u32 s3, s2, 84
    s_nop 0
    v_readfirstlane_b32 s14, v1
    s_lshl_b32 s3, s3, 2
    s_add_u32 s3, s3, s14
    s_and_b32 s14, s3, 1
    s_lshr_b32 s15, s3, 1
    s_mul_hi_u32 s28, s15, 153391690
    s_mul_i32 s29, s28, 28
    s_sub_u32 s29, s15, s29
    s_lshl_b32 s32, s29, 1
    s_add_u32 s32, s32, s14
    s_lshl_b32 s32, s32, 16
    s_lshl_b32 s33, s28, 9
    s_add_u32 s32, s32, s33
    v_and_b32 v2, 63, v0
    v_lshlrev_b32 v3, 3, v2
    s_add_u32 s33, s32, 0
    buffer_load_dwordx2 v[16:17], v3, s[16:19], s33 offen nt
    s_add_u32 s33, s32, 8192
    buffer_load_dwordx2 v[18:19], v3, s[16:19], s33 offen nt
    s_add_u32 s33, s32, 16384
    buffer_load_dwordx2 v[20:21], v3, s[16:19], s33 offen nt
    s_add_u32 s33, s32, 24576
    buffer_load_dwordx2 v[22:23], v3, s[16:19], s33 offen nt
    s_add_u32 s33, s32, 32768
    buffer_load_dwordx2 v[24:25], v3, s[16:19], s33 offen nt
    s_add_u32 s33, s32, 40960
    buffer_load_dwordx2 v[26:27], v3, s[16:19], s33 offen nt
    s_add_u32 s33, s32, 49152
    buffer_load_dwordx2 v[28:29], v3, s[16:19], s33 offen nt
    s_add_u32 s33, s32, 57344
    buffer_load_dwordx2 v[30:31], v3, s[16:19], s33 offen nt
    v_lshrrev_b32 v4, 3, v2
    v_lshlrev_b32 v4, 11, v4
    v_and_b32 v5, 4, v2
    v_lshl_add_u32 v4, v5, 6, v4
    v_and_b32 v5, 1, v2
    v_lshl_add_u32 v4, v5, 7, v4
    v_and_b32 v5, 2, v2
    v_lshl_add_u32 v4, v5, 5, v4
    s_and_b32 s34, s3, 3
    s_lshl_b32 s34, s34, 9
    v_add_u32 v4, s34, v4
    s_mul_i32 s33, s28, 229376
    s_and_b32 s34, s29, 30
    s_lshl_b32 s34, s34, 10
    s_add_u32 s33, s33, s34
    v_lshrrev_b32 v6, 7, v0
    v_mul_u32_u24 v6, 28672, v6
    v_and_b32 v5, 127, v0
    v_lshl_add_u32 v6, v5, 4, v6
    s_mov_b32 s35, 57344
    s_branch K1_TR
K1_WO:
    s_mov_b32 s16, s6
    s_mov_b32 s17, s7
    s_mov_b32 s18, 0x380000
    s_mov_b32 s19, 0x00020000
    s_add_u32 s20, s12, 0x400000
    s_addc_u32 s21, s13, 0
    s_mov_b32 s22, 0x380000
    s_mov_b32 s23, 0x00020000
    s_sub_u32 s3, s2, 308
    v_cmp_le_u32 vcc, 112, v0
    v_mov_b32 v5, 0
    s_nop 0
    v_cndmask_b32 v1, v5, 1, vcc
    v_mul_u32_u24 v2, 112, v1
    v_sub_u32 v2, v0, v2
    v_mul_u32_u24 v3, 3584, v1
    v_lshl_add_u32 v3, v2, 3, v3
    s_mul_i32 s32, s3, 14336
    s_add_u32 s33, s32, 0
    buffer_load_dwordx2 v[16:17], v3, s[16:19], s33 offen nt
    s_add_u32 s33, s32, 896
    buffer_load_dwordx2 v[18:19], v3, s[16:19], s33 offen nt
    s_add_u32 s33, s32, 1792
    buffer_load_dwordx2 v[20:21], v3, s[16:19], s33 offen nt
    s_add_u32 s33, s32, 2688
    buffer_load_dwordx2 v[22:23], v3, s[16:19], s33 offen nt
    s_add_u32 s33, s32, 7168
    buffer_load_dwordx2 v[24:25], v3, s[16:19], s33 offen nt
    s_add_u32 s33, s32, 8064
    buffer_load_dwordx2 v[26:27], v3, s[16:19], s33 offen nt
    s_add_u32 s33, s32, 8960
    buffer_load_dwordx2 v[28:29], v3, s[16:19], s33 offen nt
    s_add_u32 s33, s32, 9856
    buffer_load_dwordx2 v[30:31], v3, s[16:19], s33 offen nt
    v_lshrrev_b32 v4, 3, v2
    v_lshlrev_b32 v4, 10, v4
    v_lshl_add_u32 v4, v1, 9, v4
    v_and_b32 v5, 7, v2
    v_lshl_add_u32 v4, v5, 6, v4
    s_mul_i32 s33, s3, 14336
    v_lshlrev_b32 v6, 4, v0
    s_mov_b32 s35, 4096
    v_cmp_gt_u32 vcc, 224, v0
    v_mov_b32 v5, 16384
    s_nop 0
    v_cndmask_b32 v4, v5, v4, vcc
    s_add_u32 s22, s33, 14336
K1_TR:
    s_waitcnt vmcnt(0)
    v_perm_b32 v32, v18, v16, s30
    v_perm_b32 v33, v22, v20, s30
    v_perm_b32 v34, v26, v24, s30
    v_perm_b32 v35, v30, v28, s30
    v_perm_b32 v36, v18, v16, s31
    v_perm_b32 v37, v22, v20, s31
    v_perm_b32 v38, v26, v24, s31
    v_perm_b32 v39, v30, v28, s31
    v_perm_b32 v40, v19, v17, s30
    v_perm_b32 v41, v23, v21, s30
    v_perm_b32 v42, v27, v25, s30
    v_perm_b32 v43, v31, v29, s30
    v_perm_b32 v44, v19, v17, s31
    v_perm_b32 v45, v23, v21, s31
    v_perm_b32 v46, v27, v25, s31
    v_perm_b32 v47, v31, v29, s31
    ds_write_b128 v4, v[32:35] offset:0
    ds_write_b128 v4, v[36:39] offset:16
    ds_write_b128 v4, v[40:43] offset:32
    ds_write_b128 v4, v[44:47] offset:48
    v_lshlrev_b32 v7, 4, v0
    s_waitcnt lgkmcnt(0)
    s_barrier
    ds_read_b128 v[32:35], v7 offset:0
    ds_read_b128 v[36:39], v7 offset:4096
    ds_read_b128 v[40:43], v7 offset:8192
    ds_read_b128 v[44:47], v7 offset:12288
    s_waitcnt lgkmcnt(3)
    buffer_store_dwordx4 v[32:35], v6, s[20:23], s33 offen
    s_add_u32 s33, s33, s35
    s_waitcnt lgkmcnt(2)
    buffer_store_dwordx4 v[36:39], v6, s[20:23], s33 offen
    s_add_u32 s33, s33, s35
    s_waitcnt lgkmcnt(1)
    buffer_store_dwordx4 v[40:43], v6, s[20:23], s33 offen
    s_add_u32 s33, s33, s35
    s_waitcnt lgkmcnt(0)
    buffer_store_dwordx4 v[44:47], v6, s[20:23], s33 offen
    s_add_u32 s33, s33, s35
K1_END:
    s_endpgm
K1_LN:
    s_sub_u32 s2, s2, 564
    s_cmp_ge_u32 s2, 512
    s_cbranch_scc1 K2_END
    v_lshrrev_b32 v1, 6, v0
    s_nop 0
    v_readfirstlane_b32 s3, v1
    s_lshl_b32 s4, s2, 2
    s_add_u32 s3, s3, s4
    v_and_b32 v1, 63, v0
    v_cmp_gt_u32 vcc, 56, v1
    v_mov_b32 v2, 0
    s_nop 0
    v_cndmask_b32 v2, v2, 1.0, vcc
    s_load_dwordx2 s[4:5], s[0:1], 0
    s_load_dwordx4 s[36:39], s[0:1], 104
    s_load_dwordx4 s[8:11], s[0:1], 56
    s_load_dwordx2 s[12:13], s[0:1], 72
    s_waitcnt lgkmcnt(0)
    s_mov_b32 s16, s4
    s_mov_b32 s17, s5
    s_mov_b32 s18, 0x1c0000
    s_mov_b32 s19, 0x00020000
    s_mov_b32 s20, s38
    s_mov_b32 s21, s39
    s_mov_b32 s22, 0x2a00
    s_mov_b32 s23, 0x00020000
    s_add_u32 s24, s38, 0x800000
    s_addc_u32 s25, s39, 0
    s_mov_b32 s26, 0x1c0000
    s_mov_b32 s27, 0x00020000
    s_add_u32 s40, s38, 0x3c00000
    s_addc_u32 s41, s39, 0
    s_mov_b32 s42, 0x800
    s_mov_b32 s43, 0x00020000
    v_lshlrev_b32 v3, 4, v1
    s_mul_i32 s6, s3, 896
    buffer_load_dwordx4 v[4:7], v3, s[16:19], s6 offen
    v_lshlrev_b32 v8, 5, v1
    s_waitcnt vmcnt(0)
    v_lshlrev_b32 v16, 16, v4
    v_and_b32 v17, 0xffff0000, v4
    v_lshlrev_b32 v18, 16, v5
    v_and_b32 v19, 0xffff0000, v5
    v_lshlrev_b32 v20, 16, v6
    v_and_b32 v21, 0xffff0000, v6
    v_lshlrev_b32 v22, 16, v7
    v_and_b32 v23, 0xffff0000, v7
    v_add_f32 v32, v16, v17
    v_add_f32 v32, v32, v18
    v_add_f32 v32, v32, v19
    v_add_f32 v32, v32, v20
    v_add_f32 v32, v32, v21
    v_add_f32 v32, v32, v22
    v_add_f32 v32, v32, v23
    v_mul_f32 v32, v32, v2
    s_nop 1
    v_add_f32_dpp v32, v32, v32 quad_perm:[1,0,3,2] row_mask:0xf bank_mask:0xf
    s_nop 1
    v_add_f32_dpp v32, v32, v32 quad_perm:[2,3,0,1] row_mask:0xf bank_mask:0xf
    s_nop 1
    v_add_f32_dpp v32, v32, v32 row_half_mirror row_mask:0xf bank_mask:0xf
    s_nop 1
    v_add_f32_dpp v32, v32, v32 row_mirror row_mask:0xf bank_mask:0xf
    v_mov_b32 v33, v32
    s_nop 1
    v_permlane16_swap_b32 v32, v33
    s_nop 1
    v_add_f32 v32, v32, v33
    v_mov_b32 v33, v32
    s_nop 1
    v_permlane32_swap_b32 v32, v33
    s_nop 1
    v_add_f32 v32, v32, v33
    v_mul_f32 v32, 0x3b124925, v32
    v_sub_f32 v24, v16, v32
    v_sub_f32 v25, v17, v32
    v_sub_f32 v26, v18, v32
    v_sub_f32 v27, v19, v32
    v_sub_f32 v28, v20, v32
    v_sub_f32 v29, v21, v32
    v_sub_f32 v30, v22, v32
    v_sub_f32 v31, v23, v32
    v_mul_f32 v34, v24, v24
    v_fmac_f32 v34, v25, v25
    v_fmac_f32 v34, v26, v26
    v_fmac_f32 v34, v27, v27
    v_fmac_f32 v34, v28, v28
    v_fmac_f32 v34, v29, v29
    v_fmac_f32 v34, v30, v30
    v_fmac_f32 v34, v31, v31
    v_mul_f32 v34, v34, v2
    s_nop 1
    v_add_f32_dpp v34, v34, v34 quad_perm:[1,0,3,2] row_mask:0xf bank_mask:0xf
    s_nop 1
    v_add_f32_dpp v34, v34, v34 quad_perm:[2,3,0,1] row_mask:0xf bank_mask:0xf
    s_nop 1
    v_add_f32_dpp v34, v34, v34 row_half_mirror row_mask:0xf bank_mask:0xf
    s_nop 1
    v_add_f32_dpp v34, v34, v34 row_mirror row_mask:0xf bank_mask:0xf
    v_mov_b32 v33, v34
    s_nop 1
    v_permlane16_swap_b32 v34, v33
    s_nop 1
    v_add_f32 v34, v34, v33
    v_mov_b32 v33, v34
    s_nop 1
    v_permlane32_swap_b32 v34, v33
    s_nop 1
    v_add_f32 v34, v34, v33
    v_mul_f32 v34, 0x3b124925, v34
    v_cvt_pk_bf16_f32 v32, 0, v32
    v_cvt_pk_bf16_f32 v34, 0, v34
    v_add_f32 v34, 0x3727c5ac, v34
    v_cvt_pk_bf16_f32 v34, 0, v34
    v_sqrt_f32 v34, v34
    s_nop 0
    v_cvt_pk_bf16_f32 v34, 0, v34
    v_rcp_f32 v35, v34
    s_nop 0
    v_sub_f32 v24, v16, v32
    v_cvt_pk_bf16_f32 v24, 0, v24
    v_mul_f32 v33, v24, v35
    v_fma_f32 v24, -v33, v34, v24
    v_fma_f32 v24, v24, v35, v33
    v_cvt_pk_bf16_f32 v24, 0, v24
    v_sub_f32 v25, v17, v32
    v_cvt_pk_bf16_f32 v25, 0, v25
    v_mul_f32 v33, v25, v35
    v_fma_f32 v25, -v33, v34, v25
    v_fma_f32 v25, v25, v35, v33
    v_cvt_pk_bf16_f32 v25, 0, v25
    v_sub_f32 v26, v18, v32
    v_cvt_pk_bf16_f32 v26, 0, v26
    v_mul_f32 v33, v26, v35
    v_fma_f32 v26, -v33, v34, v26
    v_fma_f32 v26, v26, v35, v33
    v_cvt_pk_bf16_f32 v26, 0, v26
    v_sub_f32 v27, v19, v32
    v_cvt_pk_bf16_f32 v27, 0, v27
    v_mul_f32 v33, v27, v35
    v_fma_f32 v27, -v33, v34, v27
    v_fma_f32 v27, v27, v35, v33
    v_cvt_pk_bf16_f32 v27, 0, v27
    v_sub_f32 v28, v20, v32
    v_cvt_pk_bf16_f32 v28, 0, v28
    v_mul_f32 v33, v28, v35
    v_fma_f32 v28, -v33, v34, v28
    v_fma_f32 v28, v28, v35, v33
    v_cvt_pk_bf16_f32 v28, 0, v28
    v_sub_f32 v29, v21, v32
    v_cvt_pk_bf16_f32 v29, 0, v29
    v_mul_f32 v33, v29, v35
    v_fma_f32 v29, -v33, v34, v29
    v_fma_f32 v29, v29, v35, v33
    v_cvt_pk_bf16_f32 v29, 0, v29
    v_sub_f32 v30, v22, v32
    v_cvt_pk_bf16_f32 v30, 0, v30
    v_mul_f32 v33, v30, v35
    v_fma_f32 v30, -v33, v34, v30
    v_fma_f32 v30, v30, v35, v33
    v_cvt_pk_bf16_f32 v30, 0, v30
    v_sub_f32 v31, v23, v32
    v_cvt_pk_bf16_f32 v31, 0, v31
    v_mul_f32 v33, v31, v35
    v_fma_f32 v31, -v33, v34, v31
    v_fma_f32 v31, v31, v35, v33
    v_cvt_pk_bf16_f32 v31, 0, v31
    v_cvt_pk_bf16_f32 v4, v24, v25
    v_cvt_pk_bf16_f32 v5, v26, v27
    v_cvt_pk_bf16_f32 v6, v28, v29
    v_cvt_pk_bf16_f32 v7, v30, v31
    s_lshr_b32 s6, s3, 5
    s_mul_i32 s6, s6, 28672
    s_and_b32 s7, s3, 31
    s_lshl_b32 s7, s7, 4
    s_add_u32 s6, s6, s7
    v_lshlrev_b32 v3, 9, v1
    v_cmp_gt_u32 vcc, 56, v1
    s_and_saveexec_b64 s[14:15], vcc
    buffer_store_dwordx4 v[4:7], v3, s[24:27], s6 offen
K2_END:
    s_endpgm
    .globl k3_kernel
    .p2align 8
    .type k3_kernel,@function
k3_kernel:
    s_cmp_ge_u32 s2, 256
    s_cbranch_scc1 K3_END
    s_load_dwordx4 s[4:7], s[0:1], 8
    s_load_dwordx2 s[34:35], s[0:1], 112
    v_lshrrev_b32 v20, 6, v0
    v_and_b32 v0, 63, v0
    v_readfirstlane_b32 s36, v20
    s_and_b32 s37, s2, 7
    s_lshr_b32 s38, s2, 3
    s_and_b32 s40, s36, 1
    s_lshr_b32 s41, s36, 1
    s_lshl_b32 s39, s37, 1
    s_add_u32 s39, s39, s40
    v_lshlrev_b32 v21, 4, v0
    s_mul_i32 s42, s38, 57344
    s_mul_i32 s43, s36, 14336
    s_add_u32 s42, s42, s43
    s_waitcnt lgkmcnt(0)
    s_add_u32 s16, s34, 0x800000
    s_addc_u32 s17, s35, 0
    s_mov_b32 s18, 0x1c0000
    s_mov_b32 s19, 0x00020000
    s_add_u32 s44, s34, 0x10000
    s_addc_u32 s45, s35, 0
    s_mov_b32 s46, 0x380000
    s_mov_b32 s47, 0x00020000
    s_mov_b32 s48, s34
    s_mov_b32 s49, s35
    s_mov_b32 s50, 0xe00
    s_mov_b32 s51, 0x00020000
    s_mul_i32 s42, s38, 57344
    s_mul_i32 s43, s40, 28672
    s_mul_i32 s3, s41, 14336
    s_add_u32 s43, s43, s3
    s_add_u32 s42, s42, s43
    s_lshl_b32 s58, s36, 12
    s_add_u32 s58, s58, 147456
    s_add_u32 s3, s42, 0
    buffer_load_dwordx4 v[160:163], v21, s[16:19], s3 offen offset:0
    s_add_u32 s3, s42, 0
    buffer_load_dwordx4 v[164:167], v21, s[16:19], s3 offen offset:1024
    s_add_u32 s3, s42, 0
    buffer_load_dwordx4 v[168:171], v21, s[16:19], s3 offen offset:2048
    s_add_u32 s3, s42, 0
    buffer_load_dwordx4 v[172:175], v21, s[16:19], s3 offen offset:3072
    s_add_u32 s3, s42, 4096
    buffer_load_dwordx4 v[176:179], v21, s[16:19], s3 offen offset:0
    s_add_u32 s3, s42, 4096
    buffer_load_dwordx4 v[180:183], v21, s[16:19], s3 offen offset:1024
    s_add_u32 s3, s42, 4096
    buffer_load_dwordx4 v[184:187], v21, s[16:19], s3 offen offset:2048
    s_add_u32 s3, s42, 4096
    buffer_load_dwordx4 v[188:191], v21, s[16:19], s3 offen offset:3072
    s_add_u32 s3, s42, 8192
    buffer_load_dwordx4 v[192:195], v21, s[16:19], s3 offen offset:0
    s_add_u32 s3, s42, 8192
    buffer_load_dwordx4 v[196:199], v21, s[16:19], s3 offen offset:1024
    s_add_u32 s3, s42, 8192
    buffer_load_dwordx4 v[200:203], v21, s[16:19], s3 offen offset:2048
    s_add_u32 s3, s42, 8192
    buffer_load_dwordx4 v[204:207], v21, s[16:19], s3 offen offset:3072
    s_add_u32 s3, s42, 12288
    buffer_load_dwordx4 v[208:211], v21, s[16:19], s3 offen offset:0
    s_add_u32 s3, s42, 12288
    buffer_load_dwordx4 v[212:215], v21, s[16:19], s3 offen offset:1024
    s_mov_b32 m0, s58
    s_nop 0
    buffer_load_dwordx4 v21, s[48:51], 0 offen offset:0 lds
    buffer_load_dwordx4 v21, s[48:51], 0 offen offset:1024 lds
    buffer_load_dwordx4 v21, s[48:51], 0 offen offset:2048 lds
    buffer_load_dwordx4 v21, s[48:51], 0 offen offset:3072 lds
    s_lshl_b32 s3, s39, 3
    s_lshl_b32 s42, s41, 2
    s_add_u32 s3, s3, s42
    s_mul_i32 s52, s3, 28672
    s_add_u32 s53, s52, 28672
    s_add_u32 s54, s52, 57344
    s_add_u32 s55, s52, 86016
    s_add_u32 s3, s52, 0
    buffer_load_dwordx4 v[32:35], v21, s[44:47], s3 offen offset:0
    s_add_u32 s3, s53, 0
    buffer_load_dwordx4 v[36:39], v21, s[44:47], s3 offen offset:0
    s_add_u32 s3, s54, 0
    buffer_load_dwordx4 v[40:43], v21, s[44:47], s3 offen offset:0
    s_add_u32 s3, s55, 0
    buffer_load_dwordx4 v[44:47], v21, s[44:47], s3 offen offset:0
    s_add_u32 s3, s52, 0
    buffer_load_dwordx4 v[48:51], v21, s[44:47], s3 offen offset:1024
    s_add_u32 s3, s53, 0
    buffer_load_dwordx4 v[52:55], v21, s[44:47], s3 offen offset:1024
    s_add_u32 s3, s54, 0
    buffer_load_dwordx4 v[56:59], v21, s[44:47], s3 offen offset:1024
    s_add_u32 s3, s55, 0
    buffer_load_dwordx4 v[60:63], v21, s[44:47], s3 offen offset:1024
    s_add_u32 s3, s52, 0
    buffer_load_dwordx4 v[64:67], v21, s[44:47], s3 offen offset:2048
    s_add_u32 s3, s53, 0
    buffer_load_dwordx4 v[68:71], v21, s[44:47], s3 offen offset:2048
    s_add_u32 s3, s54, 0
    buffer_load_dwordx4 v[72:75], v21, s[44:47], s3 offen offset:2048
    s_add_u32 s3, s55, 0
    buffer_load_dwordx4 v[76:79], v21, s[44:47], s3 offen offset:2048
    s_add_u32 s3, s52, 0
    buffer_load_dwordx4 v[80:83], v21, s[44:47], s3 offen offset:3072
    s_add_u32 s3, s53, 0
    buffer_load_dwordx4 v[84:87], v21, s[44:47], s3 offen offset:3072
    s_add_u32 s3, s54, 0
    buffer_load_dwordx4 v[88:91], v21, s[44:47], s3 offen offset:3072
    s_add_u32 s3, s55, 0
    buffer_load_dwordx4 v[92:95], v21, s[44:47], s3 offen offset:3072
    s_add_u32 s3, s52, 4096
    buffer_load_dwordx4 v[96:99], v21, s[44:47], s3 offen offset:0
    s_add_u32 s3, s53, 4096
    buffer_load_dwordx4 v[100:103], v21, s[44:47], s3 offen offset:0
    s_add_u32 s3, s54, 4096
    buffer_load_dwordx4 v[104:107], v21, s[44:47], s3 offen offset:0
    s_add_u32 s3, s55, 4096
    buffer_load_dwordx4 v[108:111], v21, s[44:47], s3 offen offset:0
    s_add_u32 s3, s52, 4096
    buffer_load_dwordx4 v[112:115], v21, s[44:47], s3 offen offset:1024
    s_add_u32 s3, s53, 4096
    buffer_load_dwordx4 v[116:119], v21, s[44:47], s3 offen offset:1024
    s_add_u32 s3, s54, 4096
    buffer_load_dwordx4 v[120:123], v21, s[44:47], s3 offen offset:1024
    s_add_u32 s3, s55, 4096
    buffer_load_dwordx4 v[124:127], v21, s[44:47], s3 offen offset:1024
    s_add_u32 s3, s52, 4096
    buffer_load_dwordx4 v[128:131], v21, s[44:47], s3 offen offset:2048
    s_add_u32 s3, s53, 4096
    buffer_load_dwordx4 v[132:135], v21, s[44:47], s3 offen offset:2048
    s_add_u32 s3, s54, 4096
    buffer_load_dwordx4 v[136:139], v21, s[44:47], s3 offen offset:2048
    s_add_u32 s3, s55, 4096
    buffer_load_dwordx4 v[140:143], v21, s[44:47], s3 offen offset:2048
    s_add_u32 s3, s52, 4096
    buffer_load_dwordx4 v[144:147], v21, s[44:47], s3 offen offset:3072
    s_add_u32 s3, s53, 4096
    buffer_load_dwordx4 v[148:151], v21, s[44:47], s3 offen offset:3072
    s_add_u32 s3, s54, 4096
    buffer_load_dwordx4 v[152:155], v21, s[44:47], s3 offen offset:3072
    s_add_u32 s3, s55, 4096
    buffer_load_dwordx4 v[156:159], v21, s[44:47], s3 offen offset:3072
    s_mov_b32 s8, s4
    s_mov_b32 s9, s5
    s_mov_b32 s10, 0x800000
    s_mov_b32 s11, 0x00020000
    s_mov_b32 s12, s6
    s_mov_b32 s13, s7
    s_mov_b32 s14, 0x800000
    s_mov_b32 s15, 0x00020000
    s_add_u32 s48, s34, 0x1a00000
    s_addc_u32 s49, s35, 0
    s_mov_b32 s50, 0x1c00000
    s_mov_b32 s51, 0x00020000
    v_lshrrev_b32 v22, 5, v0
    v_xor_b32 v4, v0, v22
    v_lshlrev_b32 v4, 4, v4
    v_lshlrev_b32 v23, 2, v22
    v_xor_b32 v5, v0, v23
    v_lshlrev_b32 v5, 4, v5
    s_lshl_b32 s20, s37, 20
    s_lshl_b32 s3, s41, 19
    s_add_u32 s20, s20, s3
    s_lshl_b32 s3, s40, 13
    s_add_u32 s20, s20, s3
    s_add_u32 s21, s20, 4096
    s_mov_b32 s22, s20
    s_mov_b32 s23, s21
    s_mul_i32 s3, s41, 16896
    s_mul_i32 s24, s40, 8448
    s_add_u32 s24, s24, s3
    s_add_u32 s25, s24, 96256
    s_add_u32 s24, s24, 130048
    s_mul_i32 s3, s41, 36864
    s_mul_i32 s26, s40, 9216
    s_add_u32 s26, s26, s3
    s_add_u32 s27, s26, 18432
    s_mov_b32 s28, 0x3db8aa3b
    s_mov_b32 s29, 0x42700000
    s_mov_b32 s57, 0x0
    v_mov_b32 v18, s57
    s_mov_b32 s30, 0
    v_and_b32 v24, 31, v0
    v_lshrrev_b32 v25, 1, v24
    v_mul_u32_u24 v1, 1056, v25
    v_and_b32 v25, 1, v24
    v_lshl_add_u32 v1, v25, 9, v1
    v_xor_b32 v25, v25, v22
    v_lshl_add_u32 v1, v25, 4, v1
    s_mul_i32 s3, s41, 16896
    s_add_u32 s3, s3, 96256
    v_add_u32 v1, s3, v1
    v_bfe_u32 v24, v0, 3, 1
    v_lshl_add_u32 v24, v22, 1, v24
    v_mul_u32_u24 v2, 1152, v24
    v_bfe_u32 v24, v0, 2, 1
    v_lshl_add_u32 v2, v24, 9, v2
    v_bfe_u32 v25, v0, 4, 1
    v_lshl_add_u32 v2, v25, 5, v2
    v_and_b32 v25, 3, v0
    v_lshl_add_u32 v2, v25, 3, v2
    s_mul_i32 s3, s41, 36864
    v_add_u32 v2, s3, v2
    v_lshlrev_b32 v24, 6, v24
    v_sub_u32 v3, v2, v24
    v_add_u32 v2, v2, v24
    v_accvgpr_write_b32 a160, 0
    v_accvgpr_write_b32 a161, 0
    v_accvgpr_write_b32 a162, 0
    v_accvgpr_write_b32 a163, 0
    v_accvgpr_write_b32 a164, 0
    v_accvgpr_write_b32 a165, 0
    v_accvgpr_write_b32 a166, 0
    v_accvgpr_write_b32 a167, 0
    v_accvgpr_write_b32 a168, 0
    v_accvgpr_write_b32 a169, 0
    v_accvgpr_write_b32 a170, 0
    v_accvgpr_write_b32 a171, 0
    v_accvgpr_write_b32 a172, 0
    v_accvgpr_write_b32 a173, 0
    v_accvgpr_write_b32 a174, 0
    v_accvgpr_write_b32 a175, 0
    v_accvgpr_write_b32 a176, 0
    v_accvgpr_write_b32 a177, 0
    v_accvgpr_write_b32 a178, 0
    v_accvgpr_write_b32 a179, 0
    v_accvgpr_write_b32 a180, 0
    v_accvgpr_write_b32 a181, 0
    v_accvgpr_write_b32 a182, 0
    v_accvgpr_write_b32 a183, 0
    v_accvgpr_write_b32 a184, 0
    v_accvgpr_write_b32 a185, 0
    v_accvgpr_write_b32 a186, 0
    v_accvgpr_write_b32 a187, 0
    v_accvgpr_write_b32 a188, 0
    v_accvgpr_write_b32 a189, 0
    v_accvgpr_write_b32 a190, 0
    v_accvgpr_write_b32 a191, 0
    v_accvgpr_write_b32 a192, 0
    v_accvgpr_write_b32 a193, 0
    v_accvgpr_write_b32 a194, 0
    v_accvgpr_write_b32 a195, 0
    v_accvgpr_write_b32 a196, 0
    v_accvgpr_write_b32 a197, 0
    v_accvgpr_write_b32 a198, 0
    v_accvgpr_write_b32 a199, 0
    v_accvgpr_write_b32 a200, 0
    v_accvgpr_write_b32 a201, 0
    v_accvgpr_write_b32 a202, 0
    v_accvgpr_write_b32 a203, 0
    v_accvgpr_write_b32 a204, 0
    v_accvgpr_write_b32 a205, 0
    v_accvgpr_write_b32 a206, 0
    v_accvgpr_write_b32 a207, 0
    v_accvgpr_write_b32 a208, 0
    v_accvgpr_write_b32 a209, 0
    v_accvgpr_write_b32 a210, 0
    v_accvgpr_write_b32 a211, 0
    v_accvgpr_write_b32 a212, 0
    v_accvgpr_write_b32 a213, 0
    v_accvgpr_write_b32 a214, 0
    v_accvgpr_write_b32 a215, 0
    v_accvgpr_write_b32 a216, 0
    v_accvgpr_write_b32 a217, 0
    v_accvgpr_write_b32 a218, 0
    v_accvgpr_write_b32 a219, 0
    v_accvgpr_write_b32 a220, 0
    v_accvgpr_write_b32 a221, 0
    v_accvgpr_write_b32 a222, 0
    v_accvgpr_write_b32 a223, 0
    v_accvgpr_write_b32 a224, 0
    v_accvgpr_write_b32 a225, 0
    v_accvgpr_write_b32 a226, 0
    v_accvgpr_write_b32 a227, 0
    v_accvgpr_write_b32 a228, 0
    v_accvgpr_write_b32 a229, 0
    v_accvgpr_write_b32 a230, 0
    v_accvgpr_write_b32 a231, 0
    v_accvgpr_write_b32 a232, 0
    v_accvgpr_write_b32 a233, 0
    v_accvgpr_write_b32 a234, 0
    v_accvgpr_write_b32 a235, 0
    v_accvgpr_write_b32 a236, 0
    v_accvgpr_write_b32 a237, 0
    v_accvgpr_write_b32 a238, 0
    v_accvgpr_write_b32 a239, 0
    v_accvgpr_write_b32 a240, 0
    v_accvgpr_write_b32 a241, 0
    v_accvgpr_write_b32 a242, 0
    v_accvgpr_write_b32 a243, 0
    v_accvgpr_write_b32 a244, 0
    v_accvgpr_write_b32 a245, 0
    v_accvgpr_write_b32 a246, 0
    v_accvgpr_write_b32 a247, 0
    v_accvgpr_write_b32 a248, 0
    v_accvgpr_write_b32 a249, 0
    v_accvgpr_write_b32 a250, 0
    v_accvgpr_write_b32 a251, 0
    v_accvgpr_write_b32 a252, 0
    v_accvgpr_write_b32 a253, 0
    v_accvgpr_write_b32 a254, 0
    v_accvgpr_write_b32 a255, 0
    v_lshrrev_b32 v24, 5, v0
    v_lshlrev_b32 v24, 5, v24
    s_mul_i32 s3, s41, 896
    s_add_u32 s3, s3, s58
    v_add_u32 v24, s3, v24
    v_add_u32 v25, s43, v21
    s_waitcnt vmcnt(32)
    ds_read_b128 v[216:219], v24 offset:0
    ds_read_b128 v[224:227], v24 offset:1792
    ds_read_b128 v[220:223], v24 offset:16
    ds_read_b128 v[228:231], v24 offset:1808
    ds_read_b128 v[232:235], v24 offset:64
    ds_read_b128 v[240:243], v24 offset:1856
    ds_read_b128 v[236:239], v24 offset:80
    ds_read_b128 v[244:247], v24 offset:1872
    v_lshlrev_b32 v8, 16, v160
    v_and_b32 v9, 0xffff0000, v160
    v_lshlrev_b32 v10, 16, v161
    v_and_b32 v11, 0xffff0000, v161
    v_lshlrev_b32 v12, 16, v162
    v_and_b32 v13, 0xffff0000, v162
    v_lshlrev_b32 v14, 16, v163
    v_and_b32 v15, 0xffff0000, v163
    s_waitcnt lgkmcnt(4)
    v_pk_mul_f32 v[8:9], v[8:9], v[224:225]
    v_pk_mul_f32 v[10:11], v[10:11], v[226:227]
    v_pk_mul_f32 v[12:13], v[12:13], v[228:229]
    v_pk_mul_f32 v[14:15], v[14:15], v[230:231]
    v_cvt_pk_bf16_f32 v8, 0, v8
    v_cvt_pk_bf16_f32 v9, 0, v9
    v_cvt_pk_bf16_f32 v10, 0, v10
    v_cvt_pk_bf16_f32 v11, 0, v11
    v_cvt_pk_bf16_f32 v12, 0, v12
    v_cvt_pk_bf16_f32 v13, 0, v13
    v_cvt_pk_bf16_f32 v14, 0, v14
    v_cvt_pk_bf16_f32 v15, 0, v15
    v_pk_add_f32 v[8:9], v[8:9], v[216:217]
    v_pk_add_f32 v[10:11], v[10:11], v[218:219]
    v_pk_add_f32 v[12:13], v[12:13], v[220:221]
    v_pk_add_f32 v[14:15], v[14:15], v[222:223]
    v_cvt_pk_bf16_f32 v160, v8, v9
    v_cvt_pk_bf16_f32 v161, v10, v11
    v_cvt_pk_bf16_f32 v162, v12, v13
    v_cvt_pk_bf16_f32 v163, v14, v15
    ds_write_b128 v25, v[160:163] offset:0
    ds_read_b128 v[216:219], v24 offset:128
    ds_read_b128 v[224:227], v24 offset:1920
    ds_read_b128 v[220:223], v24 offset:144
    ds_read_b128 v[228:231], v24 offset:1936
    v_lshlrev_b32 v248, 16, v164
    v_and_b32 v249, 0xffff0000, v164
    v_lshlrev_b32 v250, 16, v165
    v_and_b32 v251, 0xffff0000, v165
    v_lshlrev_b32 v252, 16, v166
    v_and_b32 v253, 0xffff0000, v166
    v_lshlrev_b32 v254, 16, v167
    v_and_b32 v255, 0xffff0000, v167
    s_waitcnt lgkmcnt(4)
    v_pk_mul_f32 v[248:249], v[248:249], v[240:241]
    v_pk_mul_f32 v[250:251], v[250:251], v[242:243]
    v_pk_mul_f32 v[252:253], v[252:253], v[244:245]
    v_pk_mul_f32 v[254:255], v[254:255], v[246:247]
    v_cvt_pk_bf16_f32 v248, 0, v248
    v_cvt_pk_bf16_f32 v249, 0, v249
    v_cvt_pk_bf16_f32 v250, 0, v250
    v_cvt_pk_bf16_f32 v251, 0, v251
    v_cvt_pk_bf16_f32 v252, 0, v252
    v_cvt_pk_bf16_f32 v253, 0, v253
    v_cvt_pk_bf16_f32 v254, 0, v254
    v_cvt_pk_bf16_f32 v255, 0, v255
    v_pk_add_f32 v[248:249], v[248:249], v[232:233]
    v_pk_add_f32 v[250:251], v[250:251], v[234:235]
    v_pk_add_f32 v[252:253], v[252:253], v[236:237]
    v_pk_add_f32 v[254:255], v[254:255], v[238:239]
    v_cvt_pk_bf16_f32 v164, v248, v249
    v_cvt_pk_bf16_f32 v165, v250, v251
    v_cvt_pk_bf16_f32 v166, v252, v253
    v_cvt_pk_bf16_f32 v167, v254, v255
    ds_write_b128 v25, v[164:167] offset:1024
    ds_read_b128 v[232:235], v24 offset:192
    ds_read_b128 v[240:243], v24 offset:1984
    ds_read_b128 v[236:239], v24 offset:208
    ds_read_b128 v[244:247], v24 offset:2000
    v_lshlrev_b32 v8, 16, v168
    v_and_b32 v9, 0xffff0000, v168
    v_lshlrev_b32 v10, 16, v169
    v_and_b32 v11, 0xffff0000, v169
    v_lshlrev_b32 v12, 16, v170
    v_and_b32 v13, 0xffff0000, v170
    v_lshlrev_b32 v14, 16, v171
    v_and_b32 v15, 0xffff0000, v171
    s_waitcnt lgkmcnt(4)
    v_pk_mul_f32 v[8:9], v[8:9], v[224:225]
    v_pk_mul_f32 v[10:11], v[10:11], v[226:227]
    v_pk_mul_f32 v[12:13], v[12:13], v[228:229]
    v_pk_mul_f32 v[14:15], v[14:15], v[230:231]
    v_cvt_pk_bf16_f32 v8, 0, v8
    v_cvt_pk_bf16_f32 v9, 0, v9
    v_cvt_pk_bf16_f32 v10, 0, v10
    v_cvt_pk_bf16_f32 v11, 0, v11
    v_cvt_pk_bf16_f32 v12, 0, v12
    v_cvt_pk_bf16_f32 v13, 0, v13
    v_cvt_pk_bf16_f32 v14, 0, v14
    v_cvt_pk_bf16_f32 v15, 0, v15
    v_pk_add_f32 v[8:9], v[8:9], v[216:217]
    v_pk_add_f32 v[10:11], v[10:11], v[218:219]
    v_pk_add_f32 v[12:13], v[12:13], v[220:221]
    v_pk_add_f32 v[14:15], v[14:15], v[222:223]
    v_cvt_pk_bf16_f32 v168, v8, v9
    v_cvt_pk_bf16_f32 v169, v10, v11
    v_cvt_pk_bf16_f32 v170, v12, v13
    v_cvt_pk_bf16_f32 v171, v14, v15
    ds_write_b128 v25, v[168:171] offset:2048
    ds_read_b128 v[216:219], v24 offset:256
    ds_read_b128 v[224:227], v24 offset:2048
    ds_read_b128 v[220:223], v24 offset:272
    ds_read_b128 v[228:231], v24 offset:2064
    v_lshlrev_b32 v248, 16, v172
    v_and_b32 v249, 0xffff0000, v172
    v_lshlrev_b32 v250, 16, v173
    v_and_b32 v251, 0xffff0000, v173
    v_lshlrev_b32 v252, 16, v174
    v_and_b32 v253, 0xffff0000, v174
    v_lshlrev_b32 v254, 16, v175
    v_and_b32 v255, 0xffff0000, v175
    s_waitcnt lgkmcnt(4)
    v_pk_mul_f32 v[248:249], v[248:249], v[240:241]
    v_pk_mul_f32 v[250:251], v[250:251], v[242:243]
    v_pk_mul_f32 v[252:253], v[252:253], v[244:245]
    v_pk_mul_f32 v[254:255], v[254:255], v[246:247]
    v_cvt_pk_bf16_f32 v248, 0, v248
    v_cvt_pk_bf16_f32 v249, 0, v249
    v_cvt_pk_bf16_f32 v250, 0, v250
    v_cvt_pk_bf16_f32 v251, 0, v251
    v_cvt_pk_bf16_f32 v252, 0, v252
    v_cvt_pk_bf16_f32 v253, 0, v253
    v_cvt_pk_bf16_f32 v254, 0, v254
    v_cvt_pk_bf16_f32 v255, 0, v255
    v_pk_add_f32 v[248:249], v[248:249], v[232:233]
    v_pk_add_f32 v[250:251], v[250:251], v[234:235]
    v_pk_add_f32 v[252:253], v[252:253], v[236:237]
    v_pk_add_f32 v[254:255], v[254:255], v[238:239]
    v_cvt_pk_bf16_f32 v172, v248, v249
    v_cvt_pk_bf16_f32 v173, v250, v251
    v_cvt_pk_bf16_f32 v174, v252, v253
    v_cvt_pk_bf16_f32 v175, v254, v255
    ds_write_b128 v25, v[172:175] offset:3072
    ds_read_b128 v[232:235], v24 offset:320
    ds_read_b128 v[240:243], v24 offset:2112
    ds_read_b128 v[236:239], v24 offset:336
    ds_read_b128 v[244:247], v24 offset:2128
    v_lshlrev_b32 v8, 16, v176
    v_and_b32 v9, 0xffff0000, v176
    v_lshlrev_b32 v10, 16, v177
    v_and_b32 v11, 0xffff0000, v177
    v_lshlrev_b32 v12, 16, v178
    v_and_b32 v13, 0xffff0000, v178
    v_lshlrev_b32 v14, 16, v179
    v_and_b32 v15, 0xffff0000, v179
    s_waitcnt lgkmcnt(4)
    v_pk_mul_f32 v[8:9], v[8:9], v[224:225]
    v_pk_mul_f32 v[10:11], v[10:11], v[226:227]
    v_pk_mul_f32 v[12:13], v[12:13], v[228:229]
    v_pk_mul_f32 v[14:15], v[14:15], v[230:231]
    v_cvt_pk_bf16_f32 v8, 0, v8
    v_cvt_pk_bf16_f32 v9, 0, v9
    v_cvt_pk_bf16_f32 v10, 0, v10
    v_cvt_pk_bf16_f32 v11, 0, v11
    v_cvt_pk_bf16_f32 v12, 0, v12
    v_cvt_pk_bf16_f32 v13, 0, v13
    v_cvt_pk_bf16_f32 v14, 0, v14
    v_cvt_pk_bf16_f32 v15, 0, v15
    v_pk_add_f32 v[8:9], v[8:9], v[216:217]
    v_pk_add_f32 v[10:11], v[10:11], v[218:219]
    v_pk_add_f32 v[12:13], v[12:13], v[220:221]
    v_pk_add_f32 v[14:15], v[14:15], v[222:223]
    v_cvt_pk_bf16_f32 v176, v8, v9
    v_cvt_pk_bf16_f32 v177, v10, v11
    v_cvt_pk_bf16_f32 v178, v12, v13
    v_cvt_pk_bf16_f32 v179, v14, v15
    ds_write_b128 v25, v[176:179] offset:4096
    ds_read_b128 v[216:219], v24 offset:384
    ds_read_b128 v[224:227], v24 offset:2176
    ds_read_b128 v[220:223], v24 offset:400
    ds_read_b128 v[228:231], v24 offset:2192
    v_lshlrev_b32 v248, 16, v180
    v_and_b32 v249, 0xffff0000, v180
    v_lshlrev_b32 v250, 16, v181
    v_and_b32 v251, 0xffff0000, v181
    v_lshlrev_b32 v252, 16, v182
    v_and_b32 v253, 0xffff0000, v182
    v_lshlrev_b32 v254, 16, v183
    v_and_b32 v255, 0xffff0000, v183
    s_waitcnt lgkmcnt(4)
    v_pk_mul_f32 v[248:249], v[248:249], v[240:241]
    v_pk_mul_f32 v[250:251], v[250:251], v[242:243]
    v_pk_mul_f32 v[252:253], v[252:253], v[244:245]
    v_pk_mul_f32 v[254:255], v[254:255], v[246:247]
    v_cvt_pk_bf16_f32 v248, 0, v248
    v_cvt_pk_bf16_f32 v249, 0, v249
    v_cvt_pk_bf16_f32 v250, 0, v250
    v_cvt_pk_bf16_f32 v251, 0, v251
    v_cvt_pk_bf16_f32 v252, 0, v252
    v_cvt_pk_bf16_f32 v253, 0, v253
    v_cvt_pk_bf16_f32 v254, 0, v254
    v_cvt_pk_bf16_f32 v255, 0, v255
    v_pk_add_f32 v[248:249], v[248:249], v[232:233]
    v_pk_add_f32 v[250:251], v[250:251], v[234:235]
    v_pk_add_f32 v[252:253], v[252:253], v[236:237]
    v_pk_add_f32 v[254:255], v[254:255], v[238:239]
    v_cvt_pk_bf16_f32 v180, v248, v249
    v_cvt_pk_bf16_f32 v181, v250, v251
    v_cvt_pk_bf16_f32 v182, v252, v253
    v_cvt_pk_bf16_f32 v183, v254, v255
    ds_write_b128 v25, v[180:183] offset:5120
    ds_read_b128 v[232:235], v24 offset:448
    ds_read_b128 v[240:243], v24 offset:2240
    ds_read_b128 v[236:239], v24 offset:464
    ds_read_b128 v[244:247], v24 offset:2256
    v_lshlrev_b32 v8, 16, v184
    v_and_b32 v9, 0xffff0000, v184
    v_lshlrev_b32 v10, 16, v185
    v_and_b32 v11, 0xffff0000, v185
    v_lshlrev_b32 v12, 16, v186
    v_and_b32 v13, 0xffff0000, v186
    v_lshlrev_b32 v14, 16, v187
    v_and_b32 v15, 0xffff0000, v187
    s_waitcnt lgkmcnt(4)
    v_pk_mul_f32 v[8:9], v[8:9], v[224:225]
    v_pk_mul_f32 v[10:11], v[10:11], v[226:227]
    v_pk_mul_f32 v[12:13], v[12:13], v[228:229]
    v_pk_mul_f32 v[14:15], v[14:15], v[230:231]
    v_cvt_pk_bf16_f32 v8, 0, v8
    v_cvt_pk_bf16_f32 v9, 0, v9
    v_cvt_pk_bf16_f32 v10, 0, v10
    v_cvt_pk_bf16_f32 v11, 0, v11
    v_cvt_pk_bf16_f32 v12, 0, v12
    v_cvt_pk_bf16_f32 v13, 0, v13
    v_cvt_pk_bf16_f32 v14, 0, v14
    v_cvt_pk_bf16_f32 v15, 0, v15
    v_pk_add_f32 v[8:9], v[8:9], v[216:217]
    v_pk_add_f32 v[10:11], v[10:11], v[218:219]
    v_pk_add_f32 v[12:13], v[12:13], v[220:221]
    v_pk_add_f32 v[14:15], v[14:15], v[222:223]
    v_cvt_pk_bf16_f32 v184, v8, v9
    v_cvt_pk_bf16_f32 v185, v10, v11
    v_cvt_pk_bf16_f32 v186, v12, v13
    v_cvt_pk_bf16_f32 v187, v14, v15
    ds_write_b128 v25, v[184:187] offset:6144
    ds_read_b128 v[216:219], v24 offset:512
    ds_read_b128 v[224:227], v24 offset:2304
    ds_read_b128 v[220:223], v24 offset:528
    ds_read_b128 v[228:231], v24 offset:2320
    v_lshlrev_b32 v248, 16, v188
    v_and_b32 v249, 0xffff0000, v188
    v_lshlrev_b32 v250, 16, v189
    v_and_b32 v251, 0xffff0000, v189
    v_lshlrev_b32 v252, 16, v190
    v_and_b32 v253, 0xffff0000, v190
    v_lshlrev_b32 v254, 16, v191
    v_and_b32 v255, 0xffff0000, v191
    s_waitcnt lgkmcnt(4)
    v_pk_mul_f32 v[248:249], v[248:249], v[240:241]
    v_pk_mul_f32 v[250:251], v[250:251], v[242:243]
    v_pk_mul_f32 v[252:253], v[252:253], v[244:245]
    v_pk_mul_f32 v[254:255], v[254:255], v[246:247]
    v_cvt_pk_bf16_f32 v248, 0, v248
    v_cvt_pk_bf16_f32 v249, 0, v249
    v_cvt_pk_bf16_f32 v250, 0, v250
    v_cvt_pk_bf16_f32 v251, 0, v251
    v_cvt_pk_bf16_f32 v252, 0, v252
    v_cvt_pk_bf16_f32 v253, 0, v253
    v_cvt_pk_bf16_f32 v254, 0, v254
    v_cvt_pk_bf16_f32 v255, 0, v255
    v_pk_add_f32 v[248:249], v[248:249], v[232:233]
    v_pk_add_f32 v[250:251], v[250:251], v[234:235]
    v_pk_add_f32 v[252:253], v[252:253], v[236:237]
    v_pk_add_f32 v[254:255], v[254:255], v[238:239]
    v_cvt_pk_bf16_f32 v188, v248, v249
    v_cvt_pk_bf16_f32 v189, v250, v251
    v_cvt_pk_bf16_f32 v190, v252, v253
    v_cvt_pk_bf16_f32 v191, v254, v255
    ds_write_b128 v25, v[188:191] offset:7168
    ds_read_b128 v[232:235], v24 offset:576
    ds_read_b128 v[240:243], v24 offset:2368
    ds_read_b128 v[236:239], v24 offset:592
    ds_read_b128 v[244:247], v24 offset:2384
    v_lshlrev_b32 v8, 16, v192
    v_and_b32 v9, 0xffff0000, v192
    v_lshlrev_b32 v10, 16, v193
    v_and_b32 v11, 0xffff0000, v193
    v_lshlrev_b32 v12, 16, v194
    v_and_b32 v13, 0xffff0000, v194
    v_lshlrev_b32 v14, 16, v195
    v_and_b32 v15, 0xffff0000, v195
    s_waitcnt lgkmcnt(4)
    v_pk_mul_f32 v[8:9], v[8:9], v[224:225]
    v_pk_mul_f32 v[10:11], v[10:11], v[226:227]
    v_pk_mul_f32 v[12:13], v[12:13], v[228:229]
    v_pk_mul_f32 v[14:15], v[14:15], v[230:231]
    v_cvt_pk_bf16_f32 v8, 0, v8
    v_cvt_pk_bf16_f32 v9, 0, v9
    v_cvt_pk_bf16_f32 v10, 0, v10
    v_cvt_pk_bf16_f32 v11, 0, v11
    v_cvt_pk_bf16_f32 v12, 0, v12
    v_cvt_pk_bf16_f32 v13, 0, v13
    v_cvt_pk_bf16_f32 v14, 0, v14
    v_cvt_pk_bf16_f32 v15, 0, v15
    v_pk_add_f32 v[8:9], v[8:9], v[216:217]
    v_pk_add_f32 v[10:11], v[10:11], v[218:219]
    v_pk_add_f32 v[12:13], v[12:13], v[220:221]
    v_pk_add_f32 v[14:15], v[14:15], v[222:223]
    v_cvt_pk_bf16_f32 v192, v8, v9
    v_cvt_pk_bf16_f32 v193, v10, v11
    v_cvt_pk_bf16_f32 v194, v12, v13
    v_cvt_pk_bf16_f32 v195, v14, v15
    ds_write_b128 v25, v[192:195] offset:8192
    ds_read_b128 v[216:219], v24 offset:640
    ds_read_b128 v[224:227], v24 offset:2432
    ds_read_b128 v[220:223], v24 offset:656
    ds_read_b128 v[228:231], v24 offset:2448
    v_lshlrev_b32 v248, 16, v196
    v_and_b32 v249, 0xffff0000, v196
    v_lshlrev_b32 v250, 16, v197
    v_and_b32 v251, 0xffff0000, v197
    v_lshlrev_b32 v252, 16, v198
    v_and_b32 v253, 0xffff0000, v198
    v_lshlrev_b32 v254, 16, v199
    v_and_b32 v255, 0xffff0000, v199
    s_waitcnt lgkmcnt(4)
    v_pk_mul_f32 v[248:249], v[248:249], v[240:241]
    v_pk_mul_f32 v[250:251], v[250:251], v[242:243]
    v_pk_mul_f32 v[252:253], v[252:253], v[244:245]
    v_pk_mul_f32 v[254:255], v[254:255], v[246:247]
    v_cvt_pk_bf16_f32 v248, 0, v248
    v_cvt_pk_bf16_f32 v249, 0, v249
    v_cvt_pk_bf16_f32 v250, 0, v250
    v_cvt_pk_bf16_f32 v251, 0, v251
    v_cvt_pk_bf16_f32 v252, 0, v252
    v_cvt_pk_bf16_f32 v253, 0, v253
    v_cvt_pk_bf16_f32 v254, 0, v254
    v_cvt_pk_bf16_f32 v255, 0, v255
    v_pk_add_f32 v[248:249], v[248:249], v[232:233]
    v_pk_add_f32 v[250:251], v[250:251], v[234:235]
    v_pk_add_f32 v[252:253], v[252:253], v[236:237]
    v_pk_add_f32 v[254:255], v[254:255], v[238:239]
    v_cvt_pk_bf16_f32 v196, v248, v249
    v_cvt_pk_bf16_f32 v197, v250, v251
    v_cvt_pk_bf16_f32 v198, v252, v253
    v_cvt_pk_bf16_f32 v199, v254, v255
    ds_write_b128 v25, v[196:199] offset:9216
    ds_read_b128 v[232:235], v24 offset:704
    ds_read_b128 v[240:243], v24 offset:2496
    ds_read_b128 v[236:239], v24 offset:720
    ds_read_b128 v[244:247], v24 offset:2512
    v_lshlrev_b32 v8, 16, v200
    v_and_b32 v9, 0xffff0000, v200
    v_lshlrev_b32 v10, 16, v201
    v_and_b32 v11, 0xffff0000, v201
    v_lshlrev_b32 v12, 16, v202
    v_and_b32 v13, 0xffff0000, v202
    v_lshlrev_b32 v14, 16, v203
    v_and_b32 v15, 0xffff0000, v203
    s_waitcnt lgkmcnt(4)
    v_pk_mul_f32 v[8:9], v[8:9], v[224:225]
    v_pk_mul_f32 v[10:11], v[10:11], v[226:227]
    v_pk_mul_f32 v[12:13], v[12:13], v[228:229]
    v_pk_mul_f32 v[14:15], v[14:15], v[230:231]
    v_cvt_pk_bf16_f32 v8, 0, v8
    v_cvt_pk_bf16_f32 v9, 0, v9
    v_cvt_pk_bf16_f32 v10, 0, v10
    v_cvt_pk_bf16_f32 v11, 0, v11
    v_cvt_pk_bf16_f32 v12, 0, v12
    v_cvt_pk_bf16_f32 v13, 0, v13
    v_cvt_pk_bf16_f32 v14, 0, v14
    v_cvt_pk_bf16_f32 v15, 0, v15
    v_pk_add_f32 v[8:9], v[8:9], v[216:217]
    v_pk_add_f32 v[10:11], v[10:11], v[218:219]
    v_pk_add_f32 v[12:13], v[12:13], v[220:221]
    v_pk_add_f32 v[14:15], v[14:15], v[222:223]
    v_cvt_pk_bf16_f32 v200, v8, v9
    v_cvt_pk_bf16_f32 v201, v10, v11
    v_cvt_pk_bf16_f32 v202, v12, v13
    v_cvt_pk_bf16_f32 v203, v14, v15
    ds_write_b128 v25, v[200:203] offset:10240
    ds_read_b128 v[216:219], v24 offset:768
    ds_read_b128 v[224:227], v24 offset:2560
    ds_read_b128 v[220:223], v24 offset:784
    ds_read_b128 v[228:231], v24 offset:2576
    v_lshlrev_b32 v248, 16, v204
    v_and_b32 v249, 0xffff0000, v204
    v_lshlrev_b32 v250, 16, v205
    v_and_b32 v251, 0xffff0000, v205
    v_lshlrev_b32 v252, 16, v206
    v_and_b32 v253, 0xffff0000, v206
    v_lshlrev_b32 v254, 16, v207
    v_and_b32 v255, 0xffff0000, v207
    s_waitcnt lgkmcnt(4)
    v_pk_mul_f32 v[248:249], v[248:249], v[240:241]
    v_pk_mul_f32 v[250:251], v[250:251], v[242:243]
    v_pk_mul_f32 v[252:253], v[252:253], v[244:245]
    v_pk_mul_f32 v[254:255], v[254:255], v[246:247]
    v_cvt_pk_bf16_f32 v248, 0, v248
    v_cvt_pk_bf16_f32 v249, 0, v249
    v_cvt_pk_bf16_f32 v250, 0, v250
    v_cvt_pk_bf16_f32 v251, 0, v251
    v_cvt_pk_bf16_f32 v252, 0, v252
    v_cvt_pk_bf16_f32 v253, 0, v253
    v_cvt_pk_bf16_f32 v254, 0, v254
    v_cvt_pk_bf16_f32 v255, 0, v255
    v_pk_add_f32 v[248:249], v[248:249], v[232:233]
    v_pk_add_f32 v[250:251], v[250:251], v[234:235]
    v_pk_add_f32 v[252:253], v[252:253], v[236:237]
    v_pk_add_f32 v[254:255], v[254:255], v[238:239]
    v_cvt_pk_bf16_f32 v204, v248, v249
    v_cvt_pk_bf16_f32 v205, v250, v251
    v_cvt_pk_bf16_f32 v206, v252, v253
    v_cvt_pk_bf16_f32 v207, v254, v255
    ds_write_b128 v25, v[204:207] offset:11264
    ds_read_b128 v[232:235], v24 offset:832
    ds_read_b128 v[240:243], v24 offset:2624
    ds_read_b128 v[236:239], v24 offset:848
    ds_read_b128 v[244:247], v24 offset:2640
    v_lshlrev_b32 v8, 16, v208
    v_and_b32 v9, 0xffff0000, v208
    v_lshlrev_b32 v10, 16, v209
    v_and_b32 v11, 0xffff0000, v209
    v_lshlrev_b32 v12, 16, v210
    v_and_b32 v13, 0xffff0000, v210
    v_lshlrev_b32 v14, 16, v211
    v_and_b32 v15, 0xffff0000, v211
    s_waitcnt lgkmcnt(4)
    v_pk_mul_f32 v[8:9], v[8:9], v[224:225]
    v_pk_mul_f32 v[10:11], v[10:11], v[226:227]
    v_pk_mul_f32 v[12:13], v[12:13], v[228:229]
    v_pk_mul_f32 v[14:15], v[14:15], v[230:231]
    v_cvt_pk_bf16_f32 v8, 0, v8
    v_cvt_pk_bf16_f32 v9, 0, v9
    v_cvt_pk_bf16_f32 v10, 0, v10
    v_cvt_pk_bf16_f32 v11, 0, v11
    v_cvt_pk_bf16_f32 v12, 0, v12
    v_cvt_pk_bf16_f32 v13, 0, v13
    v_cvt_pk_bf16_f32 v14, 0, v14
    v_cvt_pk_bf16_f32 v15, 0, v15
    v_pk_add_f32 v[8:9], v[8:9], v[216:217]
    v_pk_add_f32 v[10:11], v[10:11], v[218:219]
    v_pk_add_f32 v[12:13], v[12:13], v[220:221]
    v_pk_add_f32 v[14:15], v[14:15], v[222:223]
    v_cvt_pk_bf16_f32 v208, v8, v9
    v_cvt_pk_bf16_f32 v209, v10, v11
    v_cvt_pk_bf16_f32 v210, v12, v13
    v_cvt_pk_bf16_f32 v211, v14, v15
    ds_write_b128 v25, v[208:211] offset:12288
    v_lshlrev_b32 v248, 16, v212
    v_and_b32 v249, 0xffff0000, v212
    v_lshlrev_b32 v250, 16, v213
    v_and_b32 v251, 0xffff0000, v213
    v_lshlrev_b32 v252, 16, v214
    v_and_b32 v253, 0xffff0000, v214
    v_lshlrev_b32 v254, 16, v215
    v_and_b32 v255, 0xffff0000, v215
    s_waitcnt lgkmcnt(0)
    v_pk_mul_f32 v[248:249], v[248:249], v[240:241]
    v_pk_mul_f32 v[250:251], v[250:251], v[242:243]
    v_pk_mul_f32 v[252:253], v[252:253], v[244:245]
    v_pk_mul_f32 v[254:255], v[254:255], v[246:247]
    v_cvt_pk_bf16_f32 v248, 0, v248
    v_cvt_pk_bf16_f32 v249, 0, v249
    v_cvt_pk_bf16_f32 v250, 0, v250
    v_cvt_pk_bf16_f32 v251, 0, v251
    v_cvt_pk_bf16_f32 v252, 0, v252
    v_cvt_pk_bf16_f32 v253, 0, v253
    v_cvt_pk_bf16_f32 v254, 0, v254
    v_cvt_pk_bf16_f32 v255, 0, v255
    v_pk_add_f32 v[248:249], v[248:249], v[232:233]
    v_pk_add_f32 v[250:251], v[250:251], v[234:235]
    v_pk_add_f32 v[252:253], v[252:253], v[236:237]
    v_pk_add_f32 v[254:255], v[254:255], v[238:239]
    v_cvt_pk_bf16_f32 v212, v248, v249
    v_cvt_pk_bf16_f32 v213, v250, v251
    v_cvt_pk_bf16_f32 v214, v252, v253
    v_cvt_pk_bf16_f32 v215, v254, v255
    ds_write_b128 v25, v[212:215] offset:13312
    s_waitcnt lgkmcnt(0)
    s_barrier
    ds_read_b128 a[128:131], v21 offset:0
    ds_read_b128 a[132:135], v21 offset:28672
    ds_read_b128 a[136:139], v21 offset:1024
    ds_read_b128 a[140:143], v21 offset:29696
    ds_read_b128 a[144:147], v21 offset:2048
    ds_read_b128 a[148:151], v21 offset:30720
    s_add_u32 s3, s52, 8192
    buffer_load_dwordx4 v[160:163], v21, s[44:47], s3 offen offset:0
    s_add_u32 s3, s53, 8192
    buffer_load_dwordx4 v[164:167], v21, s[44:47], s3 offen offset:0
    s_add_u32 s3, s54, 8192
    buffer_load_dwordx4 v[168:171], v21, s[44:47], s3 offen offset:0
    s_add_u32 s3, s55, 8192
    buffer_load_dwordx4 v[172:175], v21, s[44:47], s3 offen offset:0
    s_waitcnt vmcnt(32) lgkmcnt(4)
    v_mfma_f32_32x32x16_bf16 a[0:15], v[32:35], a[128:131], 0
    v_mfma_f32_32x32x16_bf16 a[16:31], v[32:35], a[132:135], 0
    v_mfma_f32_32x32x16_bf16 a[32:47], v[36:39], a[128:131], 0
    v_mfma_f32_32x32x16_bf16 a[48:63], v[36:39], a[132:135], 0
    v_mfma_f32_32x32x16_bf16 a[64:79], v[40:43], a[128:131], 0
    v_mfma_f32_32x32x16_bf16 a[80:95], v[40:43], a[132:135], 0
    v_mfma_f32_32x32x16_bf16 a[96:111], v[44:47], a[128:131], 0
    v_mfma_f32_32x32x16_bf16 a[112:127], v[44:47], a[132:135], 0
    ds_read_b128 a[152:155], v21 offset:3072
    ds_read_b128 a[156:159], v21 offset:31744
    s_add_u32 s3, s52, 8192
    buffer_load_dwordx4 v[176:179], v21, s[44:47], s3 offen offset:1024
    s_add_u32 s3, s53, 8192
    buffer_load_dwordx4 v[180:183], v21, s[44:47], s3 offen offset:1024
    s_add_u32 s3, s54, 8192
    buffer_load_dwordx4 v[184:187], v21, s[44:47], s3 offen offset:1024
    s_add_u32 s3, s55, 8192
    buffer_load_dwordx4 v[188:191], v21, s[44:47], s3 offen offset:1024
    s_waitcnt vmcnt(32) lgkmcnt(4)
    v_mfma_f32_32x32x16_bf16 a[0:15], v[48:51], a[136:139], a[0:15]
    v_mfma_f32_32x32x16_bf16 a[16:31], v[48:51], a[140:143], a[16:31]
    v_mfma_f32_32x32x16_bf16 a[32:47], v[52:55], a[136:139], a[32:47]
    v_mfma_f32_32x32x16_bf16 a[48:63], v[52:55], a[140:143], a[48:63]
    v_mfma_f32_32x32x16_bf16 a[64:79], v[56:59], a[136:139], a[64:79]
    v_mfma_f32_32x32x16_bf16 a[80:95], v[56:59], a[140:143], a[80:95]
    v_mfma_f32_32x32x16_bf16 a[96:111], v[60:63], a[136:139], a[96:111]
    v_mfma_f32_32x32x16_bf16 a[112:127], v[60:63], a[140:143], a[112:127]
    ds_read_b128 a[128:131], v21 offset:4096
    ds_read_b128 a[132:135], v21 offset:32768
    s_add_u32 s3, s52, 8192
    buffer_load_dwordx4 v[192:195], v21, s[44:47], s3 offen offset:2048
    s_add_u32 s3, s53, 8192
    buffer_load_dwordx4 v[196:199], v21, s[44:47], s3 offen offset:2048
    s_add_u32 s3, s54, 8192
    buffer_load_dwordx4 v[200:203], v21, s[44:47], s3 offen offset:2048
    s_add_u32 s3, s55, 8192
    buffer_load_dwordx4 v[204:207], v21, s[44:47], s3 offen offset:2048
    s_waitcnt vmcnt(32) lgkmcnt(4)
    v_mfma_f32_32x32x16_bf16 a[0:15], v[64:67], a[144:147], a[0:15]
    v_mfma_f32_32x32x16_bf16 a[16:31], v[64:67], a[148:151], a[16:31]
    v_mfma_f32_32x32x16_bf16 a[32:47], v[68:71], a[144:147], a[32:47]
    v_mfma_f32_32x32x16_bf16 a[48:63], v[68:71], a[148:151], a[48:63]
    v_mfma_f32_32x32x16_bf16 a[64:79], v[72:75], a[144:147], a[64:79]
    v_mfma_f32_32x32x16_bf16 a[80:95], v[72:75], a[148:151], a[80:95]
    v_mfma_f32_32x32x16_bf16 a[96:111], v[76:79], a[144:147], a[96:111]
    v_mfma_f32_32x32x16_bf16 a[112:127], v[76:79], a[148:151], a[112:127]
    ds_read_b128 a[136:139], v21 offset:5120
    ds_read_b128 a[140:143], v21 offset:33792
    s_add_u32 s3, s52, 8192
    buffer_load_dwordx4 v[208:211], v21, s[44:47], s3 offen offset:3072
    s_add_u32 s3, s53, 8192
    buffer_load_dwordx4 v[212:215], v21, s[44:47], s3 offen offset:3072
    s_add_u32 s3, s54, 8192
    buffer_load_dwordx4 v[216:219], v21, s[44:47], s3 offen offset:3072
    s_add_u32 s3, s55, 8192
    buffer_load_dwordx4 v[220:223], v21, s[44:47], s3 offen offset:3072
    s_waitcnt vmcnt(32) lgkmcnt(4)
    v_mfma_f32_32x32x16_bf16 a[0:15], v[80:83], a[152:155], a[0:15]
    v_mfma_f32_32x32x16_bf16 a[16:31], v[80:83], a[156:159], a[16:31]
    v_mfma_f32_32x32x16_bf16 a[32:47], v[84:87], a[152:155], a[32:47]
    v_mfma_f32_32x32x16_bf16 a[48:63], v[84:87], a[156:159], a[48:63]
    v_mfma_f32_32x32x16_bf16 a[64:79], v[88:91], a[152:155], a[64:79]
    v_mfma_f32_32x32x16_bf16 a[80:95], v[88:91], a[156:159], a[80:95]
    v_mfma_f32_32x32x16_bf16 a[96:111], v[92:95], a[152:155], a[96:111]
    v_mfma_f32_32x32x16_bf16 a[112:127], v[92:95], a[156:159], a[112:127]
    ds_read_b128 a[144:147], v21 offset:6144
    ds_read_b128 a[148:151], v21 offset:34816
    s_add_u32 s3, s52, 12288
    buffer_load_dwordx4 v[224:227], v21, s[44:47], s3 offen offset:0
    s_add_u32 s3, s53, 12288
    buffer_load_dwordx4 v[228:231], v21, s[44:47], s3 offen offset:0
    s_add_u32 s3, s54, 12288
    buffer_load_dwordx4 v[232:235], v21, s[44:47], s3 offen offset:0
    s_add_u32 s3, s55, 12288
    buffer_load_dwordx4 v[236:239], v21, s[44:47], s3 offen offset:0
    s_waitcnt vmcnt(32) lgkmcnt(4)
    v_mfma_f32_32x32x16_bf16 a[0:15], v[96:99], a[128:131], a[0:15]
    v_mfma_f32_32x32x16_bf16 a[16:31], v[96:99], a[132:135], a[16:31]
    v_mfma_f32_32x32x16_bf16 a[32:47], v[100:103], a[128:131], a[32:47]
    v_mfma_f32_32x32x16_bf16 a[48:63], v[100:103], a[132:135], a[48:63]
    v_mfma_f32_32x32x16_bf16 a[64:79], v[104:107], a[128:131], a[64:79]
    v_mfma_f32_32x32x16_bf16 a[80:95], v[104:107], a[132:135], a[80:95]
    v_mfma_f32_32x32x16_bf16 a[96:111], v[108:111], a[128:131], a[96:111]
    v_mfma_f32_32x32x16_bf16 a[112:127], v[108:111], a[132:135], a[112:127]
    ds_read_b128 a[152:155], v21 offset:7168
    ds_read_b128 a[156:159], v21 offset:35840
    s_add_u32 s3, s52, 12288
    buffer_load_dwordx4 v[240:243], v21, s[44:47], s3 offen offset:1024
    s_add_u32 s3, s53, 12288
    buffer_load_dwordx4 v[244:247], v21, s[44:47], s3 offen offset:1024
    s_add_u32 s3, s54, 12288
    buffer_load_dwordx4 v[248:251], v21, s[44:47], s3 offen offset:1024
    s_add_u32 s3, s55, 12288
    buffer_load_dwordx4 v[252:255], v21, s[44:47], s3 offen offset:1024
    s_waitcnt vmcnt(32) lgkmcnt(4)
    v_mfma_f32_32x32x16_bf16 a[0:15], v[112:115], a[136:139], a[0:15]
    v_mfma_f32_32x32x16_bf16 a[16:31], v[112:115], a[140:143], a[16:31]
    v_mfma_f32_32x32x16_bf16 a[32:47], v[116:119], a[136:139], a[32:47]
    v_mfma_f32_32x32x16_bf16 a[48:63], v[116:119], a[140:143], a[48:63]
    v_mfma_f32_32x32x16_bf16 a[64:79], v[120:123], a[136:139], a[64:79]
    v_mfma_f32_32x32x16_bf16 a[80:95], v[120:123], a[140:143], a[80:95]
    v_mfma_f32_32x32x16_bf16 a[96:111], v[124:127], a[136:139], a[96:111]
    v_mfma_f32_32x32x16_bf16 a[112:127], v[124:127], a[140:143], a[112:127]
    ds_read_b128 a[128:131], v21 offset:8192
    ds_read_b128 a[132:135], v21 offset:36864
    s_add_u32 s3, s52, 12288
    buffer_load_dwordx4 v[32:35], v21, s[44:47], s3 offen offset:2048
    s_add_u32 s3, s53, 12288
    buffer_load_dwordx4 v[36:39], v21, s[44:47], s3 offen offset:2048
    s_add_u32 s3, s54, 12288
    buffer_load_dwordx4 v[40:43], v21, s[44:47], s3 offen offset:2048
    s_add_u32 s3, s55, 12288
    buffer_load_dwordx4 v[44:47], v21, s[44:47], s3 offen offset:2048
    s_add_u32 m0, s24, 0
    s_nop 0
    buffer_load_dwordx4 v4, s[8:11], s20 offen offset:0 lds
    s_waitcnt vmcnt(33) lgkmcnt(4)
    v_mfma_f32_32x32x16_bf16 a[0:15], v[128:131], a[144:147], a[0:15]
    v_mfma_f32_32x32x16_bf16 a[16:31], v[128:131], a[148:151], a[16:31]
    v_mfma_f32_32x32x16_bf16 a[32:47], v[132:135], a[144:147], a[32:47]
    v_mfma_f32_32x32x16_bf16 a[48:63], v[132:135], a[148:151], a[48:63]
    v_mfma_f32_32x32x16_bf16 a[64:79], v[136:139], a[144:147], a[64:79]
    v_mfma_f32_32x32x16_bf16 a[80:95], v[136:139], a[148:151], a[80:95]
    v_mfma_f32_32x32x16_bf16 a[96:111], v[140:143], a[144:147], a[96:111]
    v_mfma_f32_32x32x16_bf16 a[112:127], v[140:143], a[148:151], a[112:127]
    ds_read_b128 a[136:139], v21 offset:9216
    ds_read_b128 a[140:143], v21 offset:37888
    s_add_u32 s3, s52, 12288
    buffer_load_dwordx4 v[48:51], v21, s[44:47], s3 offen offset:3072
    s_add_u32 s3, s53, 12288
    buffer_load_dwordx4 v[52:55], v21, s[44:47], s3 offen offset:3072
    s_add_u32 s3, s54, 12288
    buffer_load_dwordx4 v[56:59], v21, s[44:47], s3 offen offset:3072
    s_add_u32 s3, s55, 12288
    buffer_load_dwordx4 v[60:63], v21, s[44:47], s3 offen offset:3072
    s_add_u32 m0, s24, 32
    s_nop 0
    buffer_load_dwordx4 v4, s[8:11], s20 offen offset:1024 lds
    s_waitcnt vmcnt(34) lgkmcnt(4)
    v_mfma_f32_32x32x16_bf16 a[0:15], v[144:147], a[152:155], a[0:15]
    v_mfma_f32_32x32x16_bf16 a[16:31], v[144:147], a[156:159], a[16:31]
    v_mfma_f32_32x32x16_bf16 a[32:47], v[148:151], a[152:155], a[32:47]
    v_mfma_f32_32x32x16_bf16 a[48:63], v[148:151], a[156:159], a[48:63]
    v_mfma_f32_32x32x16_bf16 a[64:79], v[152:155], a[152:155], a[64:79]
    v_mfma_f32_32x32x16_bf16 a[80:95], v[152:155], a[156:159], a[80:95]
    v_mfma_f32_32x32x16_bf16 a[96:111], v[156:159], a[152:155], a[96:111]
    v_mfma_f32_32x32x16_bf16 a[112:127], v[156:159], a[156:159], a[112:127]
    ds_read_b128 a[144:147], v21 offset:10240
    ds_read_b128 a[148:151], v21 offset:38912
    s_add_u32 s3, s52, 16384
    buffer_load_dwordx4 v[64:67], v21, s[44:47], s3 offen offset:0
    s_add_u32 s3, s53, 16384
    buffer_load_dwordx4 v[68:71], v21, s[44:47], s3 offen offset:0
    s_add_u32 s3, s54, 16384
    buffer_load_dwordx4 v[72:75], v21, s[44:47], s3 offen offset:0
    s_add_u32 s3, s55, 16384
    buffer_load_dwordx4 v[76:79], v21, s[44:47], s3 offen offset:0
    s_add_u32 m0, s24, 64
    s_nop 0
    buffer_load_dwordx4 v4, s[8:11], s20 offen offset:2048 lds
    s_waitcnt vmcnt(35) lgkmcnt(4)
    v_mfma_f32_32x32x16_bf16 a[0:15], v[160:163], a[128:131], a[0:15]
    v_mfma_f32_32x32x16_bf16 a[16:31], v[160:163], a[132:135], a[16:31]
    v_mfma_f32_32x32x16_bf16 a[32:47], v[164:167], a[128:131], a[32:47]
    v_mfma_f32_32x32x16_bf16 a[48:63], v[164:167], a[132:135], a[48:63]
    v_mfma_f32_32x32x16_bf16 a[64:79], v[168:171], a[128:131], a[64:79]
    v_mfma_f32_32x32x16_bf16 a[80:95], v[168:171], a[132:135], a[80:95]
    v_mfma_f32_32x32x16_bf16 a[96:111], v[172:175], a[128:131], a[96:111]
    v_mfma_f32_32x32x16_bf16 a[112:127], v[172:175], a[132:135], a[112:127]
    ds_read_b128 a[152:155], v21 offset:11264
    ds_read_b128 a[156:159], v21 offset:39936
    s_add_u32 s3, s52, 16384
    buffer_load_dwordx4 v[80:83], v21, s[44:47], s3 offen offset:1024
    s_add_u32 s3, s53, 16384
    buffer_load_dwordx4 v[84:87], v21, s[44:47], s3 offen offset:1024
    s_add_u32 s3, s54, 16384
    buffer_load_dwordx4 v[88:91], v21, s[44:47], s3 offen offset:1024
    s_add_u32 s3, s55, 16384
    buffer_load_dwordx4 v[92:95], v21, s[44:47], s3 offen offset:1024
    s_add_u32 m0, s24, 96
    s_nop 0
    buffer_load_dwordx4 v4, s[8:11], s20 offen offset:3072 lds
    s_waitcnt vmcnt(36) lgkmcnt(4)
    v_mfma_f32_32x32x16_bf16 a[0:15], v[176:179], a[136:139], a[0:15]
    v_mfma_f32_32x32x16_bf16 a[16:31], v[176:179], a[140:143], a[16:31]
    v_mfma_f32_32x32x16_bf16 a[32:47], v[180:183], a[136:139], a[32:47]
    v_mfma_f32_32x32x16_bf16 a[48:63], v[180:183], a[140:143], a[48:63]
    v_mfma_f32_32x32x16_bf16 a[64:79], v[184:187], a[136:139], a[64:79]
    v_mfma_f32_32x32x16_bf16 a[80:95], v[184:187], a[140:143], a[80:95]
    v_mfma_f32_32x32x16_bf16 a[96:111], v[188:191], a[136:139], a[96:111]
    v_mfma_f32_32x32x16_bf16 a[112:127], v[188:191], a[140:143], a[112:127]
    ds_read_b128 a[128:131], v21 offset:12288
    ds_read_b128 a[132:135], v21 offset:40960
    s_add_u32 s3, s52, 16384
    buffer_load_dwordx4 v[96:99], v21, s[44:47], s3 offen offset:2048
    s_add_u32 s3, s53, 16384
    buffer_load_dwordx4 v[100:103], v21, s[44:47], s3 offen offset:2048
    s_add_u32 s3, s54, 16384
    buffer_load_dwordx4 v[104:107], v21, s[44:47], s3 offen offset:2048
    s_add_u32 s3, s55, 16384
    buffer_load_dwordx4 v[108:111], v21, s[44:47], s3 offen offset:2048
    s_add_u32 m0, s24, 4224
    s_nop 0
    buffer_load_dwordx4 v4, s[8:11], s21 offen offset:0 lds
    s_waitcnt vmcnt(37) lgkmcnt(4)
    v_mfma_f32_32x32x16_bf16 a[0:15], v[192:195], a[144:147], a[0:15]
    v_mfma_f32_32x32x16_bf16 a[16:31], v[192:195], a[148:151], a[16:31]
    v_mfma_f32_32x32x16_bf16 a[32:47], v[196:199], a[144:147], a[32:47]
    v_mfma_f32_32x32x16_bf16 a[48:63], v[196:199], a[148:151], a[48:63]
    v_mfma_f32_32x32x16_bf16 a[64:79], v[200:203], a[144:147], a[64:79]
    v_mfma_f32_32x32x16_bf16 a[80:95], v[200:203], a[148:151], a[80:95]
    v_mfma_f32_32x32x16_bf16 a[96:111], v[204:207], a[144:147], a[96:111]
    v_mfma_f32_32x32x16_bf16 a[112:127], v[204:207], a[148:151], a[112:127]
    ds_read_b128 a[136:139], v21 offset:13312
    ds_read_b128 a[140:143], v21 offset:41984
    s_add_u32 s3, s52, 16384
    buffer_load_dwordx4 v[112:115], v21, s[44:47], s3 offen offset:3072
    s_add_u32 s3, s53, 16384
    buffer_load_dwordx4 v[116:119], v21, s[44:47], s3 offen offset:3072
    s_add_u32 s3, s54, 16384
    buffer_load_dwordx4 v[120:123], v21, s[44:47], s3 offen offset:3072
    s_add_u32 s3, s55, 16384
    buffer_load_dwordx4 v[124:127], v21, s[44:47], s3 offen offset:3072
    s_add_u32 m0, s24, 4256
    s_nop 0
    buffer_load_dwordx4 v4, s[8:11], s21 offen offset:1024 lds
    s_waitcnt vmcnt(38) lgkmcnt(4)
    v_mfma_f32_32x32x16_bf16 a[0:15], v[208:211], a[152:155], a[0:15]
    v_mfma_f32_32x32x16_bf16 a[16:31], v[208:211], a[156:159], a[16:31]
    v_mfma_f32_32x32x16_bf16 a[32:47], v[212:215], a[152:155], a[32:47]
    v_mfma_f32_32x32x16_bf16 a[48:63], v[212:215], a[156:159], a[48:63]
    v_mfma_f32_32x32x16_bf16 a[64:79], v[216:219], a[152:155], a[64:79]
    v_mfma_f32_32x32x16_bf16 a[80:95], v[216:219], a[156:159], a[80:95]
    v_mfma_f32_32x32x16_bf16 a[96:111], v[220:223], a[152:155], a[96:111]
    v_mfma_f32_32x32x16_bf16 a[112:127], v[220:223], a[156:159], a[112:127]
    ds_read_b128 a[144:147], v21 offset:14336
    ds_read_b128 a[148:151], v21 offset:43008
    s_add_u32 s3, s52, 20480
    buffer_load_dwordx4 v[128:131], v21, s[44:47], s3 offen offset:0
    s_add_u32 s3, s53, 20480
    buffer_load_dwordx4 v[132:135], v21, s[44:47], s3 offen offset:0
    s_add_u32 s3, s54, 20480
    buffer_load_dwordx4 v[136:139], v21, s[44:47], s3 offen offset:0
    s_add_u32 s3, s55, 20480
    buffer_load_dwordx4 v[140:143], v21, s[44:47], s3 offen offset:0
    s_add_u32 m0, s24, 4288
    s_nop 0
    buffer_load_dwordx4 v4, s[8:11], s21 offen offset:2048 lds
    s_waitcnt vmcnt(39) lgkmcnt(4)
    v_mfma_f32_32x32x16_bf16 a[0:15], v[224:227], a[128:131], a[0:15]
    v_mfma_f32_32x32x16_bf16 a[16:31], v[224:227], a[132:135], a[16:31]
    v_mfma_f32_32x32x16_bf16 a[32:47], v[228:231], a[128:131], a[32:47]
    v_mfma_f32_32x32x16_bf16 a[48:63], v[228:231], a[132:135], a[48:63]
    v_mfma_f32_32x32x16_bf16 a[64:79], v[232:235], a[128:131], a[64:79]
    v_mfma_f32_32x32x16_bf16 a[80:95], v[232:235], a[132:135], a[80:95]
    v_mfma_f32_32x32x16_bf16 a[96:111], v[236:239], a[128:131], a[96:111]
    v_mfma_f32_32x32x16_bf16 a[112:127], v[236:239], a[132:135], a[112:127]
    ds_read_b128 a[152:155], v21 offset:15360
    ds_read_b128 a[156:159], v21 offset:44032
    s_add_u32 s3, s52, 20480
    buffer_load_dwordx4 v[144:147], v21, s[44:47], s3 offen offset:1024
    s_add_u32 s3, s53, 20480
    buffer_load_dwordx4 v[148:151], v21, s[44:47], s3 offen offset:1024
    s_add_u32 s3, s54, 20480
    buffer_load_dwordx4 v[152:155], v21, s[44:47], s3 offen offset:1024
    s_add_u32 s3, s55, 20480
    buffer_load_dwordx4 v[156:159], v21, s[44:47], s3 offen offset:1024
    s_add_u32 m0, s24, 4320
    s_nop 0
    buffer_load_dwordx4 v4, s[8:11], s21 offen offset:3072 lds
    s_add_u32 s20, s20, 16384
    s_add_u32 s21, s21, 16384
    s_waitcnt vmcnt(40) lgkmcnt(4)
    v_mfma_f32_32x32x16_bf16 a[0:15], v[240:243], a[136:139], a[0:15]
    v_mfma_f32_32x32x16_bf16 a[16:31], v[240:243], a[140:143], a[16:31]
    v_mfma_f32_32x32x16_bf16 a[32:47], v[244:247], a[136:139], a[32:47]
    v_mfma_f32_32x32x16_bf16 a[48:63], v[244:247], a[140:143], a[48:63]
    v_mfma_f32_32x32x16_bf16 a[64:79], v[248:251], a[136:139], a[64:79]
    v_mfma_f32_32x32x16_bf16 a[80:95], v[248:251], a[140:143], a[80:95]
    v_mfma_f32_32x32x16_bf16 a[96:111], v[252:255], a[136:139], a[96:111]
    v_mfma_f32_32x32x16_bf16 a[112:127], v[252:255], a[140:143], a[112:127]
    ds_read_b128 a[128:131], v21 offset:16384
    ds_read_b128 a[132:135], v21 offset:45056
    s_add_u32 s3, s52, 20480
    buffer_load_dwordx4 v[160:163], v21, s[44:47], s3 offen offset:2048
    s_add_u32 s3, s53, 20480
    buffer_load_dwordx4 v[164:167], v21, s[44:47], s3 offen offset:2048
    s_add_u32 s3, s54, 20480
    buffer_load_dwordx4 v[168:171], v21, s[44:47], s3 offen offset:2048
    s_add_u32 s3, s55, 20480
    buffer_load_dwordx4 v[172:175], v21, s[44:47], s3 offen offset:2048
    s_add_u32 m0, s25, 0
    s_nop 0
    buffer_load_dwordx4 v4, s[8:11], s20 offen offset:0 lds
    s_waitcnt vmcnt(41) lgkmcnt(4)
    v_mfma_f32_32x32x16_bf16 a[0:15], v[32:35], a[144:147], a[0:15]
    v_mfma_f32_32x32x16_bf16 a[16:31], v[32:35], a[148:151], a[16:31]
    v_mfma_f32_32x32x16_bf16 a[32:47], v[36:39], a[144:147], a[32:47]
    v_mfma_f32_32x32x16_bf16 a[48:63], v[36:39], a[148:151], a[48:63]
    v_mfma_f32_32x32x16_bf16 a[64:79], v[40:43], a[144:147], a[64:79]
    v_mfma_f32_32x32x16_bf16 a[80:95], v[40:43], a[148:151], a[80:95]
    v_mfma_f32_32x32x16_bf16 a[96:111], v[44:47], a[144:147], a[96:111]
    v_mfma_f32_32x32x16_bf16 a[112:127], v[44:47], a[148:151], a[112:127]
    ds_read_b128 a[136:139], v21 offset:17408
    ds_read_b128 a[140:143], v21 offset:46080
    s_add_u32 s3, s52, 20480
    buffer_load_dwordx4 v[176:179], v21, s[44:47], s3 offen offset:3072
    s_add_u32 s3, s53, 20480
    buffer_load_dwordx4 v[180:183], v21, s[44:47], s3 offen offset:3072
    s_add_u32 s3, s54, 20480
    buffer_load_dwordx4 v[184:187], v21, s[44:47], s3 offen offset:3072
    s_add_u32 s3, s55, 20480
    buffer_load_dwordx4 v[188:191], v21, s[44:47], s3 offen offset:3072
    s_add_u32 m0, s25, 32
    s_nop 0
    buffer_load_dwordx4 v4, s[8:11], s20 offen offset:1024 lds
    s_waitcnt vmcnt(41) lgkmcnt(4)
    v_mfma_f32_32x32x16_bf16 a[0:15], v[48:51], a[152:155], a[0:15]
    v_mfma_f32_32x32x16_bf16 a[16:31], v[48:51], a[156:159], a[16:31]
    v_mfma_f32_32x32x16_bf16 a[32:47], v[52:55], a[152:155], a[32:47]
    v_mfma_f32_32x32x16_bf16 a[48:63], v[52:55], a[156:159], a[48:63]
    v_mfma_f32_32x32x16_bf16 a[64:79], v[56:59], a[152:155], a[64:79]
    v_mfma_f32_32x32x16_bf16 a[80:95], v[56:59], a[156:159], a[80:95]
    v_mfma_f32_32x32x16_bf16 a[96:111], v[60:63], a[152:155], a[96:111]
    v_mfma_f32_32x32x16_bf16 a[112:127], v[60:63], a[156:159], a[112:127]
    ds_read_b128 a[144:147], v21 offset:18432
    ds_read_b128 a[148:151], v21 offset:47104
    s_add_u32 s3, s52, 24576
    buffer_load_dwordx4 v[192:195], v21, s[44:47], s3 offen offset:0
    s_add_u32 s3, s53, 24576
    buffer_load_dwordx4 v[196:199], v21, s[44:47], s3 offen offset:0
    s_add_u32 s3, s54, 24576
    buffer_load_dwordx4 v[200:203], v21, s[44:47], s3 offen offset:0
    s_add_u32 s3, s55, 24576
    buffer_load_dwordx4 v[204:207], v21, s[44:47], s3 offen offset:0
    s_add_u32 m0, s25, 64
    s_nop 0
    buffer_load_dwordx4 v4, s[8:11], s20 offen offset:2048 lds
    s_waitcnt vmcnt(41) lgkmcnt(4)
    v_mfma_f32_32x32x16_bf16 a[0:15], v[64:67], a[128:131], a[0:15]
    v_mfma_f32_32x32x16_bf16 a[16:31], v[64:67], a[132:135], a[16:31]
    v_mfma_f32_32x32x16_bf16 a[32:47], v[68:71], a[128:131], a[32:47]
    v_mfma_f32_32x32x16_bf16 a[48:63], v[68:71], a[132:135], a[48:63]
    v_mfma_f32_32x32x16_bf16 a[64:79], v[72:75], a[128:131], a[64:79]
    v_mfma_f32_32x32x16_bf16 a[80:95], v[72:75], a[132:135], a[80:95]
    v_mfma_f32_32x32x16_bf16 a[96:111], v[76:79], a[128:131], a[96:111]
    v_mfma_f32_32x32x16_bf16 a[112:127], v[76:79], a[132:135], a[112:127]
    ds_read_b128 a[152:155], v21 offset:19456
    ds_read_b128 a[156:159], v21 offset:48128
    s_add_u32 s3, s52, 24576
    buffer_load_dwordx4 v[208:211], v21, s[44:47], s3 offen offset:1024
    s_add_u32 s3, s53, 24576
    buffer_load_dwordx4 v[212:215], v21, s[44:47], s3 offen offset:1024
    s_add_u32 s3, s54, 24576
    buffer_load_dwordx4 v[216:219], v21, s[44:47], s3 offen offset:1024
    s_add_u32 s3, s55, 24576
    buffer_load_dwordx4 v[220:223], v21, s[44:47], s3 offen offset:1024
    s_add_u32 m0, s25, 96
    s_nop 0
    buffer_load_dwordx4 v4, s[8:11], s20 offen offset:3072 lds
    s_waitcnt vmcnt(41) lgkmcnt(4)
    v_mfma_f32_32x32x16_bf16 a[0:15], v[80:83], a[136:139], a[0:15]
    v_mfma_f32_32x32x16_bf16 a[16:31], v[80:83], a[140:143], a[16:31]
    v_mfma_f32_32x32x16_bf16 a[32:47], v[84:87], a[136:139], a[32:47]
    v_mfma_f32_32x32x16_bf16 a[48:63], v[84:87], a[140:143], a[48:63]
    v_mfma_f32_32x32x16_bf16 a[64:79], v[88:91], a[136:139], a[64:79]
    v_mfma_f32_32x32x16_bf16 a[80:95], v[88:91], a[140:143], a[80:95]
    v_mfma_f32_32x32x16_bf16 a[96:111], v[92:95], a[136:139], a[96:111]
    v_mfma_f32_32x32x16_bf16 a[112:127], v[92:95], a[140:143], a[112:127]
    ds_read_b128 a[128:131], v21 offset:20480
    ds_read_b128 a[132:135], v21 offset:49152
    s_add_u32 s3, s52, 24576
    buffer_load_dwordx4 v[224:227], v21, s[44:47], s3 offen offset:2048
    s_add_u32 s3, s53, 24576
    buffer_load_dwordx4 v[228:231], v21, s[44:47], s3 offen offset:2048
    s_add_u32 s3, s54, 24576
    buffer_load_dwordx4 v[232:235], v21, s[44:47], s3 offen offset:2048
    s_add_u32 s3, s55, 24576
    buffer_load_dwordx4 v[236:239], v21, s[44:47], s3 offen offset:2048
    s_add_u32 m0, s25, 4224
    s_nop 0
    buffer_load_dwordx4 v4, s[8:11], s21 offen offset:0 lds
    s_waitcnt vmcnt(41) lgkmcnt(4)
    v_mfma_f32_32x32x16_bf16 a[0:15], v[96:99], a[144:147], a[0:15]
    v_mfma_f32_32x32x16_bf16 a[16:31], v[96:99], a[148:151], a[16:31]
    v_mfma_f32_32x32x16_bf16 a[32:47], v[100:103], a[144:147], a[32:47]
    v_mfma_f32_32x32x16_bf16 a[48:63], v[100:103], a[148:151], a[48:63]
    v_mfma_f32_32x32x16_bf16 a[64:79], v[104:107], a[144:147], a[64:79]
    v_mfma_f32_32x32x16_bf16 a[80:95], v[104:107], a[148:151], a[80:95]
    v_mfma_f32_32x32x16_bf16 a[96:111], v[108:111], a[144:147], a[96:111]
    v_mfma_f32_32x32x16_bf16 a[112:127], v[108:111], a[148:151], a[112:127]
    ds_read_b128 a[136:139], v21 offset:21504
    ds_read_b128 a[140:143], v21 offset:50176
    s_add_u32 s3, s52, 24576
    buffer_load_dwordx4 v[240:243], v21, s[44:47], s3 offen offset:3072
    s_add_u32 s3, s53, 24576
    buffer_load_dwordx4 v[244:247], v21, s[44:47], s3 offen offset:3072
    s_add_u32 s3, s54, 24576
    buffer_load_dwordx4 v[248:251], v21, s[44:47], s3 offen offset:3072
    s_add_u32 s3, s55, 24576
    buffer_load_dwordx4 v[252:255], v21, s[44:47], s3 offen offset:3072
    s_add_u32 m0, s25, 4256
    s_nop 0
    buffer_load_dwordx4 v4, s[8:11], s21 offen offset:1024 lds
    s_waitcnt vmcnt(41) lgkmcnt(4)
    v_mfma_f32_32x32x16_bf16 a[0:15], v[112:115], a[152:155], a[0:15]
    v_mfma_f32_32x32x16_bf16 a[16:31], v[112:115], a[156:159], a[16:31]
    v_mfma_f32_32x32x16_bf16 a[32:47], v[116:119], a[152:155], a[32:47]
    v_mfma_f32_32x32x16_bf16 a[48:63], v[116:119], a[156:159], a[48:63]
    v_mfma_f32_32x32x16_bf16 a[64:79], v[120:123], a[152:155], a[64:79]
    v_mfma_f32_32x32x16_bf16 a[80:95], v[120:123], a[156:159], a[80:95]
    v_mfma_f32_32x32x16_bf16 a[96:111], v[124:127], a[152:155], a[96:111]
    v_mfma_f32_32x32x16_bf16 a[112:127], v[124:127], a[156:159], a[112:127]
    ds_read_b128 a[144:147], v21 offset:22528
    ds_read_b128 a[148:151], v21 offset:51200
    s_add_u32 m0, s25, 4288
    s_nop 0
    buffer_load_dwordx4 v4, s[8:11], s21 offen offset:2048 lds
    s_waitcnt vmcnt(37) lgkmcnt(4)
    v_mfma_f32_32x32x16_bf16 a[0:15], v[128:131], a[128:131], a[0:15]
    v_mfma_f32_32x32x16_bf16 a[16:31], v[128:131], a[132:135], a[16:31]
    v_mfma_f32_32x32x16_bf16 a[32:47], v[132:135], a[128:131], a[32:47]
    v_mfma_f32_32x32x16_bf16 a[48:63], v[132:135], a[132:135], a[48:63]
    v_mfma_f32_32x32x16_bf16 a[64:79], v[136:139], a[128:131], a[64:79]
    v_mfma_f32_32x32x16_bf16 a[80:95], v[136:139], a[132:135], a[80:95]
    v_mfma_f32_32x32x16_bf16 a[96:111], v[140:143], a[128:131], a[96:111]
    v_mfma_f32_32x32x16_bf16 a[112:127], v[140:143], a[132:135], a[112:127]
    ds_read_b128 a[152:155], v21 offset:23552
    ds_read_b128 a[156:159], v21 offset:52224
    s_add_u32 m0, s25, 4320
    s_nop 0
    buffer_load_dwordx4 v4, s[8:11], s21 offen offset:3072 lds
    s_add_u32 s20, s20, 16384
    s_add_u32 s21, s21, 16384
    s_waitcnt vmcnt(33) lgkmcnt(4)
    v_mfma_f32_32x32x16_bf16 a[0:15], v[144:147], a[136:139], a[0:15]
    v_mfma_f32_32x32x16_bf16 a[16:31], v[144:147], a[140:143], a[16:31]
    v_mfma_f32_32x32x16_bf16 a[32:47], v[148:151], a[136:139], a[32:47]
    v_mfma_f32_32x32x16_bf16 a[48:63], v[148:151], a[140:143], a[48:63]
    v_mfma_f32_32x32x16_bf16 a[64:79], v[152:155], a[136:139], a[64:79]
    v_mfma_f32_32x32x16_bf16 a[80:95], v[152:155], a[140:143], a[80:95]
    v_mfma_f32_32x32x16_bf16 a[96:111], v[156:159], a[136:139], a[96:111]
    v_mfma_f32_32x32x16_bf16 a[112:127], v[156:159], a[140:143], a[112:127]
    ds_read_b128 a[128:131], v21 offset:24576
    ds_read_b128 a[132:135], v21 offset:53248
    s_waitcnt vmcnt(28) lgkmcnt(4)
    v_mfma_f32_32x32x16_bf16 a[0:15], v[160:163], a[144:147], a[0:15]
    v_mfma_f32_32x32x16_bf16 a[16:31], v[160:163], a[148:151], a[16:31]
    v_mfma_f32_32x32x16_bf16 a[32:47], v[164:167], a[144:147], a[32:47]
    v_mfma_f32_32x32x16_bf16 a[48:63], v[164:167], a[148:151], a[48:63]
    v_mfma_f32_32x32x16_bf16 a[64:79], v[168:171], a[144:147], a[64:79]
    v_mfma_f32_32x32x16_bf16 a[80:95], v[168:171], a[148:151], a[80:95]
    v_mfma_f32_32x32x16_bf16 a[96:111], v[172:175], a[144:147], a[96:111]
    v_mfma_f32_32x32x16_bf16 a[112:127], v[172:175], a[148:151], a[112:127]
    ds_read_b128 a[136:139], v21 offset:25600
    ds_read_b128 a[140:143], v21 offset:54272
    s_waitcnt vmcnt(23) lgkmcnt(4)
    v_mfma_f32_32x32x16_bf16 a[0:15], v[176:179], a[152:155], a[0:15]
    v_mfma_f32_32x32x16_bf16 a[16:31], v[176:179], a[156:159], a[16:31]
    v_mfma_f32_32x32x16_bf16 a[32:47], v[180:183], a[152:155], a[32:47]
    v_mfma_f32_32x32x16_bf16 a[48:63], v[180:183], a[156:159], a[48:63]
    v_mfma_f32_32x32x16_bf16 a[64:79], v[184:187], a[152:155], a[64:79]
    v_mfma_f32_32x32x16_bf16 a[80:95], v[184:187], a[156:159], a[80:95]
    v_mfma_f32_32x32x16_bf16 a[96:111], v[188:191], a[152:155], a[96:111]
    v_mfma_f32_32x32x16_bf16 a[112:127], v[188:191], a[156:159], a[112:127]
    ds_read_b128 a[144:147], v21 offset:26624
    ds_read_b128 a[148:151], v21 offset:55296
    s_waitcnt vmcnt(18) lgkmcnt(4)
    v_mfma_f32_32x32x16_bf16 a[0:15], v[192:195], a[128:131], a[0:15]
    v_mfma_f32_32x32x16_bf16 a[16:31], v[192:195], a[132:135], a[16:31]
    v_mfma_f32_32x32x16_bf16 a[32:47], v[196:199], a[128:131], a[32:47]
    v_mfma_f32_32x32x16_bf16 a[48:63], v[196:199], a[132:135], a[48:63]
    v_mfma_f32_32x32x16_bf16 a[64:79], v[200:203], a[128:131], a[64:79]
    v_mfma_f32_32x32x16_bf16 a[80:95], v[200:203], a[132:135], a[80:95]
    v_mfma_f32_32x32x16_bf16 a[96:111], v[204:207], a[128:131], a[96:111]
    v_mfma_f32_32x32x16_bf16 a[112:127], v[204:207], a[132:135], a[112:127]
    ds_read_b128 a[152:155], v21 offset:27648
    ds_read_b128 a[156:159], v21 offset:56320
    s_waitcnt vmcnt(13) lgkmcnt(4)
    v_mfma_f32_32x32x16_bf16 a[0:15], v[208:211], a[136:139], a[0:15]
    v_mfma_f32_32x32x16_bf16 a[16:31], v[208:211], a[140:143], a[16:31]
    v_mfma_f32_32x32x16_bf16 a[32:47], v[212:215], a[136:139], a[32:47]
    v_mfma_f32_32x32x16_bf16 a[48:63], v[212:215], a[140:143], a[48:63]
    v_mfma_f32_32x32x16_bf16 a[64:79], v[216:219], a[136:139], a[64:79]
    v_mfma_f32_32x32x16_bf16 a[80:95], v[216:219], a[140:143], a[80:95]
    v_mfma_f32_32x32x16_bf16 a[96:111], v[220:223], a[136:139], a[96:111]
    v_mfma_f32_32x32x16_bf16 a[112:127], v[220:223], a[140:143], a[112:127]
    s_waitcnt vmcnt(8) lgkmcnt(2)
    v_mfma_f32_32x32x16_bf16 a[0:15], v[224:227], a[144:147], a[0:15]
    v_mfma_f32_32x32x16_bf16 a[16:31], v[224:227], a[148:151], a[16:31]
    v_mfma_f32_32x32x16_bf16 a[32:47], v[228:231], a[144:147], a[32:47]
    v_mfma_f32_32x32x16_bf16 a[48:63], v[228:231], a[148:151], a[48:63]
    v_mfma_f32_32x32x16_bf16 a[64:79], v[232:235], a[144:147], a[64:79]
    v_mfma_f32_32x32x16_bf16 a[80:95], v[232:235], a[148:151], a[80:95]
    v_mfma_f32_32x32x16_bf16 a[96:111], v[236:239], a[144:147], a[96:111]
    v_mfma_f32_32x32x16_bf16 a[112:127], v[236:239], a[148:151], a[112:127]
    s_waitcnt vmcnt(3) lgkmcnt(0)
    v_mfma_f32_32x32x16_bf16 a[0:15], v[240:243], a[152:155], a[0:15]
    v_mfma_f32_32x32x16_bf16 a[16:31], v[240:243], a[156:159], a[16:31]
    v_mfma_f32_32x32x16_bf16 a[32:47], v[244:247], a[152:155], a[32:47]
    v_mfma_f32_32x32x16_bf16 a[48:63], v[244:247], a[156:159], a[48:63]
    v_mfma_f32_32x32x16_bf16 a[64:79], v[248:251], a[152:155], a[64:79]
    v_mfma_f32_32x32x16_bf16 a[80:95], v[248:251], a[156:159], a[80:95]
    v_mfma_f32_32x32x16_bf16 a[96:111], v[252:255], a[152:155], a[96:111]
    v_mfma_f32_32x32x16_bf16 a[112:127], v[252:255], a[156:159], a[112:127]
    s_barrier
    s_lshl_b32 s3, s40, 15
    v_add_u32 v25, s3, v21
    s_lshl_b32 s42, s41, 13
    s_add_u32 s3, s3, s42
    v_add_u32 v24, s3, v21
    s_nop 7
    v_accvgpr_read_b32 v32, a0
    v_accvgpr_read_b32 v33, a1
    v_accvgpr_read_b32 v34, a2
    v_accvgpr_read_b32 v35, a3
    v_accvgpr_read_b32 v36, a4
    v_accvgpr_read_b32 v37, a5
    v_accvgpr_read_b32 v38, a6
    v_accvgpr_read_b32 v39, a7
    v_accvgpr_read_b32 v40, a8
    v_accvgpr_read_b32 v41, a9
    v_accvgpr_read_b32 v42, a10
    v_accvgpr_read_b32 v43, a11
    v_accvgpr_read_b32 v44, a12
    v_accvgpr_read_b32 v45, a13
    v_accvgpr_read_b32 v46, a14
    v_accvgpr_read_b32 v47, a15
    v_cvt_pk_bf16_f32 v48, v32, v33
    v_cvt_pk_bf16_f32 v49, v34, v35
    v_cvt_pk_bf16_f32 v50, v36, v37
    v_cvt_pk_bf16_f32 v51, v38, v39
    v_cvt_pk_bf16_f32 v52, v40, v41
    v_cvt_pk_bf16_f32 v53, v42, v43
    v_cvt_pk_bf16_f32 v54, v44, v45
    v_cvt_pk_bf16_f32 v55, v46, v47
    ds_write_b128 v24, v[48:51] offset:0
    ds_write_b128 v24, v[52:55] offset:1024
    v_accvgpr_read_b32 v56, a16
    v_accvgpr_read_b32 v57, a17
    v_accvgpr_read_b32 v58, a18
    v_accvgpr_read_b32 v59, a19
    v_accvgpr_read_b32 v60, a20
    v_accvgpr_read_b32 v61, a21
    v_accvgpr_read_b32 v62, a22
    v_accvgpr_read_b32 v63, a23
    v_accvgpr_read_b32 v64, a24
    v_accvgpr_read_b32 v65, a25
    v_accvgpr_read_b32 v66, a26
    v_accvgpr_read_b32 v67, a27
    v_accvgpr_read_b32 v68, a28
    v_accvgpr_read_b32 v69, a29
    v_accvgpr_read_b32 v70, a30
    v_accvgpr_read_b32 v71, a31
    v_cvt_pk_bf16_f32 v72, v56, v57
    v_cvt_pk_bf16_f32 v73, v58, v59
    v_cvt_pk_bf16_f32 v74, v60, v61
    v_cvt_pk_bf16_f32 v75, v62, v63
    v_cvt_pk_bf16_f32 v76, v64, v65
    v_cvt_pk_bf16_f32 v77, v66, v67
    v_cvt_pk_bf16_f32 v78, v68, v69
    v_cvt_pk_bf16_f32 v79, v70, v71
    ds_write_b128 v24, v[72:75] offset:16384
    ds_write_b128 v24, v[76:79] offset:17408
    v_accvgpr_read_b32 v32, a32
    v_accvgpr_read_b32 v33, a33
    v_accvgpr_read_b32 v34, a34
    v_accvgpr_read_b32 v35, a35
    v_accvgpr_read_b32 v36, a36
    v_accvgpr_read_b32 v37, a37
    v_accvgpr_read_b32 v38, a38
    v_accvgpr_read_b32 v39, a39
    v_accvgpr_read_b32 v40, a40
    v_accvgpr_read_b32 v41, a41
    v_accvgpr_read_b32 v42, a42
    v_accvgpr_read_b32 v43, a43
    v_accvgpr_read_b32 v44, a44
    v_accvgpr_read_b32 v45, a45
    v_accvgpr_read_b32 v46, a46
    v_accvgpr_read_b32 v47, a47
    v_cvt_pk_bf16_f32 v48, v32, v33
    v_cvt_pk_bf16_f32 v49, v34, v35
    v_cvt_pk_bf16_f32 v50, v36, v37
    v_cvt_pk_bf16_f32 v51, v38, v39
    v_cvt_pk_bf16_f32 v52, v40, v41
    v_cvt_pk_bf16_f32 v53, v42, v43
    v_cvt_pk_bf16_f32 v54, v44, v45
    v_cvt_pk_bf16_f32 v55, v46, v47
    ds_write_b128 v24, v[48:51] offset:2048
    ds_write_b128 v24, v[52:55] offset:3072
    v_accvgpr_read_b32 v56, a48
    v_accvgpr_read_b32 v57, a49
    v_accvgpr_read_b32 v58, a50
    v_accvgpr_read_b32 v59, a51
    v_accvgpr_read_b32 v60, a52
    v_accvgpr_read_b32 v61, a53
    v_accvgpr_read_b32 v62, a54
    v_accvgpr_read_b32 v63, a55
    v_accvgpr_read_b32 v64, a56
    v_accvgpr_read_b32 v65, a57
    v_accvgpr_read_b32 v66, a58
    v_accvgpr_read_b32 v67, a59
    v_accvgpr_read_b32 v68, a60
    v_accvgpr_read_b32 v69, a61
    v_accvgpr_read_b32 v70, a62
    v_accvgpr_read_b32 v71, a63
    v_cvt_pk_bf16_f32 v72, v56, v57
    v_cvt_pk_bf16_f32 v73, v58, v59
    v_cvt_pk_bf16_f32 v74, v60, v61
    v_cvt_pk_bf16_f32 v75, v62, v63
    v_cvt_pk_bf16_f32 v76, v64, v65
    v_cvt_pk_bf16_f32 v77, v66, v67
    v_cvt_pk_bf16_f32 v78, v68, v69
    v_cvt_pk_bf16_f32 v79, v70, v71
    ds_write_b128 v24, v[72:75] offset:18432
    ds_write_b128 v24, v[76:79] offset:19456
    v_accvgpr_read_b32 v32, a64
    v_accvgpr_read_b32 v33, a65
    v_accvgpr_read_b32 v34, a66
    v_accvgpr_read_b32 v35, a67
    v_accvgpr_read_b32 v36, a68
    v_accvgpr_read_b32 v37, a69
    v_accvgpr_read_b32 v38, a70
    v_accvgpr_read_b32 v39, a71
    v_accvgpr_read_b32 v40, a72
    v_accvgpr_read_b32 v41, a73
    v_accvgpr_read_b32 v42, a74
    v_accvgpr_read_b32 v43, a75
    v_accvgpr_read_b32 v44, a76
    v_accvgpr_read_b32 v45, a77
    v_accvgpr_read_b32 v46, a78
    v_accvgpr_read_b32 v47, a79
    v_cvt_pk_bf16_f32 v48, v32, v33
    v_cvt_pk_bf16_f32 v49, v34, v35
    v_cvt_pk_bf16_f32 v50, v36, v37
    v_cvt_pk_bf16_f32 v51, v38, v39
    v_cvt_pk_bf16_f32 v52, v40, v41
    v_cvt_pk_bf16_f32 v53, v42, v43
    v_cvt_pk_bf16_f32 v54, v44, v45
    v_cvt_pk_bf16_f32 v55, v46, v47
    ds_write_b128 v24, v[48:51] offset:4096
    ds_write_b128 v24, v[52:55] offset:5120
    v_accvgpr_read_b32 v56, a80
    v_accvgpr_read_b32 v57, a81
    v_accvgpr_read_b32 v58, a82
    v_accvgpr_read_b32 v59, a83
    v_accvgpr_read_b32 v60, a84
    v_accvgpr_read_b32 v61, a85
    v_accvgpr_read_b32 v62, a86
    v_accvgpr_read_b32 v63, a87
    v_accvgpr_read_b32 v64, a88
    v_accvgpr_read_b32 v65, a89
    v_accvgpr_read_b32 v66, a90
    v_accvgpr_read_b32 v67, a91
    v_accvgpr_read_b32 v68, a92
    v_accvgpr_read_b32 v69, a93
    v_accvgpr_read_b32 v70, a94
    v_accvgpr_read_b32 v71, a95
    v_cvt_pk_bf16_f32 v72, v56, v57
    v_cvt_pk_bf16_f32 v73, v58, v59
    v_cvt_pk_bf16_f32 v74, v60, v61
    v_cvt_pk_bf16_f32 v75, v62, v63
    v_cvt_pk_bf16_f32 v76, v64, v65
    v_cvt_pk_bf16_f32 v77, v66, v67
    v_cvt_pk_bf16_f32 v78, v68, v69
    v_cvt_pk_bf16_f32 v79, v70, v71
    ds_write_b128 v24, v[72:75] offset:20480
    ds_write_b128 v24, v[76:79] offset:21504
    v_accvgpr_read_b32 v32, a96
    v_accvgpr_read_b32 v33, a97
    v_accvgpr_read_b32 v34, a98
    v_accvgpr_read_b32 v35, a99
    v_accvgpr_read_b32 v36, a100
    v_accvgpr_read_b32 v37, a101
    v_accvgpr_read_b32 v38, a102
    v_accvgpr_read_b32 v39, a103
    v_accvgpr_read_b32 v40, a104
    v_accvgpr_read_b32 v41, a105
    v_accvgpr_read_b32 v42, a106
    v_accvgpr_read_b32 v43, a107
    v_accvgpr_read_b32 v44, a108
    v_accvgpr_read_b32 v45, a109
    v_accvgpr_read_b32 v46, a110
    v_accvgpr_read_b32 v47, a111
    v_cvt_pk_bf16_f32 v48, v32, v33
    v_cvt_pk_bf16_f32 v49, v34, v35
    v_cvt_pk_bf16_f32 v50, v36, v37
    v_cvt_pk_bf16_f32 v51, v38, v39
    v_cvt_pk_bf16_f32 v52, v40, v41
    v_cvt_pk_bf16_f32 v53, v42, v43
    v_cvt_pk_bf16_f32 v54, v44, v45
    v_cvt_pk_bf16_f32 v55, v46, v47
    ds_write_b128 v24, v[48:51] offset:6144
    ds_write_b128 v24, v[52:55] offset:7168
    v_accvgpr_read_b32 v56, a112
    v_accvgpr_read_b32 v57, a113
    v_accvgpr_read_b32 v58, a114
    v_accvgpr_read_b32 v59, a115
    v_accvgpr_read_b32 v60, a116
    v_accvgpr_read_b32 v61, a117
    v_accvgpr_read_b32 v62, a118
    v_accvgpr_read_b32 v63, a119
    v_accvgpr_read_b32 v64, a120
    v_accvgpr_read_b32 v65, a121
    v_accvgpr_read_b32 v66, a122
    v_accvgpr_read_b32 v67, a123
    v_accvgpr_read_b32 v68, a124
    v_accvgpr_read_b32 v69, a125
    v_accvgpr_read_b32 v70, a126
    v_accvgpr_read_b32 v71, a127
    v_cvt_pk_bf16_f32 v72, v56, v57
    v_cvt_pk_bf16_f32 v73, v58, v59
    v_cvt_pk_bf16_f32 v74, v60, v61
    v_cvt_pk_bf16_f32 v75, v62, v63
    v_cvt_pk_bf16_f32 v76, v64, v65
    v_cvt_pk_bf16_f32 v77, v66, v67
    v_cvt_pk_bf16_f32 v78, v68, v69
    v_cvt_pk_bf16_f32 v79, v70, v71
    ds_write_b128 v24, v[72:75] offset:22528
    ds_write_b128 v24, v[76:79] offset:23552
    s_waitcnt lgkmcnt(0)
    s_barrier
    ds_read_b128 v[128:131], v25 offset:0
    ds_read_b128 v[192:195], v25 offset:16384
    ds_read_b128 v[132:135], v25 offset:1024
    ds_read_b128 v[196:199], v25 offset:17408
    ds_read_b128 v[136:139], v25 offset:2048
    ds_read_b128 v[200:203], v25 offset:18432
    ds_read_b128 v[140:143], v25 offset:3072
    ds_read_b128 v[204:207], v25 offset:19456
    ds_read_b128 v[144:147], v25 offset:4096
    ds_read_b128 v[208:211], v25 offset:20480
    ds_read_b128 v[148:151], v25 offset:5120
    ds_read_b128 v[212:215], v25 offset:21504
    ds_read_b128 v[152:155], v25 offset:6144
    ds_read_b128 v[216:219], v25 offset:22528
    ds_read_b128 v[156:159], v25 offset:7168
    ds_read_b128 v[220:223], v25 offset:23552
    ds_read_b128 v[160:163], v25 offset:8192
    ds_read_b128 v[224:227], v25 offset:24576
    ds_read_b128 v[164:167], v25 offset:9216
    ds_read_b128 v[228:231], v25 offset:25600
    ds_read_b128 v[168:171], v25 offset:10240
    ds_read_b128 v[232:235], v25 offset:26624
    ds_read_b128 v[172:175], v25 offset:11264
    ds_read_b128 v[236:239], v25 offset:27648
    ds_read_b128 v[176:179], v25 offset:12288
    ds_read_b128 v[240:243], v25 offset:28672
    ds_read_b128 v[180:183], v25 offset:13312
    ds_read_b128 v[244:247], v25 offset:29696
    ds_read_b128 v[184:187], v25 offset:14336
    ds_read_b128 v[248:251], v25 offset:30720
    ds_read_b128 v[188:191], v25 offset:15360
    ds_read_b128 v[252:255], v25 offset:31744
    v_accvgpr_write_b32 a0, 0
    v_accvgpr_write_b32 a1, 0
    v_accvgpr_write_b32 a2, 0
    v_accvgpr_write_b32 a3, 0
    v_accvgpr_write_b32 a4, 0
    v_accvgpr_write_b32 a5, 0
    v_accvgpr_write_b32 a6, 0
    v_accvgpr_write_b32 a7, 0
    v_accvgpr_write_b32 a8, 0
    v_accvgpr_write_b32 a9, 0
    v_accvgpr_write_b32 a10, 0
    v_accvgpr_write_b32 a11, 0
    v_accvgpr_write_b32 a12, 0
    v_accvgpr_write_b32 a13, 0
    v_accvgpr_write_b32 a14, 0
    v_accvgpr_write_b32 a15, 0
    v_accvgpr_write_b32 a16, 0
    v_accvgpr_write_b32 a17, 0
    v_accvgpr_write_b32 a18, 0
    v_accvgpr_write_b32 a19, 0
    v_accvgpr_write_b32 a20, 0
    v_accvgpr_write_b32 a21, 0
    v_accvgpr_write_b32 a22, 0
    v_accvgpr_write_b32 a23, 0
    v_accvgpr_write_b32 a24, 0
    v_accvgpr_write_b32 a25, 0
    v_accvgpr_write_b32 a26, 0
    v_accvgpr_write_b32 a27, 0
    v_accvgpr_write_b32 a28, 0
    v_accvgpr_write_b32 a29, 0
    v_accvgpr_write_b32 a30, 0
    v_accvgpr_write_b32 a31, 0
    v_accvgpr_write_b32 a32, 0
    v_accvgpr_write_b32 a33, 0
    v_accvgpr_write_b32 a34, 0
    v_accvgpr_write_b32 a35, 0
    v_accvgpr_write_b32 a36, 0
    v_accvgpr_write_b32 a37, 0
    v_accvgpr_write_b32 a38, 0
    v_accvgpr_write_b32 a39, 0
    s_waitcnt vmcnt(0) lgkmcnt(0)
    s_barrier
    s_add_u32 m0, s26, 0
    s_nop 0
    buffer_load_dwordx4 v5, s[12:15], s22 offen offset:0 lds
    s_add_u32 m0, s26, 128
    s_nop 0
    buffer_load_dwordx4 v5, s[12:15], s22 offen offset:1024 lds
    s_add_u32 m0, s26, 256
    s_nop 0
    buffer_load_dwordx4 v5, s[12:15], s22 offen offset:2048 lds
    s_add_u32 m0, s26, 384
    s_nop 0
    buffer_load_dwordx4 v5, s[12:15], s22 offen offset:3072 lds
    s_add_u32 m0, s26, 4608
    s_nop 0
    buffer_load_dwordx4 v5, s[12:15], s23 offen offset:0 lds
    s_add_u32 m0, s26, 4736
    s_nop 0
    buffer_load_dwordx4 v5, s[12:15], s23 offen offset:1024 lds
    s_add_u32 m0, s26, 4864
    s_nop 0
    buffer_load_dwordx4 v5, s[12:15], s23 offen offset:2048 lds
    s_add_u32 m0, s26, 4992
    s_nop 0
    buffer_load_dwordx4 v5, s[12:15], s23 offen offset:3072 lds
    s_add_u32 s22, s22, 16384
    s_add_u32 s23, s23, 16384
    ds_read_b128 v[32:35], v1 offset:33792
    ds_read_b128 v[36:39], v1 offset:33824
    ds_read_b128 v[40:43], v1 offset:33856
    ds_read_b128 v[44:47], v1 offset:33888
    ds_read_b128 v[48:51], v1 offset:33920
    v_accvgpr_write_b32 a40, 0
    v_accvgpr_write_b32 a41, 0
    v_accvgpr_write_b32 a42, 0
    v_accvgpr_write_b32 a43, 0
    s_waitcnt lgkmcnt(4)
    v_mfma_f32_32x32x16_bf16 v[64:79], v[32:35], v[128:131], 0
    v_accvgpr_write_b32 a44, 0
    v_accvgpr_write_b32 a45, 0
    v_accvgpr_write_b32 a46, 0
    v_accvgpr_write_b32 a47, 0
    v_accvgpr_write_b32 a48, 0
    v_mfma_f32_32x32x16_bf16 v[80:95], v[32:35], v[192:195], 0
    ds_read_b128 v[52:55], v1 offset:33952
    v_accvgpr_write_b32 a49, 0
    v_accvgpr_write_b32 a50, 0
    v_accvgpr_write_b32 a51, 0
    v_accvgpr_write_b32 a52, 0
    s_waitcnt lgkmcnt(4)
    v_mfma_f32_32x32x16_bf16 v[64:79], v[36:39], v[132:135], v[64:79]
    v_accvgpr_write_b32 a53, 0
    v_accvgpr_write_b32 a54, 0
    v_accvgpr_write_b32 a55, 0
    v_accvgpr_write_b32 a56, 0
    v_accvgpr_write_b32 a57, 0
    v_mfma_f32_32x32x16_bf16 v[80:95], v[36:39], v[196:199], v[80:95]
    ds_read_b128 v[56:59], v1 offset:33984
    v_accvgpr_write_b32 a58, 0
    v_accvgpr_write_b32 a59, 0
    v_accvgpr_write_b32 a60, 0
    v_accvgpr_write_b32 a61, 0
    s_waitcnt lgkmcnt(4)
    v_mfma_f32_32x32x16_bf16 v[64:79], v[40:43], v[136:139], v[64:79]
    v_accvgpr_write_b32 a62, 0
    v_accvgpr_write_b32 a63, 0
    v_accvgpr_write_b32 a64, 0
    v_accvgpr_write_b32 a65, 0
    v_accvgpr_write_b32 a66, 0
    v_mfma_f32_32x32x16_bf16 v[80:95], v[40:43], v[200:203], v[80:95]
    ds_read_b128 v[60:63], v1 offset:34016
    v_accvgpr_write_b32 a67, 0
    v_accvgpr_write_b32 a68, 0
    v_accvgpr_write_b32 a69, 0
    v_accvgpr_write_b32 a70, 0
    s_waitcnt lgkmcnt(4)
    v_mfma_f32_32x32x16_bf16 v[64:79], v[44:47], v[140:143], v[64:79]
    v_accvgpr_write_b32 a71, 0
    v_accvgpr_write_b32 a72, 0
    v_accvgpr_write_b32 a73, 0
    v_accvgpr_write_b32 a74, 0
    v_accvgpr_write_b32 a75, 0
    v_mfma_f32_32x32x16_bf16 v[80:95], v[44:47], v[204:207], v[80:95]
    ds_read_b128 v[32:35], v1 offset:34048
    v_accvgpr_write_b32 a76, 0
    v_accvgpr_write_b32 a77, 0
    v_accvgpr_write_b32 a78, 0
    v_accvgpr_write_b32 a79, 0
    s_waitcnt lgkmcnt(4)
    v_mfma_f32_32x32x16_bf16 v[64:79], v[48:51], v[144:147], v[64:79]
    v_accvgpr_write_b32 a80, 0
    v_accvgpr_write_b32 a81, 0
    v_accvgpr_write_b32 a82, 0
    v_accvgpr_write_b32 a83, 0
    v_accvgpr_write_b32 a84, 0
    v_mfma_f32_32x32x16_bf16 v[80:95], v[48:51], v[208:211], v[80:95]
    ds_read_b128 v[36:39], v1 offset:34080
    v_accvgpr_write_b32 a85, 0
    v_accvgpr_write_b32 a86, 0
    v_accvgpr_write_b32 a87, 0
    v_accvgpr_write_b32 a88, 0
    s_waitcnt lgkmcnt(4)
    v_mfma_f32_32x32x16_bf16 v[64:79], v[52:55], v[148:151], v[64:79]
    v_accvgpr_write_b32 a89, 0
    v_accvgpr_write_b32 a90, 0
    v_accvgpr_write_b32 a91, 0
    v_accvgpr_write_b32 a92, 0
    v_accvgpr_write_b32 a93, 0
    v_mfma_f32_32x32x16_bf16 v[80:95], v[52:55], v[212:215], v[80:95]
    ds_read_b128 v[40:43], v1 offset:34112
    v_accvgpr_write_b32 a94, 0
    v_accvgpr_write_b32 a95, 0
    v_accvgpr_write_b32 a96, 0
    v_accvgpr_write_b32 a97, 0
    s_waitcnt lgkmcnt(4)
    v_mfma_f32_32x32x16_bf16 v[64:79], v[56:59], v[152:155], v[64:79]
    ds_read_b128 v[44:47], v1 offset:34144
    v_accvgpr_write_b32 a98, 0
    v_accvgpr_write_b32 a99, 0
    v_accvgpr_write_b32 a100, 0
    v_accvgpr_write_b32 a101, 0
    v_mfma_f32_32x32x16_bf16 v[80:95], v[56:59], v[216:219], v[80:95]
    v_accvgpr_write_b32 a102, 0
    v_accvgpr_write_b32 a103, 0
    v_accvgpr_write_b32 a104, 0
    v_accvgpr_write_b32 a105, 0
    v_accvgpr_write_b32 a106, 0
    s_waitcnt lgkmcnt(4)
    v_mfma_f32_32x32x16_bf16 v[64:79], v[60:63], v[156:159], v[64:79]
    ds_read_b128 v[48:51], v1 offset:34176
    v_accvgpr_write_b32 a107, 0
    v_accvgpr_write_b32 a108, 0
    v_accvgpr_write_b32 a109, 0
    v_accvgpr_write_b32 a110, 0
    v_mfma_f32_32x32x16_bf16 v[80:95], v[60:63], v[220:223], v[80:95]
    ds_read_b128 v[52:55], v1 offset:34208
    v_accvgpr_write_b32 a111, 0
    v_accvgpr_write_b32 a112, 0
    v_accvgpr_write_b32 a113, 0
    v_accvgpr_write_b32 a114, 0
    s_waitcnt lgkmcnt(5)
    v_mfma_f32_32x32x16_bf16 v[64:79], v[32:35], v[160:163], v[64:79]
    v_accvgpr_write_b32 a115, 0
    v_accvgpr_write_b32 a116, 0
    v_accvgpr_write_b32 a117, 0
    v_accvgpr_write_b32 a118, 0
    v_accvgpr_write_b32 a119, 0
    v_mfma_f32_32x32x16_bf16 v[80:95], v[32:35], v[224:227], v[80:95]
    ds_read_b128 v[56:59], v1 offset:34240
    v_accvgpr_write_b32 a120, 0
    v_accvgpr_write_b32 a121, 0
    v_accvgpr_write_b32 a122, 0
    v_accvgpr_write_b32 a123, 0
    s_waitcnt lgkmcnt(5)
    v_mfma_f32_32x32x16_bf16 v[64:79], v[36:39], v[164:167], v[64:79]
    ds_read_b128 v[60:63], v1 offset:34272
    v_accvgpr_write_b32 a124, 0
    v_accvgpr_write_b32 a125, 0
    v_accvgpr_write_b32 a126, 0
    v_accvgpr_write_b32 a127, 0
    v_mfma_f32_32x32x16_bf16 v[80:95], v[36:39], v[228:231], v[80:95]
    v_accvgpr_write_b32 a128, 0
    v_accvgpr_write_b32 a129, 0
    v_accvgpr_write_b32 a130, 0
    v_accvgpr_write_b32 a131, 0
    v_accvgpr_write_b32 a132, 0
    s_waitcnt lgkmcnt(5)
    v_mfma_f32_32x32x16_bf16 v[64:79], v[40:43], v[168:171], v[64:79]
    v_accvgpr_write_b32 a133, 0
    v_accvgpr_write_b32 a134, 0
    v_accvgpr_write_b32 a135, 0
    v_accvgpr_write_b32 a136, 0
    v_accvgpr_write_b32 a137, 0
    v_mfma_f32_32x32x16_bf16 v[80:95], v[40:43], v[232:235], v[80:95]
    v_accvgpr_write_b32 a138, 0
    v_accvgpr_write_b32 a139, 0
    v_accvgpr_write_b32 a140, 0
    v_accvgpr_write_b32 a141, 0
    v_accvgpr_write_b32 a142, 0
    s_waitcnt lgkmcnt(4)
    v_mfma_f32_32x32x16_bf16 v[64:79], v[44:47], v[172:175], v[64:79]
    v_accvgpr_write_b32 a143, 0
    v_accvgpr_write_b32 a144, 0
    v_accvgpr_write_b32 a145, 0
    v_accvgpr_write_b32 a146, 0
    v_accvgpr_write_b32 a147, 0
    v_mfma_f32_32x32x16_bf16 v[80:95], v[44:47], v[236:239], v[80:95]
    s_waitcnt vmcnt(8) lgkmcnt(0)
    s_barrier
    ds_read_b128 v[32:35], v1 offset:0
    v_accvgpr_write_b32 a148, 0
    v_accvgpr_write_b32 a149, 0
    v_mfma_f32_32x32x16_bf16 v[64:79], v[48:51], v[176:179], v[64:79]
    v_accvgpr_write_b32 a150, 0
    v_accvgpr_write_b32 a151, 0
    v_accvgpr_write_b32 a152, 0
    v_accvgpr_write_b32 a153, 0
    v_accvgpr_write_b32 a154, 0
    v_mfma_f32_32x32x16_bf16 v[80:95], v[48:51], v[240:243], v[80:95]
    ds_read_b128 v[36:39], v1 offset:32
    v_accvgpr_write_b32 a155, 0
    v_accvgpr_write_b32 a156, 0
    v_accvgpr_write_b32 a157, 0
    v_accvgpr_write_b32 a158, 0
    v_mfma_f32_32x32x16_bf16 v[64:79], v[52:55], v[180:183], v[64:79]
    v_accvgpr_write_b32 a159, 0
    v_mfma_f32_32x32x16_bf16 v[80:95], v[52:55], v[244:247], v[80:95]
    ds_read_b128 v[40:43], v1 offset:64
    v_mfma_f32_32x32x16_bf16 v[64:79], v[56:59], v[184:187], v[64:79]
    v_mfma_f32_32x32x16_bf16 v[80:95], v[56:59], v[248:251], v[80:95]
    ds_read_b128 v[44:47], v1 offset:96
    v_mfma_f32_32x32x16_bf16 v[64:79], v[60:63], v[188:191], v[64:79]
    v_mfma_f32_32x32x16_bf16 v[80:95], v[60:63], v[252:255], v[80:95]
    ds_read_b128 v[48:51], v1 offset:128
    s_waitcnt lgkmcnt(4)
    v_mfma_f32_32x32x16_bf16 v[96:111], v[32:35], v[128:131], 0
    s_add_u32 m0, s24, 0
    s_nop 0
    buffer_load_dwordx4 v4, s[8:11], s20 offen offset:0 lds
    v_mfma_f32_32x32x16_bf16 v[112:127], v[32:35], v[192:195], 0
    ds_read_b128 v[52:55], v1 offset:160
    s_add_u32 m0, s24, 32
    s_nop 0
    buffer_load_dwordx4 v4, s[8:11], s20 offen offset:1024 lds
    s_waitcnt lgkmcnt(4)
    v_mfma_f32_32x32x16_bf16 v[96:111], v[36:39], v[132:135], v[96:111]
    s_add_u32 m0, s24, 64
    s_nop 0
    buffer_load_dwordx4 v4, s[8:11], s20 offen offset:2048 lds
    v_max3_f32 v10, v64, v65, v66
    v_max3_f32 v11, v67, v68, v69
    v_max3_f32 v12, v70, v71, v72
    v_max3_f32 v13, v73, v74, v75
    v_mfma_f32_32x32x16_bf16 v[112:127], v[36:39], v[196:199], v[112:127]
    ds_read_b128 v[56:59], v1 offset:192
    s_add_u32 m0, s24, 96
    s_nop 0
    buffer_load_dwordx4 v4, s[8:11], s20 offen offset:3072 lds
    v_max3_f32 v10, v10, v76, v77
    v_max3_f32 v11, v11, v78, v79
    v_max3_f32 v10, v10, v12, v13
    s_waitcnt lgkmcnt(4)
    v_mfma_f32_32x32x16_bf16 v[96:111], v[40:43], v[136:139], v[96:111]
    v_max_f32 v10, v10, v11
    v_mov_b32 v11, v10
    v_max3_f32 v14, v80, v81, v82
    v_max3_f32 v15, v83, v84, v85
    v_max3_f32 v16, v86, v87, v88
    v_max3_f32 v17, v89, v90, v91
    v_max3_f32 v14, v14, v92, v93
    v_mfma_f32_32x32x16_bf16 v[112:127], v[40:43], v[200:203], v[112:127]
    ds_read_b128 v[60:63], v1 offset:224
    s_add_u32 m0, s24, 4224
    s_nop 0
    buffer_load_dwordx4 v4, s[8:11], s21 offen offset:0 lds
    v_max3_f32 v15, v15, v94, v95
    v_max3_f32 v14, v14, v16, v17
    v_max_f32 v14, v14, v15
    s_waitcnt lgkmcnt(4)
    v_mfma_f32_32x32x16_bf16 v[96:111], v[44:47], v[140:143], v[96:111]
    s_add_u32 m0, s24, 4256
    s_nop 0
    buffer_load_dwordx4 v4, s[8:11], s21 offen offset:1024 lds
    v_mov_b32 v15, v14
    s_nop 0
    v_permlane32_swap_b32 v10, v11
    v_permlane32_swap_b32 v14, v15
    v_mfma_f32_32x32x16_bf16 v[112:127], v[44:47], v[204:207], v[112:127]
    ds_read_b128 v[32:35], v1 offset:256
    s_add_u32 m0, s24, 4288
    s_nop 0
    buffer_load_dwordx4 v4, s[8:11], s21 offen offset:2048 lds
    s_nop 0
    v_max_f32 v10, v10, v11
    v_max_f32 v14, v14, v15
    s_waitcnt lgkmcnt(4)
    v_mfma_f32_32x32x16_bf16 v[96:111], v[48:51], v[144:147], v[96:111]
    s_add_u32 m0, s24, 4320
    s_nop 0
    buffer_load_dwordx4 v4, s[8:11], s21 offen offset:3072 lds
    v_fma_f32 v6, s28, v10, v18
    v_fma_f32 v7, s28, v14, v18
    v_mov_b32 v8, 0
    v_mov_b32 v9, 0
    v_mfma_f32_32x32x16_bf16 v[112:127], v[48:51], v[208:211], v[112:127]
    ds_read_b128 v[36:39], v1 offset:288
    v_cvt_pk_bf16_f32 v64, 0, v64
    v_cvt_pk_bf16_f32 v65, 0, v65
    v_cvt_pk_bf16_f32 v66, 0, v66
    v_cvt_pk_bf16_f32 v67, 0, v67
    v_fma_f32 v64, v64, s28, -v6
    v_fma_f32 v65, v65, s28, -v6
    s_waitcnt lgkmcnt(4)
    v_mfma_f32_32x32x16_bf16 v[96:111], v[52:55], v[148:151], v[96:111]
    s_add_u32 s20, s20, 16384
    s_add_u32 s21, s21, 16384
    v_fma_f32 v66, v66, s28, -v6
    v_fma_f32 v67, v67, s28, -v6
    v_exp_f32 v64, v64
    v_mfma_f32_32x32x16_bf16 v[112:127], v[52:55], v[212:215], v[112:127]
    ds_read_b128 v[40:43], v1 offset:320
    s_add_u32 m0, s27, 0
    s_nop 0
    buffer_load_dwordx4 v5, s[12:15], s22 offen offset:0 lds
    v_exp_f32 v65, v65
    s_waitcnt lgkmcnt(4)
    v_mfma_f32_32x32x16_bf16 v[96:111], v[56:59], v[152:155], v[96:111]
    ds_read_b128 v[44:47], v1 offset:352
    s_add_u32 m0, s27, 128
    s_nop 0
    buffer_load_dwordx4 v5, s[12:15], s22 offen offset:1024 lds
    v_exp_f32 v66, v66
    v_mfma_f32_32x32x16_bf16 v[112:127], v[56:59], v[216:219], v[112:127]
    v_exp_f32 v67, v67
    v_add_f32 v8, v8, v64
    v_add_f32 v8, v8, v65
    v_add_f32 v8, v8, v66
    v_add_f32 v8, v8, v67
    v_cvt_pk_bf16_f32 v64, v64, v65
    s_waitcnt lgkmcnt(4)
    v_mfma_f32_32x32x16_bf16 v[96:111], v[60:63], v[156:159], v[96:111]
    ds_read_b128 v[48:51], v1 offset:384
    s_add_u32 m0, s27, 256
    s_nop 0
    buffer_load_dwordx4 v5, s[12:15], s22 offen offset:2048 lds
    v_cvt_pk_bf16_f32 v65, v66, v67
    v_cvt_pk_bf16_f32 v68, 0, v68
    v_cvt_pk_bf16_f32 v69, 0, v69
    v_mfma_f32_32x32x16_bf16 v[112:127], v[60:63], v[220:223], v[112:127]
    ds_read_b128 v[52:55], v1 offset:416
    s_add_u32 m0, s27, 384
    s_nop 0
    buffer_load_dwordx4 v5, s[12:15], s22 offen offset:3072 lds
    v_cvt_pk_bf16_f32 v70, 0, v70
    v_cvt_pk_bf16_f32 v71, 0, v71
    v_fma_f32 v68, v68, s28, -v6
    s_waitcnt lgkmcnt(5)
    v_mfma_f32_32x32x16_bf16 v[96:111], v[32:35], v[160:163], v[96:111]
    s_add_u32 m0, s27, 4608
    s_nop 0
    buffer_load_dwordx4 v5, s[12:15], s23 offen offset:0 lds
    v_fma_f32 v69, v69, s28, -v6
    v_fma_f32 v70, v70, s28, -v6
    v_fma_f32 v71, v71, s28, -v6
    v_mfma_f32_32x32x16_bf16 v[112:127], v[32:35], v[224:227], v[112:127]
    ds_read_b128 v[56:59], v1 offset:448
    s_add_u32 m0, s27, 4736
    s_nop 0
    buffer_load_dwordx4 v5, s[12:15], s23 offen offset:1024 lds
    v_exp_f32 v68, v68
    s_waitcnt lgkmcnt(5)
    v_mfma_f32_32x32x16_bf16 v[96:111], v[36:39], v[164:167], v[96:111]
    ds_read_b128 v[60:63], v1 offset:480
    v_exp_f32 v69, v69
    v_exp_f32 v70, v70
    v_exp_f32 v71, v71
    v_mfma_f32_32x32x16_bf16 v[112:127], v[36:39], v[228:231], v[112:127]
    s_add_u32 m0, s27, 4864
    s_nop 0
    buffer_load_dwordx4 v5, s[12:15], s23 offen offset:2048 lds
    v_add_f32 v8, v8, v68
    v_add_f32 v8, v8, v69
    v_add_f32 v8, v8, v70
    v_add_f32 v8, v8, v71
    s_waitcnt lgkmcnt(5)
    v_mfma_f32_32x32x16_bf16 v[96:111], v[40:43], v[168:171], v[96:111]
    s_add_u32 m0, s27, 4992
    s_nop 0
    buffer_load_dwordx4 v5, s[12:15], s23 offen offset:3072 lds
    v_cvt_pk_bf16_f32 v66, v68, v69
    v_cvt_pk_bf16_f32 v67, v70, v71
    v_cvt_pk_bf16_f32 v72, 0, v72
    v_cvt_pk_bf16_f32 v73, 0, v73
    v_mfma_f32_32x32x16_bf16 v[112:127], v[40:43], v[232:235], v[112:127]
    s_add_u32 s22, s22, 16384
    s_add_u32 s23, s23, 16384
    v_cvt_pk_bf16_f32 v74, 0, v74
    v_cvt_pk_bf16_f32 v75, 0, v75
    v_fma_f32 v72, v72, s28, -v6
    v_fma_f32 v73, v73, s28, -v6
    v_fma_f32 v74, v74, s28, -v6
    s_waitcnt lgkmcnt(4)
    v_mfma_f32_32x32x16_bf16 v[96:111], v[44:47], v[172:175], v[96:111]
    v_fma_f32 v75, v75, s28, -v6
    v_exp_f32 v72, v72
    v_exp_f32 v73, v73
    v_exp_f32 v74, v74
    v_mfma_f32_32x32x16_bf16 v[112:127], v[44:47], v[236:239], v[112:127]
    s_waitcnt vmcnt(16) lgkmcnt(0)
    s_barrier
    ds_read_b64_tr_b16 v[32:33], v2 offset:0
    ds_read_b64_tr_b16 v[34:35], v2 offset:4608
    v_exp_f32 v75, v75
    v_add_f32 v8, v8, v72
    v_mfma_f32_32x32x16_bf16 v[96:111], v[48:51], v[176:179], v[96:111]
    v_add_f32 v8, v8, v73
    v_add_f32 v8, v8, v74
    v_add_f32 v8, v8, v75
    v_cvt_pk_bf16_f32 v68, v72, v73
    v_cvt_pk_bf16_f32 v69, v74, v75
    v_cvt_pk_bf16_f32 v76, 0, v76
    v_cvt_pk_bf16_f32 v77, 0, v77
    v_mfma_f32_32x32x16_bf16 v[112:127], v[48:51], v[240:243], v[112:127]
    ds_read_b64_tr_b16 v[36:37], v2 offset:9216
    ds_read_b64_tr_b16 v[38:39], v2 offset:13824
    v_cvt_pk_bf16_f32 v78, 0, v78
    v_cvt_pk_bf16_f32 v79, 0, v79
    v_fma_f32 v76, v76, s28, -v6
    v_fma_f32 v77, v77, s28, -v6
    v_fma_f32 v78, v78, s28, -v6
    v_mfma_f32_32x32x16_bf16 v[96:111], v[52:55], v[180:183], v[96:111]
    v_fma_f32 v79, v79, s28, -v6
    v_exp_f32 v76, v76
    v_exp_f32 v77, v77
    v_exp_f32 v78, v78
    v_mfma_f32_32x32x16_bf16 v[112:127], v[52:55], v[244:247], v[112:127]
    ds_read_b64_tr_b16 v[40:41], v3 offset:64
    ds_read_b64_tr_b16 v[42:43], v3 offset:4672
    v_exp_f32 v79, v79
    v_add_f32 v8, v8, v76
    v_add_f32 v8, v8, v77
    v_add_f32 v8, v8, v78
    v_mfma_f32_32x32x16_bf16 v[96:111], v[56:59], v[184:187], v[96:111]
    v_add_f32 v8, v8, v79
    v_cvt_pk_bf16_f32 v70, v76, v77
    v_cvt_pk_bf16_f32 v71, v78, v79
    v_cvt_pk_bf16_f32 v80, 0, v80
    v_cvt_pk_bf16_f32 v81, 0, v81
    v_cvt_pk_bf16_f32 v82, 0, v82
    v_cvt_pk_bf16_f32 v83, 0, v83
    v_mfma_f32_32x32x16_bf16 v[112:127], v[56:59], v[248:251], v[112:127]
    ds_read_b64_tr_b16 v[44:45], v3 offset:9280
    ds_read_b64_tr_b16 v[46:47], v3 offset:13888
    v_fma_f32 v80, v80, s28, -v7
    v_fma_f32 v81, v81, s28, -v7
    v_fma_f32 v82, v82, s28, -v7
    v_fma_f32 v83, v83, s28, -v7
    v_mfma_f32_32x32x16_bf16 v[96:111], v[60:63], v[188:191], v[96:111]
    v_exp_f32 v80, v80
    v_exp_f32 v81, v81
    v_exp_f32 v82, v82
    v_mfma_f32_32x32x16_bf16 v[112:127], v[60:63], v[252:255], v[112:127]
    v_exp_f32 v83, v83
    v_add_f32 v9, v9, v80
    v_add_f32 v9, v9, v81
    v_add_f32 v9, v9, v82
    v_add_f32 v9, v9, v83
    v_cvt_pk_bf16_f32 v80, v80, v81
    v_cvt_pk_bf16_f32 v81, v82, v83
    v_cvt_pk_bf16_f32 v84, 0, v84
    v_cvt_pk_bf16_f32 v85, 0, v85
    v_cvt_pk_bf16_f32 v86, 0, v86
    v_cvt_pk_bf16_f32 v87, 0, v87
    v_fma_f32 v84, v84, s28, -v7
    v_fma_f32 v85, v85, s28, -v7
    v_fma_f32 v86, v86, s28, -v7
    v_fma_f32 v87, v87, s28, -v7
    v_exp_f32 v84, v84
    v_exp_f32 v85, v85
    v_exp_f32 v86, v86
    v_exp_f32 v87, v87
    v_add_f32 v9, v9, v84
    v_add_f32 v9, v9, v85
    v_add_f32 v9, v9, v86
    v_add_f32 v9, v9, v87
    v_cvt_pk_bf16_f32 v82, v84, v85
    v_cvt_pk_bf16_f32 v83, v86, v87
    v_cvt_pk_bf16_f32 v88, 0, v88
    v_cvt_pk_bf16_f32 v89, 0, v89
    v_cvt_pk_bf16_f32 v90, 0, v90
    v_cvt_pk_bf16_f32 v91, 0, v91
    v_fma_f32 v88, v88, s28, -v7
    v_fma_f32 v89, v89, s28, -v7
    v_fma_f32 v90, v90, s28, -v7
    v_fma_f32 v91, v91, s28, -v7
    v_exp_f32 v88, v88
    v_exp_f32 v89, v89
    v_exp_f32 v90, v90
    v_exp_f32 v91, v91
    v_add_f32 v9, v9, v88
    v_add_f32 v9, v9, v89
    v_add_f32 v9, v9, v90
    v_add_f32 v9, v9, v91
    v_cvt_pk_bf16_f32 v84, v88, v89
    v_cvt_pk_bf16_f32 v85, v90, v91
    v_cvt_pk_bf16_f32 v92, 0, v92
    v_cvt_pk_bf16_f32 v93, 0, v93
    v_cvt_pk_bf16_f32 v94, 0, v94
    v_cvt_pk_bf16_f32 v95, 0, v95
    v_fma_f32 v92, v92, s28, -v7
    v_fma_f32 v93, v93, s28, -v7
    v_fma_f32 v94, v94, s28, -v7
    v_fma_f32 v95, v95, s28, -v7
    v_exp_f32 v92, v92
    v_exp_f32 v93, v93
    v_exp_f32 v94, v94
    v_exp_f32 v95, v95
    v_add_f32 v9, v9, v92
    v_add_f32 v9, v9, v93
    v_add_f32 v9, v9, v94
    v_add_f32 v9, v9, v95
    v_cvt_pk_bf16_f32 v86, v92, v93
    v_cvt_pk_bf16_f32 v87, v94, v95
    s_mov_b32 s31, 15
    s_nop 1
K3_LOOP:
    ds_read_b64_tr_b16 v[48:49], v2 offset:128
    ds_read_b64_tr_b16 v[50:51], v2 offset:4736
    s_waitcnt lgkmcnt(8)
    v_mfma_f32_32x32x16_bf16 a[0:15], v[32:35], v[64:67], a[0:15]
    s_add_u32 m0, s25, 0
    s_nop 0
    buffer_load_dwordx4 v4, s[8:11], s20 offen offset:0 lds
    v_mfma_f32_32x32x16_bf16 a[16:31], v[32:35], v[80:83], a[16:31]
    ds_read_b64_tr_b16 v[52:53], v2 offset:9344
    ds_read_b64_tr_b16 v[54:55], v2 offset:13952
    s_waitcnt lgkmcnt(8)
    v_mfma_f32_32x32x16_bf16 a[0:15], v[36:39], v[68:71], a[0:15]
    s_add_u32 m0, s25, 32
    s_nop 0
    buffer_load_dwordx4 v4, s[8:11], s20 offen offset:1024 lds
    v_max3_f32 v10, v96, v97, v98
    v_max3_f32 v11, v99, v100, v101
    v_mfma_f32_32x32x16_bf16 a[16:31], v[36:39], v[84:87], a[16:31]
    ds_read_b64_tr_b16 v[56:57], v3 offset:192
    ds_read_b64_tr_b16 v[58:59], v3 offset:4800
    v_max3_f32 v12, v102, v103, v104
    v_max3_f32 v13, v105, v106, v107
    v_max3_f32 v10, v10, v108, v109
    s_waitcnt lgkmcnt(8)
    v_mfma_f32_32x32x16_bf16 a[32:47], v[40:43], v[64:67], a[32:47]
    s_add_u32 m0, s25, 64
    s_nop 0
    buffer_load_dwordx4 v4, s[8:11], s20 offen offset:2048 lds
    v_max3_f32 v11, v11, v110, v111
    v_max3_f32 v10, v10, v12, v13
    v_mfma_f32_32x32x16_bf16 a[48:63], v[40:43], v[80:83], a[48:63]
    ds_read_b64_tr_b16 v[60:61], v3 offset:9408
    ds_read_b64_tr_b16 v[62:63], v3 offset:14016
    v_max_f32 v10, v10, v11
    v_mov_b32 v11, v10
    v_max3_f32 v14, v112, v113, v114
    s_waitcnt lgkmcnt(8)
    v_mfma_f32_32x32x16_bf16 a[32:47], v[44:47], v[68:71], a[32:47]
    v_max3_f32 v15, v115, v116, v117
    v_max3_f32 v16, v118, v119, v120
    v_max3_f32 v17, v121, v122, v123
    v_max3_f32 v14, v14, v124, v125
    v_max3_f32 v15, v15, v126, v127
    v_mfma_f32_32x32x16_bf16 a[48:63], v[44:47], v[84:87], a[48:63]
    ds_read_b64_tr_b16 v[32:33], v2 offset:256
    ds_read_b64_tr_b16 v[34:35], v2 offset:4864
    v_max3_f32 v14, v14, v16, v17
    v_max_f32 v14, v14, v15
    v_mov_b32 v15, v14
    s_waitcnt lgkmcnt(8)
    v_mfma_f32_32x32x16_bf16 a[64:79], v[48:51], v[64:67], a[64:79]
    s_add_u32 m0, s25, 96
    s_nop 0
    buffer_load_dwordx4 v4, s[8:11], s20 offen offset:3072 lds
    s_nop 0
    v_permlane32_swap_b32 v10, v11
    v_mfma_f32_32x32x16_bf16 a[80:95], v[48:51], v[80:83], a[80:95]
    ds_read_b64_tr_b16 v[36:37], v2 offset:9472
    ds_read_b64_tr_b16 v[38:39], v2 offset:14080
    v_permlane32_swap_b32 v14, v15
    s_nop 0
    v_max_f32 v10, v10, v11
    s_waitcnt lgkmcnt(8)
    v_mfma_f32_32x32x16_bf16 a[64:79], v[52:55], v[68:71], a[64:79]
    s_add_u32 m0, s25, 4224
    s_nop 0
    buffer_load_dwordx4 v4, s[8:11], s21 offen offset:0 lds
    v_max_f32 v14, v14, v15
    v_fma_f32 v12, v10, s28, -v6
    v_mfma_f32_32x32x16_bf16 a[80:95], v[52:55], v[84:87], a[80:95]
    ds_read_b64_tr_b16 v[40:41], v3 offset:320
    ds_read_b64_tr_b16 v[42:43], v3 offset:4928
    v_fma_f32 v13, v14, s28, -v7
    v_max_f32 v12, v12, v13
    v_cmp_lt_f32 vcc, s29, v12
    s_waitcnt lgkmcnt(8)
    v_mfma_f32_32x32x16_bf16 a[96:111], v[56:59], v[64:67], a[96:111]
    ds_read_b64_tr_b16 v[44:45], v3 offset:9536
    ds_read_b64_tr_b16 v[46:47], v3 offset:14144
    s_nop 1
    s_cbranch_vccnz RB1_l1
RB1R_l1:
    v_cvt_pk_bf16_f32 v96, 0, v96
    v_mfma_f32_32x32x16_bf16 a[112:127], v[56:59], v[80:83], a[112:127]
    s_add_u32 m0, s25, 4256
    s_nop 0
    buffer_load_dwordx4 v4, s[8:11], s21 offen offset:1024 lds
    v_cvt_pk_bf16_f32 v97, 0, v97
    v_cvt_pk_bf16_f32 v98, 0, v98
    s_waitcnt lgkmcnt(8)
    v_mfma_f32_32x32x16_bf16 a[96:111], v[60:63], v[68:71], a[96:111]
    ds_read_b64_tr_b16 v[48:49], v2 offset:384
    ds_read_b64_tr_b16 v[50:51], v2 offset:4992
    v_cvt_pk_bf16_f32 v99, 0, v99
    v_fma_f32 v96, v96, s28, -v6
    v_fma_f32 v97, v97, s28, -v6
    v_mfma_f32_32x32x16_bf16 a[112:127], v[60:63], v[84:87], a[112:127]
    ds_read_b64_tr_b16 v[52:53], v2 offset:9600
    ds_read_b64_tr_b16 v[54:55], v2 offset:14208
    v_fma_f32 v98, v98, s28, -v6
    v_fma_f32 v99, v99, s28, -v6
    s_waitcnt lgkmcnt(10)
    v_mfma_f32_32x32x16_bf16 a[128:143], v[32:35], v[64:67], a[128:143]
    v_exp_f32 v96, v96
    v_exp_f32 v97, v97
    v_mfma_f32_32x32x16_bf16 a[144:159], v[32:35], v[80:83], a[144:159]
    ds_read_b64_tr_b16 v[56:57], v3 offset:448
    ds_read_b64_tr_b16 v[58:59], v3 offset:5056
    v_exp_f32 v98, v98
    s_waitcnt lgkmcnt(10)
    v_mfma_f32_32x32x16_bf16 a[128:143], v[36:39], v[68:71], a[128:143]
    ds_read_b64_tr_b16 v[60:61], v3 offset:9664
    ds_read_b64_tr_b16 v[62:63], v3 offset:14272
    v_exp_f32 v99, v99
    v_add_f32 v8, v8, v96
    v_mfma_f32_32x32x16_bf16 a[144:159], v[36:39], v[84:87], a[144:159]
    s_add_u32 m0, s25, 4288
    s_nop 0
    buffer_load_dwordx4 v4, s[8:11], s21 offen offset:2048 lds
    v_add_f32 v8, v8, v97
    v_add_f32 v8, v8, v98
    s_waitcnt lgkmcnt(10)
    v_mfma_f32_32x32x16_bf16 a[160:175], v[40:43], v[64:67], a[160:175]
    s_add_u32 m0, s25, 4320
    s_nop 0
    buffer_load_dwordx4 v4, s[8:11], s21 offen offset:3072 lds
    v_add_f32 v8, v8, v99
    v_cvt_pk_bf16_f32 v96, v96, v97
    v_mfma_f32_32x32x16_bf16 a[176:191], v[40:43], v[80:83], a[176:191]
    s_add_u32 s20, s20, 16384
    s_add_u32 s21, s21, 16384
    v_cvt_pk_bf16_f32 v97, v98, v99
    v_cvt_pk_bf16_f32 v100, 0, v100
    v_cvt_pk_bf16_f32 v101, 0, v101
    s_waitcnt lgkmcnt(8)
    v_mfma_f32_32x32x16_bf16 a[160:175], v[44:47], v[68:71], a[160:175]
    v_cvt_pk_bf16_f32 v102, 0, v102
    v_cvt_pk_bf16_f32 v103, 0, v103
    v_fma_f32 v100, v100, s28, -v6
    v_fma_f32 v101, v101, s28, -v6
    v_fma_f32 v102, v102, s28, -v6
    v_mfma_f32_32x32x16_bf16 a[176:191], v[44:47], v[84:87], a[176:191]
    s_waitcnt vmcnt(16) lgkmcnt(0)
    s_barrier
    ds_read_b128 v[32:35], v1 offset:33792
    v_fma_f32 v103, v103, s28, -v6
    v_mfma_f32_32x32x16_bf16 a[192:207], v[48:51], v[64:67], a[192:207]
    v_exp_f32 v100, v100
    v_exp_f32 v101, v101
    v_mfma_f32_32x32x16_bf16 a[208:223], v[48:51], v[80:83], a[208:223]
    ds_read_b128 v[36:39], v1 offset:33824
    v_exp_f32 v102, v102
    v_exp_f32 v103, v103
    v_mfma_f32_32x32x16_bf16 a[192:207], v[52:55], v[68:71], a[192:207]
    v_add_f32 v8, v8, v100
    v_add_f32 v8, v8, v101
    v_add_f32 v8, v8, v102
    v_add_f32 v8, v8, v103
    v_cvt_pk_bf16_f32 v98, v100, v101
    v_mfma_f32_32x32x16_bf16 a[208:223], v[52:55], v[84:87], a[208:223]
    ds_read_b128 v[40:43], v1 offset:33856
    v_cvt_pk_bf16_f32 v99, v102, v103
    v_cvt_pk_bf16_f32 v104, 0, v104
    v_cvt_pk_bf16_f32 v105, 0, v105
    v_cvt_pk_bf16_f32 v106, 0, v106
    v_mfma_f32_32x32x16_bf16 a[224:239], v[56:59], v[64:67], a[224:239]
    v_cvt_pk_bf16_f32 v107, 0, v107
    v_fma_f32 v104, v104, s28, -v6
    v_fma_f32 v105, v105, s28, -v6
    v_fma_f32 v106, v106, s28, -v6
    v_fma_f32 v107, v107, s28, -v6
    v_mfma_f32_32x32x16_bf16 a[240:255], v[56:59], v[80:83], a[240:255]
    ds_read_b128 v[44:47], v1 offset:33888
    v_exp_f32 v104, v104
    v_exp_f32 v105, v105
    v_mfma_f32_32x32x16_bf16 a[224:239], v[60:63], v[68:71], a[224:239]
    v_exp_f32 v106, v106
    v_exp_f32 v107, v107
    v_add_f32 v8, v8, v104
    v_mfma_f32_32x32x16_bf16 a[240:255], v[60:63], v[84:87], a[240:255]
    s_cmp_eq_u32 s30, 0
    s_cbranch_scc1 NR_l1
    s_getpc_b64 s[32:33]
    s_add_u32 s32, s32, 12
    s_addc_u32 s33, s33, 0
    s_branch RESC
NR_l1:
    ds_read_b128 v[48:51], v1 offset:33920
    v_add_f32 v8, v8, v105
    v_add_f32 v8, v8, v106
    v_add_f32 v8, v8, v107
    v_cvt_pk_bf16_f32 v100, v104, v105
    s_waitcnt lgkmcnt(4)
    v_mfma_f32_32x32x16_bf16 v[64:79], v[32:35], v[128:131], 0
    s_add_u32 m0, s26, 0
    s_nop 0
    buffer_load_dwordx4 v5, s[12:15], s22 offen offset:0 lds
    v_cvt_pk_bf16_f32 v101, v106, v107
    v_cvt_pk_bf16_f32 v108, 0, v108
    v_mfma_f32_32x32x16_bf16 v[80:95], v[32:35], v[192:195], 0
    ds_read_b128 v[52:55], v1 offset:33952
    v_cvt_pk_bf16_f32 v109, 0, v109
    v_cvt_pk_bf16_f32 v110, 0, v110
    v_cvt_pk_bf16_f32 v111, 0, v111
    v_fma_f32 v108, v108, s28, -v6
    s_waitcnt lgkmcnt(4)
    v_mfma_f32_32x32x16_bf16 v[64:79], v[36:39], v[132:135], v[64:79]
    s_add_u32 m0, s26, 128
    s_nop 0
    buffer_load_dwordx4 v5, s[12:15], s22 offen offset:1024 lds
    v_fma_f32 v109, v109, s28, -v6
    v_fma_f32 v110, v110, s28, -v6
    v_mfma_f32_32x32x16_bf16 v[80:95], v[36:39], v[196:199], v[80:95]
    ds_read_b128 v[56:59], v1 offset:33984
    v_fma_f32 v111, v111, s28, -v6
    v_exp_f32 v108, v108
    s_waitcnt lgkmcnt(4)
    v_mfma_f32_32x32x16_bf16 v[64:79], v[40:43], v[136:139], v[64:79]
    s_add_u32 m0, s26, 256
    s_nop 0
    buffer_load_dwordx4 v5, s[12:15], s22 offen offset:2048 lds
    v_exp_f32 v109, v109
    v_mfma_f32_32x32x16_bf16 v[80:95], v[40:43], v[200:203], v[80:95]
    ds_read_b128 v[60:63], v1 offset:34016
    v_exp_f32 v110, v110
    v_exp_f32 v111, v111
    s_waitcnt lgkmcnt(4)
    v_mfma_f32_32x32x16_bf16 v[64:79], v[44:47], v[140:143], v[64:79]
    v_add_f32 v8, v8, v108
    v_add_f32 v8, v8, v109
    v_add_f32 v8, v8, v110
    v_add_f32 v8, v8, v111
    v_cvt_pk_bf16_f32 v102, v108, v109
    v_mfma_f32_32x32x16_bf16 v[80:95], v[44:47], v[204:207], v[80:95]
    ds_read_b128 v[32:35], v1 offset:34048
    v_cvt_pk_bf16_f32 v103, v110, v111
    v_cvt_pk_bf16_f32 v112, 0, v112
    v_cvt_pk_bf16_f32 v113, 0, v113
    v_cvt_pk_bf16_f32 v114, 0, v114
    s_waitcnt lgkmcnt(4)
    v_mfma_f32_32x32x16_bf16 v[64:79], v[48:51], v[144:147], v[64:79]
    s_add_u32 m0, s26, 384
    s_nop 0
    buffer_load_dwordx4 v5, s[12:15], s22 offen offset:3072 lds
    v_cvt_pk_bf16_f32 v115, 0, v115
    v_fma_f32 v112, v112, s28, -v7
    v_mfma_f32_32x32x16_bf16 v[80:95], v[48:51], v[208:211], v[80:95]
    ds_read_b128 v[36:39], v1 offset:34080
    v_fma_f32 v113, v113, s28, -v7
    v_fma_f32 v114, v114, s28, -v7
    v_fma_f32 v115, v115, s28, -v7
    s_waitcnt lgkmcnt(4)
    v_mfma_f32_32x32x16_bf16 v[64:79], v[52:55], v[148:151], v[64:79]
    s_add_u32 m0, s26, 4608
    s_nop 0
    buffer_load_dwordx4 v5, s[12:15], s23 offen offset:0 lds
    v_exp_f32 v112, v112
    v_mfma_f32_32x32x16_bf16 v[80:95], v[52:55], v[212:215], v[80:95]
    ds_read_b128 v[40:43], v1 offset:34112
    v_exp_f32 v113, v113
    v_exp_f32 v114, v114
    s_waitcnt lgkmcnt(4)
    v_mfma_f32_32x32x16_bf16 v[64:79], v[56:59], v[152:155], v[64:79]
    ds_read_b128 v[44:47], v1 offset:34144
    v_exp_f32 v115, v115
    v_add_f32 v9, v9, v112
    v_add_f32 v9, v9, v113
    v_mfma_f32_32x32x16_bf16 v[80:95], v[56:59], v[216:219], v[80:95]
    s_add_u32 m0, s26, 4736
    s_nop 0
    buffer_load_dwordx4 v5, s[12:15], s23 offen offset:1024 lds
    v_add_f32 v9, v9, v114
    v_add_f32 v9, v9, v115
    s_waitcnt lgkmcnt(4)
    v_mfma_f32_32x32x16_bf16 v[64:79], v[60:63], v[156:159], v[64:79]
    ds_read_b128 v[48:51], v1 offset:34176
    v_cvt_pk_bf16_f32 v112, v112, v113
    v_cvt_pk_bf16_f32 v113, v114, v115
    v_cvt_pk_bf16_f32 v116, 0, v116
    v_cvt_pk_bf16_f32 v117, 0, v117
    v_mfma_f32_32x32x16_bf16 v[80:95], v[60:63], v[220:223], v[80:95]
    ds_read_b128 v[52:55], v1 offset:34208
    v_cvt_pk_bf16_f32 v118, 0, v118
    v_cvt_pk_bf16_f32 v119, 0, v119
    v_fma_f32 v116, v116, s28, -v7
    v_fma_f32 v117, v117, s28, -v7
    s_waitcnt lgkmcnt(5)
    v_mfma_f32_32x32x16_bf16 v[64:79], v[32:35], v[160:163], v[64:79]
    v_fma_f32 v118, v118, s28, -v7
    v_fma_f32 v119, v119, s28, -v7
    v_exp_f32 v116, v116
    v_mfma_f32_32x32x16_bf16 v[80:95], v[32:35], v[224:227], v[80:95]
    ds_read_b128 v[56:59], v1 offset:34240
    v_exp_f32 v117, v117
    v_exp_f32 v118, v118
    s_waitcnt lgkmcnt(5)
    v_mfma_f32_32x32x16_bf16 v[64:79], v[36:39], v[164:167], v[64:79]
    ds_read_b128 v[60:63], v1 offset:34272
    v_exp_f32 v119, v119
    v_add_f32 v9, v9, v116
    v_add_f32 v9, v9, v117
    v_mfma_f32_32x32x16_bf16 v[80:95], v[36:39], v[228:231], v[80:95]
    s_add_u32 m0, s26, 4864
    s_nop 0
    buffer_load_dwordx4 v5, s[12:15], s23 offen offset:2048 lds
    v_add_f32 v9, v9, v118
    v_add_f32 v9, v9, v119
    s_waitcnt lgkmcnt(5)
    v_mfma_f32_32x32x16_bf16 v[64:79], v[40:43], v[168:171], v[64:79]
    s_add_u32 m0, s26, 4992
    s_nop 0
    buffer_load_dwordx4 v5, s[12:15], s23 offen offset:3072 lds
    v_cvt_pk_bf16_f32 v114, v116, v117
    v_cvt_pk_bf16_f32 v115, v118, v119
    v_mfma_f32_32x32x16_bf16 v[80:95], v[40:43], v[232:235], v[80:95]
    s_add_u32 s22, s22, 16384
    s_add_u32 s23, s23, 16384
    v_cvt_pk_bf16_f32 v120, 0, v120
    v_cvt_pk_bf16_f32 v121, 0, v121
    v_cvt_pk_bf16_f32 v122, 0, v122
    s_waitcnt lgkmcnt(4)
    v_mfma_f32_32x32x16_bf16 v[64:79], v[44:47], v[172:175], v[64:79]
    v_cvt_pk_bf16_f32 v123, 0, v123
    v_fma_f32 v120, v120, s28, -v7
    v_fma_f32 v121, v121, s28, -v7
    v_fma_f32 v122, v122, s28, -v7
    v_fma_f32 v123, v123, s28, -v7
    v_mfma_f32_32x32x16_bf16 v[80:95], v[44:47], v[236:239], v[80:95]
    s_waitcnt vmcnt(16) lgkmcnt(0)
    s_barrier
    ds_read_b64_tr_b16 v[32:33], v2 offset:18432
    ds_read_b64_tr_b16 v[34:35], v2 offset:23040
    v_mfma_f32_32x32x16_bf16 v[64:79], v[48:51], v[176:179], v[64:79]
    v_exp_f32 v120, v120
    v_exp_f32 v121, v121
    v_mfma_f32_32x32x16_bf16 v[80:95], v[48:51], v[240:243], v[80:95]
    ds_read_b64_tr_b16 v[36:37], v2 offset:27648
    ds_read_b64_tr_b16 v[38:39], v2 offset:32256
    v_exp_f32 v122, v122
    v_mfma_f32_32x32x16_bf16 v[64:79], v[52:55], v[180:183], v[64:79]
    v_exp_f32 v123, v123
    v_add_f32 v9, v9, v120
    v_add_f32 v9, v9, v121
    v_add_f32 v9, v9, v122
    v_mfma_f32_32x32x16_bf16 v[80:95], v[52:55], v[244:247], v[80:95]
    ds_read_b64_tr_b16 v[40:41], v3 offset:18496
    ds_read_b64_tr_b16 v[42:43], v3 offset:23104
    v_add_f32 v9, v9, v123
    v_cvt_pk_bf16_f32 v116, v120, v121
    v_cvt_pk_bf16_f32 v117, v122, v123
    v_mfma_f32_32x32x16_bf16 v[64:79], v[56:59], v[184:187], v[64:79]
    v_cvt_pk_bf16_f32 v124, 0, v124
    v_cvt_pk_bf16_f32 v125, 0, v125
    v_cvt_pk_bf16_f32 v126, 0, v126
    v_cvt_pk_bf16_f32 v127, 0, v127
    v_fma_f32 v124, v124, s28, -v7
    v_mfma_f32_32x32x16_bf16 v[80:95], v[56:59], v[248:251], v[80:95]
    ds_read_b64_tr_b16 v[44:45], v3 offset:27712
    ds_read_b64_tr_b16 v[46:47], v3 offset:32320
    v_fma_f32 v125, v125, s28, -v7
    v_fma_f32 v126, v126, s28, -v7
    v_fma_f32 v127, v127, s28, -v7
    v_mfma_f32_32x32x16_bf16 v[64:79], v[60:63], v[188:191], v[64:79]
    v_exp_f32 v124, v124
    v_exp_f32 v125, v125
    v_mfma_f32_32x32x16_bf16 v[80:95], v[60:63], v[252:255], v[80:95]
    v_exp_f32 v126, v126
    v_exp_f32 v127, v127
    v_add_f32 v9, v9, v124
    v_add_f32 v9, v9, v125
    v_add_f32 v9, v9, v126
    v_add_f32 v9, v9, v127
    v_cvt_pk_bf16_f32 v118, v124, v125
    v_cvt_pk_bf16_f32 v119, v126, v127
    ds_read_b64_tr_b16 v[48:49], v2 offset:18560
    ds_read_b64_tr_b16 v[50:51], v2 offset:23168
    s_waitcnt lgkmcnt(8)
    v_mfma_f32_32x32x16_bf16 a[0:15], v[32:35], v[96:99], a[0:15]
    s_add_u32 m0, s24, 0
    s_nop 0
    buffer_load_dwordx4 v4, s[8:11], s20 offen offset:0 lds
    v_mfma_f32_32x32x16_bf16 a[16:31], v[32:35], v[112:115], a[16:31]
    ds_read_b64_tr_b16 v[52:53], v2 offset:27776
    ds_read_b64_tr_b16 v[54:55], v2 offset:32384
    s_waitcnt lgkmcnt(8)
    v_mfma_f32_32x32x16_bf16 a[0:15], v[36:39], v[100:103], a[0:15]
    s_add_u32 m0, s24, 32
    s_nop 0
    buffer_load_dwordx4 v4, s[8:11], s20 offen offset:1024 lds
    v_max3_f32 v10, v64, v65, v66
    v_max3_f32 v11, v67, v68, v69
    v_mfma_f32_32x32x16_bf16 a[16:31], v[36:39], v[116:119], a[16:31]
    ds_read_b64_tr_b16 v[56:57], v3 offset:18624
    ds_read_b64_tr_b16 v[58:59], v3 offset:23232
    v_max3_f32 v12, v70, v71, v72
    v_max3_f32 v13, v73, v74, v75
    v_max3_f32 v10, v10, v76, v77
    s_waitcnt lgkmcnt(8)
    v_mfma_f32_32x32x16_bf16 a[32:47], v[40:43], v[96:99], a[32:47]
    s_add_u32 m0, s24, 64
    s_nop 0
    buffer_load_dwordx4 v4, s[8:11], s20 offen offset:2048 lds
    v_max3_f32 v11, v11, v78, v79
    v_max3_f32 v10, v10, v12, v13
    v_mfma_f32_32x32x16_bf16 a[48:63], v[40:43], v[112:115], a[48:63]
    ds_read_b64_tr_b16 v[60:61], v3 offset:27840
    ds_read_b64_tr_b16 v[62:63], v3 offset:32448
    v_max_f32 v10, v10, v11
    v_mov_b32 v11, v10
    v_max3_f32 v14, v80, v81, v82
    s_waitcnt lgkmcnt(8)
    v_mfma_f32_32x32x16_bf16 a[32:47], v[44:47], v[100:103], a[32:47]
    v_max3_f32 v15, v83, v84, v85
    v_max3_f32 v16, v86, v87, v88
    v_max3_f32 v17, v89, v90, v91
    v_max3_f32 v14, v14, v92, v93
    v_max3_f32 v15, v15, v94, v95
    v_mfma_f32_32x32x16_bf16 a[48:63], v[44:47], v[116:119], a[48:63]
    ds_read_b64_tr_b16 v[32:33], v2 offset:18688
    ds_read_b64_tr_b16 v[34:35], v2 offset:23296
    v_max3_f32 v14, v14, v16, v17
    v_max_f32 v14, v14, v15
    v_mov_b32 v15, v14
    s_waitcnt lgkmcnt(8)
    v_mfma_f32_32x32x16_bf16 a[64:79], v[48:51], v[96:99], a[64:79]
    s_add_u32 m0, s24, 96
    s_nop 0
    buffer_load_dwordx4 v4, s[8:11], s20 offen offset:3072 lds
    s_nop 0
    v_permlane32_swap_b32 v10, v11
    v_mfma_f32_32x32x16_bf16 a[80:95], v[48:51], v[112:115], a[80:95]
    ds_read_b64_tr_b16 v[36:37], v2 offset:27904
    ds_read_b64_tr_b16 v[38:39], v2 offset:32512
    v_permlane32_swap_b32 v14, v15
    s_nop 0
    v_max_f32 v10, v10, v11
    s_waitcnt lgkmcnt(8)
    v_mfma_f32_32x32x16_bf16 a[64:79], v[52:55], v[100:103], a[64:79]
    s_add_u32 m0, s24, 4224
    s_nop 0
    buffer_load_dwordx4 v4, s[8:11], s21 offen offset:0 lds
    v_max_f32 v14, v14, v15
    v_fma_f32 v12, v10, s28, -v6
    v_mfma_f32_32x32x16_bf16 a[80:95], v[52:55], v[116:119], a[80:95]
    ds_read_b64_tr_b16 v[40:41], v3 offset:18752
    ds_read_b64_tr_b16 v[42:43], v3 offset:23360
    v_fma_f32 v13, v14, s28, -v7
    v_max_f32 v12, v12, v13
    v_cmp_lt_f32 vcc, s29, v12
    s_waitcnt lgkmcnt(8)
    v_mfma_f32_32x32x16_bf16 a[96:111], v[56:59], v[96:99], a[96:111]
    ds_read_b64_tr_b16 v[44:45], v3 offset:27968
    ds_read_b64_tr_b16 v[46:47], v3 offset:32576
    s_nop 1
    s_cbranch_vccnz RB1_l0
RB1R_l0:
    v_cvt_pk_bf16_f32 v64, 0, v64
    v_mfma_f32_32x32x16_bf16 a[112:127], v[56:59], v[112:115], a[112:127]
    s_add_u32 m0, s24, 4256
    s_nop 0
    buffer_load_dwordx4 v4, s[8:11], s21 offen offset:1024 lds
    v_cvt_pk_bf16_f32 v65, 0, v65
    v_cvt_pk_bf16_f32 v66, 0, v66
    s_waitcnt lgkmcnt(8)
    v_mfma_f32_32x32x16_bf16 a[96:111], v[60:63], v[100:103], a[96:111]
    ds_read_b64_tr_b16 v[48:49], v2 offset:18816
    ds_read_b64_tr_b16 v[50:51], v2 offset:23424
    v_cvt_pk_bf16_f32 v67, 0, v67
    v_fma_f32 v64, v64, s28, -v6
    v_fma_f32 v65, v65, s28, -v6
    v_mfma_f32_32x32x16_bf16 a[112:127], v[60:63], v[116:119], a[112:127]
    ds_read_b64_tr_b16 v[52:53], v2 offset:28032
    ds_read_b64_tr_b16 v[54:55], v2 offset:32640
    v_fma_f32 v66, v66, s28, -v6
    v_fma_f32 v67, v67, s28, -v6
    s_waitcnt lgkmcnt(10)
    v_mfma_f32_32x32x16_bf16 a[128:143], v[32:35], v[96:99], a[128:143]
    v_exp_f32 v64, v64
    v_exp_f32 v65, v65
    v_mfma_f32_32x32x16_bf16 a[144:159], v[32:35], v[112:115], a[144:159]
    ds_read_b64_tr_b16 v[56:57], v3 offset:18880
    ds_read_b64_tr_b16 v[58:59], v3 offset:23488
    v_exp_f32 v66, v66
    s_waitcnt lgkmcnt(10)
    v_mfma_f32_32x32x16_bf16 a[128:143], v[36:39], v[100:103], a[128:143]
    ds_read_b64_tr_b16 v[60:61], v3 offset:28096
    ds_read_b64_tr_b16 v[62:63], v3 offset:32704
    v_exp_f32 v67, v67
    v_add_f32 v8, v8, v64
    v_mfma_f32_32x32x16_bf16 a[144:159], v[36:39], v[116:119], a[144:159]
    s_add_u32 m0, s24, 4288
    s_nop 0
    buffer_load_dwordx4 v4, s[8:11], s21 offen offset:2048 lds
    v_add_f32 v8, v8, v65
    v_add_f32 v8, v8, v66
    s_waitcnt lgkmcnt(10)
    v_mfma_f32_32x32x16_bf16 a[160:175], v[40:43], v[96:99], a[160:175]
    s_add_u32 m0, s24, 4320
    s_nop 0
    buffer_load_dwordx4 v4, s[8:11], s21 offen offset:3072 lds
    v_add_f32 v8, v8, v67
    v_cvt_pk_bf16_f32 v64, v64, v65
    v_mfma_f32_32x32x16_bf16 a[176:191], v[40:43], v[112:115], a[176:191]
    s_add_u32 s20, s20, 16384
    s_add_u32 s21, s21, 16384
    v_cvt_pk_bf16_f32 v65, v66, v67
    v_cvt_pk_bf16_f32 v68, 0, v68
    v_cvt_pk_bf16_f32 v69, 0, v69
    s_waitcnt lgkmcnt(8)
    v_mfma_f32_32x32x16_bf16 a[160:175], v[44:47], v[100:103], a[160:175]
    v_cvt_pk_bf16_f32 v70, 0, v70
    v_cvt_pk_bf16_f32 v71, 0, v71
    v_fma_f32 v68, v68, s28, -v6
    v_fma_f32 v69, v69, s28, -v6
    v_fma_f32 v70, v70, s28, -v6
    v_mfma_f32_32x32x16_bf16 a[176:191], v[44:47], v[116:119], a[176:191]
    s_waitcnt vmcnt(16) lgkmcnt(0)
    s_barrier
    ds_read_b128 v[32:35], v1 offset:0
    v_fma_f32 v71, v71, s28, -v6
    v_mfma_f32_32x32x16_bf16 a[192:207], v[48:51], v[96:99], a[192:207]
    v_exp_f32 v68, v68
    v_exp_f32 v69, v69
    v_mfma_f32_32x32x16_bf16 a[208:223], v[48:51], v[112:115], a[208:223]
    ds_read_b128 v[36:39], v1 offset:32
    v_exp_f32 v70, v70
    v_exp_f32 v71, v71
    v_mfma_f32_32x32x16_bf16 a[192:207], v[52:55], v[100:103], a[192:207]
    v_add_f32 v8, v8, v68
    v_add_f32 v8, v8, v69
    v_add_f32 v8, v8, v70
    v_add_f32 v8, v8, v71
    v_cvt_pk_bf16_f32 v66, v68, v69
    v_mfma_f32_32x32x16_bf16 a[208:223], v[52:55], v[116:119], a[208:223]
    ds_read_b128 v[40:43], v1 offset:64
    v_cvt_pk_bf16_f32 v67, v70, v71
    v_cvt_pk_bf16_f32 v72, 0, v72
    v_cvt_pk_bf16_f32 v73, 0, v73
    v_cvt_pk_bf16_f32 v74, 0, v74
    v_mfma_f32_32x32x16_bf16 a[224:239], v[56:59], v[96:99], a[224:239]
    v_cvt_pk_bf16_f32 v75, 0, v75
    v_fma_f32 v72, v72, s28, -v6
    v_fma_f32 v73, v73, s28, -v6
    v_fma_f32 v74, v74, s28, -v6
    v_fma_f32 v75, v75, s28, -v6
    v_mfma_f32_32x32x16_bf16 a[240:255], v[56:59], v[112:115], a[240:255]
    ds_read_b128 v[44:47], v1 offset:96
    v_exp_f32 v72, v72
    v_exp_f32 v73, v73
    v_mfma_f32_32x32x16_bf16 a[224:239], v[60:63], v[100:103], a[224:239]
    v_exp_f32 v74, v74
    v_exp_f32 v75, v75
    v_add_f32 v8, v8, v72
    v_mfma_f32_32x32x16_bf16 a[240:255], v[60:63], v[116:119], a[240:255]
    s_cmp_eq_u32 s30, 0
    s_cbranch_scc1 NR_l0
    s_getpc_b64 s[32:33]
    s_add_u32 s32, s32, 12
    s_addc_u32 s33, s33, 0
    s_branch RESC
NR_l0:
    ds_read_b128 v[48:51], v1 offset:128
    v_add_f32 v8, v8, v73
    v_add_f32 v8, v8, v74
    v_add_f32 v8, v8, v75
    v_cvt_pk_bf16_f32 v68, v72, v73
    s_waitcnt lgkmcnt(4)
    v_mfma_f32_32x32x16_bf16 v[96:111], v[32:35], v[128:131], 0
    s_add_u32 m0, s27, 0
    s_nop 0
    buffer_load_dwordx4 v5, s[12:15], s22 offen offset:0 lds
    v_cvt_pk_bf16_f32 v69, v74, v75
    v_cvt_pk_bf16_f32 v76, 0, v76
    v_mfma_f32_32x32x16_bf16 v[112:127], v[32:35], v[192:195], 0
    ds_read_b128 v[52:55], v1 offset:160
    v_cvt_pk_bf16_f32 v77, 0, v77
    v_cvt_pk_bf16_f32 v78, 0, v78
    v_cvt_pk_bf16_f32 v79, 0, v79
    v_fma_f32 v76, v76, s28, -v6
    s_waitcnt lgkmcnt(4)
    v_mfma_f32_32x32x16_bf16 v[96:111], v[36:39], v[132:135], v[96:111]
    s_add_u32 m0, s27, 128
    s_nop 0
    buffer_load_dwordx4 v5, s[12:15], s22 offen offset:1024 lds
    v_fma_f32 v77, v77, s28, -v6
    v_fma_f32 v78, v78, s28, -v6
    v_mfma_f32_32x32x16_bf16 v[112:127], v[36:39], v[196:199], v[112:127]
    ds_read_b128 v[56:59], v1 offset:192
    v_fma_f32 v79, v79, s28, -v6
    v_exp_f32 v76, v76
    s_waitcnt lgkmcnt(4)
    v_mfma_f32_32x32x16_bf16 v[96:111], v[40:43], v[136:139], v[96:111]
    s_add_u32 m0, s27, 256
    s_nop 0
    buffer_load_dwordx4 v5, s[12:15], s22 offen offset:2048 lds
    v_exp_f32 v77, v77
    v_mfma_f32_32x32x16_bf16 v[112:127], v[40:43], v[200:203], v[112:127]
    ds_read_b128 v[60:63], v1 offset:224
    v_exp_f32 v78, v78
    v_exp_f32 v79, v79
    s_waitcnt lgkmcnt(4)
    v_mfma_f32_32x32x16_bf16 v[96:111], v[44:47], v[140:143], v[96:111]
    v_add_f32 v8, v8, v76
    v_add_f32 v8, v8, v77
    v_add_f32 v8, v8, v78
    v_add_f32 v8, v8, v79
    v_cvt_pk_bf16_f32 v70, v76, v77
    v_mfma_f32_32x32x16_bf16 v[112:127], v[44:47], v[204:207], v[112:127]
    ds_read_b128 v[32:35], v1 offset:256
    v_cvt_pk_bf16_f32 v71, v78, v79
    v_cvt_pk_bf16_f32 v80, 0, v80
    v_cvt_pk_bf16_f32 v81, 0, v81
    v_cvt_pk_bf16_f32 v82, 0, v82
    s_waitcnt lgkmcnt(4)
    v_mfma_f32_32x32x16_bf16 v[96:111], v[48:51], v[144:147], v[96:111]
    s_add_u32 m0, s27, 384
    s_nop 0
    buffer_load_dwordx4 v5, s[12:15], s22 offen offset:3072 lds
    v_cvt_pk_bf16_f32 v83, 0, v83
    v_fma_f32 v80, v80, s28, -v7
    v_mfma_f32_32x32x16_bf16 v[112:127], v[48:51], v[208:211], v[112:127]
    ds_read_b128 v[36:39], v1 offset:288
    v_fma_f32 v81, v81, s28, -v7
    v_fma_f32 v82, v82, s28, -v7
    v_fma_f32 v83, v83, s28, -v7
    s_waitcnt lgkmcnt(4)
    v_mfma_f32_32x32x16_bf16 v[96:111], v[52:55], v[148:151], v[96:111]
    s_add_u32 m0, s27, 4608
    s_nop 0
    buffer_load_dwordx4 v5, s[12:15], s23 offen offset:0 lds
    v_exp_f32 v80, v80
    v_mfma_f32_32x32x16_bf16 v[112:127], v[52:55], v[212:215], v[112:127]
    ds_read_b128 v[40:43], v1 offset:320
    v_exp_f32 v81, v81
    v_exp_f32 v82, v82
    s_waitcnt lgkmcnt(4)
    v_mfma_f32_32x32x16_bf16 v[96:111], v[56:59], v[152:155], v[96:111]
    ds_read_b128 v[44:47], v1 offset:352
    v_exp_f32 v83, v83
    v_add_f32 v9, v9, v80
    v_add_f32 v9, v9, v81
    v_mfma_f32_32x32x16_bf16 v[112:127], v[56:59], v[216:219], v[112:127]
    s_add_u32 m0, s27, 4736
    s_nop 0
    buffer_load_dwordx4 v5, s[12:15], s23 offen offset:1024 lds
    v_add_f32 v9, v9, v82
    v_add_f32 v9, v9, v83
    s_waitcnt lgkmcnt(4)
    v_mfma_f32_32x32x16_bf16 v[96:111], v[60:63], v[156:159], v[96:111]
    ds_read_b128 v[48:51], v1 offset:384
    v_cvt_pk_bf16_f32 v80, v80, v81
    v_cvt_pk_bf16_f32 v81, v82, v83
    v_cvt_pk_bf16_f32 v84, 0, v84
    v_cvt_pk_bf16_f32 v85, 0, v85
    v_mfma_f32_32x32x16_bf16 v[112:127], v[60:63], v[220:223], v[112:127]
    ds_read_b128 v[52:55], v1 offset:416
    v_cvt_pk_bf16_f32 v86, 0, v86
    v_cvt_pk_bf16_f32 v87, 0, v87
    v_fma_f32 v84, v84, s28, -v7
    v_fma_f32 v85, v85, s28, -v7
    s_waitcnt lgkmcnt(5)
    v_mfma_f32_32x32x16_bf16 v[96:111], v[32:35], v[160:163], v[96:111]
    v_fma_f32 v86, v86, s28, -v7
    v_fma_f32 v87, v87, s28, -v7
    v_exp_f32 v84, v84
    v_mfma_f32_32x32x16_bf16 v[112:127], v[32:35], v[224:227], v[112:127]
    ds_read_b128 v[56:59], v1 offset:448
    v_exp_f32 v85, v85
    v_exp_f32 v86, v86
    s_waitcnt lgkmcnt(5)
    v_mfma_f32_32x32x16_bf16 v[96:111], v[36:39], v[164:167], v[96:111]
    ds_read_b128 v[60:63], v1 offset:480
    v_exp_f32 v87, v87
    v_add_f32 v9, v9, v84
    v_add_f32 v9, v9, v85
    v_mfma_f32_32x32x16_bf16 v[112:127], v[36:39], v[228:231], v[112:127]
    s_add_u32 m0, s27, 4864
    s_nop 0
    buffer_load_dwordx4 v5, s[12:15], s23 offen offset:2048 lds
    v_add_f32 v9, v9, v86
    v_add_f32 v9, v9, v87
    s_waitcnt lgkmcnt(5)
    v_mfma_f32_32x32x16_bf16 v[96:111], v[40:43], v[168:171], v[96:111]
    s_add_u32 m0, s27, 4992
    s_nop 0
    buffer_load_dwordx4 v5, s[12:15], s23 offen offset:3072 lds
    v_cvt_pk_bf16_f32 v82, v84, v85
    v_cvt_pk_bf16_f32 v83, v86, v87
    v_mfma_f32_32x32x16_bf16 v[112:127], v[40:43], v[232:235], v[112:127]
    s_add_u32 s22, s22, 16384
    s_add_u32 s23, s23, 16384
    v_cvt_pk_bf16_f32 v88, 0, v88
    v_cvt_pk_bf16_f32 v89, 0, v89
    v_cvt_pk_bf16_f32 v90, 0, v90
    s_waitcnt lgkmcnt(4)
    v_mfma_f32_32x32x16_bf16 v[96:111], v[44:47], v[172:175], v[96:111]
    v_cvt_pk_bf16_f32 v91, 0, v91
    v_fma_f32 v88, v88, s28, -v7
    v_fma_f32 v89, v89, s28, -v7
    v_fma_f32 v90, v90, s28, -v7
    v_fma_f32 v91, v91, s28, -v7
    v_mfma_f32_32x32x16_bf16 v[112:127], v[44:47], v[236:239], v[112:127]
    s_waitcnt vmcnt(16) lgkmcnt(0)
    s_barrier
    ds_read_b64_tr_b16 v[32:33], v2 offset:0
    ds_read_b64_tr_b16 v[34:35], v2 offset:4608
    v_mfma_f32_32x32x16_bf16 v[96:111], v[48:51], v[176:179], v[96:111]
    v_exp_f32 v88, v88
    v_exp_f32 v89, v89
    v_mfma_f32_32x32x16_bf16 v[112:127], v[48:51], v[240:243], v[112:127]
    ds_read_b64_tr_b16 v[36:37], v2 offset:9216
    ds_read_b64_tr_b16 v[38:39], v2 offset:13824
    v_exp_f32 v90, v90
    v_mfma_f32_32x32x16_bf16 v[96:111], v[52:55], v[180:183], v[96:111]
    v_exp_f32 v91, v91
    v_add_f32 v9, v9, v88
    v_add_f32 v9, v9, v89
    v_add_f32 v9, v9, v90
    v_mfma_f32_32x32x16_bf16 v[112:127], v[52:55], v[244:247], v[112:127]
    ds_read_b64_tr_b16 v[40:41], v3 offset:64
    ds_read_b64_tr_b16 v[42:43], v3 offset:4672
    v_add_f32 v9, v9, v91
    v_cvt_pk_bf16_f32 v84, v88, v89
    v_cvt_pk_bf16_f32 v85, v90, v91
    v_mfma_f32_32x32x16_bf16 v[96:111], v[56:59], v[184:187], v[96:111]
    v_cvt_pk_bf16_f32 v92, 0, v92
    v_cvt_pk_bf16_f32 v93, 0, v93
    v_cvt_pk_bf16_f32 v94, 0, v94
    v_cvt_pk_bf16_f32 v95, 0, v95
    v_fma_f32 v92, v92, s28, -v7
    v_mfma_f32_32x32x16_bf16 v[112:127], v[56:59], v[248:251], v[112:127]
    ds_read_b64_tr_b16 v[44:45], v3 offset:9280
    ds_read_b64_tr_b16 v[46:47], v3 offset:13888
    v_fma_f32 v93, v93, s28, -v7
    v_fma_f32 v94, v94, s28, -v7
    v_fma_f32 v95, v95, s28, -v7
    v_mfma_f32_32x32x16_bf16 v[96:111], v[60:63], v[188:191], v[96:111]
    v_exp_f32 v92, v92
    v_exp_f32 v93, v93
    v_mfma_f32_32x32x16_bf16 v[112:127], v[60:63], v[252:255], v[112:127]
    v_exp_f32 v94, v94
    v_exp_f32 v95, v95
    v_add_f32 v9, v9, v92
    v_add_f32 v9, v9, v93
    v_add_f32 v9, v9, v94
    v_add_f32 v9, v9, v95
    v_cvt_pk_bf16_f32 v86, v92, v93
    v_cvt_pk_bf16_f32 v87, v94, v95
    s_sub_u32 s31, s31, 1
    s_cmp_lg_u32 s31, 0
    s_cbranch_scc1 K3_LOOP
    s_add_u32 s44, s34, 0x400000
    s_addc_u32 s45, s35, 0
    s_mov_b32 s46, 0x380000
    s_mov_b32 s47, 0x00020000
    s_mul_i32 s56, s36, 3
    s_mul_i32 s52, s37, 448
    s_add_u32 s53, s52, s41
    s_add_u32 s53, s53, 12
    s_lshl_b32 s53, s53, 10
    s_add_u32 s52, s52, s56
    s_lshl_b32 s52, s52, 10
    ds_read_b64_tr_b16 v[48:49], v2 offset:128
    ds_read_b64_tr_b16 v[50:51], v2 offset:4736
    s_waitcnt lgkmcnt(8)
    v_mfma_f32_32x32x16_bf16 a[0:15], v[32:35], v[64:67], a[0:15]
    v_mfma_f32_32x32x16_bf16 a[16:31], v[32:35], v[80:83], a[16:31]
    ds_read_b64_tr_b16 v[52:53], v2 offset:9344
    ds_read_b64_tr_b16 v[54:55], v2 offset:13952
    s_waitcnt lgkmcnt(8)
    v_mfma_f32_32x32x16_bf16 a[0:15], v[36:39], v[68:71], a[0:15]
    v_max3_f32 v10, v96, v97, v98
    v_max3_f32 v11, v99, v100, v101
    v_max3_f32 v12, v102, v103, v104
    v_max3_f32 v13, v105, v106, v107
    v_max3_f32 v10, v10, v108, v109
    v_max3_f32 v11, v11, v110, v111
    v_max3_f32 v10, v10, v12, v13
    v_mfma_f32_32x32x16_bf16 a[16:31], v[36:39], v[84:87], a[16:31]
    ds_read_b64_tr_b16 v[56:57], v3 offset:192
    ds_read_b64_tr_b16 v[58:59], v3 offset:4800
    v_max_f32 v10, v10, v11
    v_mov_b32 v11, v10
    v_max3_f32 v14, v112, v113, v114
    v_max3_f32 v15, v115, v116, v117
    v_max3_f32 v16, v118, v119, v120
    s_waitcnt lgkmcnt(8)
    v_mfma_f32_32x32x16_bf16 a[32:47], v[40:43], v[64:67], a[32:47]
    v_max3_f32 v17, v121, v122, v123
    v_max3_f32 v14, v14, v124, v125
    v_max3_f32 v15, v15, v126, v127
    v_max3_f32 v14, v14, v16, v17
    v_max_f32 v14, v14, v15
    v_mov_b32 v15, v14
    s_nop 0
    v_mfma_f32_32x32x16_bf16 a[48:63], v[40:43], v[80:83], a[48:63]
    ds_read_b64_tr_b16 v[60:61], v3 offset:9408
    ds_read_b64_tr_b16 v[62:63], v3 offset:14016
    v_permlane32_swap_b32 v10, v11
    v_permlane32_swap_b32 v14, v15
    s_nop 0
    v_max_f32 v10, v10, v11
    v_max_f32 v14, v14, v15
    s_waitcnt lgkmcnt(8)
    v_mfma_f32_32x32x16_bf16 a[32:47], v[44:47], v[68:71], a[32:47]
    v_fma_f32 v12, v10, s28, -v6
    v_fma_f32 v13, v14, s28, -v7
    v_max_f32 v12, v12, v13
    v_cmp_lt_f32 vcc, s29, v12
    s_nop 1
    s_cbranch_vccnz RB1_t
RB1R_t:
    v_cvt_pk_bf16_f32 v96, 0, v96
    v_mfma_f32_32x32x16_bf16 a[48:63], v[44:47], v[84:87], a[48:63]
    ds_read_b64_tr_b16 v[32:33], v2 offset:256
    ds_read_b64_tr_b16 v[34:35], v2 offset:4864
    v_cvt_pk_bf16_f32 v97, 0, v97
    v_cvt_pk_bf16_f32 v98, 0, v98
    v_cvt_pk_bf16_f32 v99, 0, v99
    v_fma_f32 v96, v96, s28, -v6
    v_fma_f32 v97, v97, s28, -v6
    s_waitcnt lgkmcnt(8)
    v_mfma_f32_32x32x16_bf16 a[64:79], v[48:51], v[64:67], a[64:79]
    v_fma_f32 v98, v98, s28, -v6
    v_fma_f32 v99, v99, s28, -v6
    v_exp_f32 v96, v96
    v_exp_f32 v97, v97
    v_mfma_f32_32x32x16_bf16 a[80:95], v[48:51], v[80:83], a[80:95]
    ds_read_b64_tr_b16 v[36:37], v2 offset:9472
    ds_read_b64_tr_b16 v[38:39], v2 offset:14080
    v_exp_f32 v98, v98
    v_exp_f32 v99, v99
    v_add_f32 v8, v8, v96
    s_waitcnt lgkmcnt(8)
    v_mfma_f32_32x32x16_bf16 a[64:79], v[52:55], v[68:71], a[64:79]
    v_add_f32 v8, v8, v97
    v_add_f32 v8, v8, v98
    v_add_f32 v8, v8, v99
    v_cvt_pk_bf16_f32 v96, v96, v97
    v_cvt_pk_bf16_f32 v97, v98, v99
    v_cvt_pk_bf16_f32 v100, 0, v100
    v_cvt_pk_bf16_f32 v101, 0, v101
    v_mfma_f32_32x32x16_bf16 a[80:95], v[52:55], v[84:87], a[80:95]
    ds_read_b64_tr_b16 v[40:41], v3 offset:320
    ds_read_b64_tr_b16 v[42:43], v3 offset:4928
    v_cvt_pk_bf16_f32 v102, 0, v102
    v_cvt_pk_bf16_f32 v103, 0, v103
    v_fma_f32 v100, v100, s28, -v6
    v_fma_f32 v101, v101, s28, -v6
    v_fma_f32 v102, v102, s28, -v6
    s_waitcnt lgkmcnt(8)
    v_mfma_f32_32x32x16_bf16 a[96:111], v[56:59], v[64:67], a[96:111]
    ds_read_b64_tr_b16 v[44:45], v3 offset:9536
    ds_read_b64_tr_b16 v[46:47], v3 offset:14144
    v_fma_f32 v103, v103, s28, -v6
    v_exp_f32 v100, v100
    v_exp_f32 v101, v101
    v_mfma_f32_32x32x16_bf16 a[112:127], v[56:59], v[80:83], a[112:127]
    v_exp_f32 v102, v102
    v_exp_f32 v103, v103
    v_add_f32 v8, v8, v100
    v_add_f32 v8, v8, v101
    v_add_f32 v8, v8, v102
    s_waitcnt lgkmcnt(8)
    v_mfma_f32_32x32x16_bf16 a[96:111], v[60:63], v[68:71], a[96:111]
    ds_read_b64_tr_b16 v[48:49], v2 offset:384
    ds_read_b64_tr_b16 v[50:51], v2 offset:4992
    v_add_f32 v8, v8, v103
    v_cvt_pk_bf16_f32 v98, v100, v101
    v_cvt_pk_bf16_f32 v99, v102, v103
    v_cvt_pk_bf16_f32 v104, 0, v104
    v_cvt_pk_bf16_f32 v105, 0, v105
    v_mfma_f32_32x32x16_bf16 a[112:127], v[60:63], v[84:87], a[112:127]
    ds_read_b64_tr_b16 v[52:53], v2 offset:9600
    ds_read_b64_tr_b16 v[54:55], v2 offset:14208
    v_cvt_pk_bf16_f32 v106, 0, v106
    v_cvt_pk_bf16_f32 v107, 0, v107
    v_fma_f32 v104, v104, s28, -v6
    v_fma_f32 v105, v105, s28, -v6
    v_fma_f32 v106, v106, s28, -v6
    s_waitcnt lgkmcnt(10)
    v_mfma_f32_32x32x16_bf16 a[128:143], v[32:35], v[64:67], a[128:143]
    v_fma_f32 v107, v107, s28, -v6
    v_exp_f32 v104, v104
    v_exp_f32 v105, v105
    v_exp_f32 v106, v106
    v_mfma_f32_32x32x16_bf16 a[144:159], v[32:35], v[80:83], a[144:159]
    ds_read_b64_tr_b16 v[56:57], v3 offset:448
    ds_read_b64_tr_b16 v[58:59], v3 offset:5056
    v_exp_f32 v107, v107
    v_add_f32 v8, v8, v104
    v_add_f32 v8, v8, v105
    v_add_f32 v8, v8, v106
    s_waitcnt lgkmcnt(10)
    v_mfma_f32_32x32x16_bf16 a[128:143], v[36:39], v[68:71], a[128:143]
    ds_read_b64_tr_b16 v[60:61], v3 offset:9664
    ds_read_b64_tr_b16 v[62:63], v3 offset:14272
    v_add_f32 v8, v8, v107
    v_cvt_pk_bf16_f32 v100, v104, v105
    v_cvt_pk_bf16_f32 v101, v106, v107
    v_cvt_pk_bf16_f32 v108, 0, v108
    v_cvt_pk_bf16_f32 v109, 0, v109
    v_mfma_f32_32x32x16_bf16 a[144:159], v[36:39], v[84:87], a[144:159]
    v_cvt_pk_bf16_f32 v110, 0, v110
    v_cvt_pk_bf16_f32 v111, 0, v111
    v_fma_f32 v108, v108, s28, -v6
    v_fma_f32 v109, v109, s28, -v6
    v_fma_f32 v110, v110, s28, -v6
    v_fma_f32 v111, v111, s28, -v6
    s_waitcnt lgkmcnt(10)
    v_mfma_f32_32x32x16_bf16 a[160:175], v[40:43], v[64:67], a[160:175]
    v_exp_f32 v108, v108
    v_exp_f32 v109, v109
    v_exp_f32 v110, v110
    v_mfma_f32_32x32x16_bf16 a[176:191], v[40:43], v[80:83], a[176:191]
    v_exp_f32 v111, v111
    v_add_f32 v8, v8, v108
    v_add_f32 v8, v8, v109
    v_add_f32 v8, v8, v110
    v_add_f32 v8, v8, v111
    v_cvt_pk_bf16_f32 v102, v108, v109
    s_waitcnt lgkmcnt(8)
    v_mfma_f32_32x32x16_bf16 a[160:175], v[44:47], v[68:71], a[160:175]
    v_cvt_pk_bf16_f32 v103, v110, v111
    v_cvt_pk_bf16_f32 v112, 0, v112
    v_cvt_pk_bf16_f32 v113, 0, v113
    v_cvt_pk_bf16_f32 v114, 0, v114
    v_cvt_pk_bf16_f32 v115, 0, v115
    v_fma_f32 v112, v112, s28, -v7
    v_fma_f32 v113, v113, s28, -v7
    v_mfma_f32_32x32x16_bf16 a[176:191], v[44:47], v[84:87], a[176:191]
    s_waitcnt vmcnt(0) lgkmcnt(0)
    s_barrier
    ds_read_b64_tr_b16 v[32:33], v2 offset:18432
    ds_read_b64_tr_b16 v[34:35], v2 offset:23040
    v_fma_f32 v114, v114, s28, -v7
    v_fma_f32 v115, v115, s28, -v7
    v_mfma_f32_32x32x16_bf16 a[192:207], v[48:51], v[64:67], a[192:207]
    v_exp_f32 v112, v112
    v_exp_f32 v113, v113
    v_exp_f32 v114, v114
    v_mfma_f32_32x32x16_bf16 a[208:223], v[48:51], v[80:83], a[208:223]
    ds_read_b64_tr_b16 v[36:37], v2 offset:27648
    ds_read_b64_tr_b16 v[38:39], v2 offset:32256
    v_exp_f32 v115, v115
    v_add_f32 v9, v9, v112
    v_add_f32 v9, v9, v113
    v_add_f32 v9, v9, v114
    v_mfma_f32_32x32x16_bf16 a[192:207], v[52:55], v[68:71], a[192:207]
    v_add_f32 v9, v9, v115
    v_cvt_pk_bf16_f32 v112, v112, v113
    v_cvt_pk_bf16_f32 v113, v114, v115
    v_cvt_pk_bf16_f32 v116, 0, v116
    v_cvt_pk_bf16_f32 v117, 0, v117
    v_cvt_pk_bf16_f32 v118, 0, v118
    v_cvt_pk_bf16_f32 v119, 0, v119
    v_mfma_f32_32x32x16_bf16 a[208:223], v[52:55], v[84:87], a[208:223]
    ds_read_b64_tr_b16 v[40:41], v3 offset:18496
    ds_read_b64_tr_b16 v[42:43], v3 offset:23104
    v_fma_f32 v116, v116, s28, -v7
    v_fma_f32 v117, v117, s28, -v7
    v_fma_f32 v118, v118, s28, -v7
    v_fma_f32 v119, v119, s28, -v7
    v_mfma_f32_32x32x16_bf16 a[224:239], v[56:59], v[64:67], a[224:239]
    v_exp_f32 v116, v116
    v_exp_f32 v117, v117
    v_exp_f32 v118, v118
    v_mfma_f32_32x32x16_bf16 a[240:255], v[56:59], v[80:83], a[240:255]
    ds_read_b64_tr_b16 v[44:45], v3 offset:27712
    ds_read_b64_tr_b16 v[46:47], v3 offset:32320
    v_exp_f32 v119, v119
    v_add_f32 v9, v9, v116
    v_add_f32 v9, v9, v117
    v_add_f32 v9, v9, v118
    v_mfma_f32_32x32x16_bf16 a[224:239], v[60:63], v[68:71], a[224:239]
    v_add_f32 v9, v9, v119
    v_cvt_pk_bf16_f32 v114, v116, v117
    v_cvt_pk_bf16_f32 v115, v118, v119
    v_cvt_pk_bf16_f32 v120, 0, v120
    v_cvt_pk_bf16_f32 v121, 0, v121
    v_cvt_pk_bf16_f32 v122, 0, v122
    v_cvt_pk_bf16_f32 v123, 0, v123
    v_mfma_f32_32x32x16_bf16 a[240:255], v[60:63], v[84:87], a[240:255]
    v_fma_f32 v120, v120, s28, -v7
    v_fma_f32 v121, v121, s28, -v7
    v_fma_f32 v122, v122, s28, -v7
    v_fma_f32 v123, v123, s28, -v7
    v_exp_f32 v120, v120
    v_exp_f32 v121, v121
    v_exp_f32 v122, v122
    v_exp_f32 v123, v123
    v_add_f32 v9, v9, v120
    v_add_f32 v9, v9, v121
    v_add_f32 v9, v9, v122
    v_add_f32 v9, v9, v123
    v_cvt_pk_bf16_f32 v116, v120, v121
    v_cvt_pk_bf16_f32 v117, v122, v123
    v_cvt_pk_bf16_f32 v124, 0, v124
    v_cvt_pk_bf16_f32 v125, 0, v125
    v_cvt_pk_bf16_f32 v126, 0, v126
    v_cvt_pk_bf16_f32 v127, 0, v127
    v_fma_f32 v124, v124, s28, -v7
    v_fma_f32 v125, v125, s28, -v7
    v_fma_f32 v126, v126, s28, -v7
    v_fma_f32 v127, v127, s28, -v7
    v_exp_f32 v124, v124
    v_exp_f32 v125, v125
    v_exp_f32 v126, v126
    v_exp_f32 v127, v127
    v_add_f32 v9, v9, v124
    v_add_f32 v9, v9, v125
    v_add_f32 v9, v9, v126
    v_add_f32 v9, v9, v127
    v_cvt_pk_bf16_f32 v118, v124, v125
    v_cvt_pk_bf16_f32 v119, v126, v127
    s_nop 1
    s_cmp_eq_u32 s30, 0
    s_cbranch_scc1 NR_t
    s_getpc_b64 s[32:33]
    s_add_u32 s32, s32, 12
    s_addc_u32 s33, s33, 0
    s_branch RESC
NR_t:
    ds_read_b64_tr_b16 v[48:49], v2 offset:18560
    ds_read_b64_tr_b16 v[50:51], v2 offset:23168
    s_waitcnt lgkmcnt(8)
    v_mfma_f32_32x32x16_bf16 a[0:15], v[32:35], v[96:99], a[0:15]
    s_add_u32 s3, s52, 0
    buffer_load_dwordx4 v[128:131], v21, s[44:47], s3 offen
    s_add_u32 s3, s52, 14336
    buffer_load_dwordx4 v[132:135], v21, s[44:47], s3 offen
    s_add_u32 s3, s52, 28672
    buffer_load_dwordx4 v[136:139], v21, s[44:47], s3 offen
    s_add_u32 s3, s52, 43008
    buffer_load_dwordx4 v[140:143], v21, s[44:47], s3 offen
    v_mfma_f32_32x32x16_bf16 a[16:31], v[32:35], v[112:115], a[16:31]
    ds_read_b64_tr_b16 v[52:53], v2 offset:27776
    ds_read_b64_tr_b16 v[54:55], v2 offset:32384
    s_waitcnt lgkmcnt(8)
    v_mfma_f32_32x32x16_bf16 a[0:15], v[36:39], v[100:103], a[0:15]
    s_add_u32 s3, s52, 57344
    buffer_load_dwordx4 v[144:147], v21, s[44:47], s3 offen
    s_add_u32 s3, s52, 71680
    buffer_load_dwordx4 v[148:151], v21, s[44:47], s3 offen
    s_add_u32 s3, s52, 86016
    buffer_load_dwordx4 v[152:155], v21, s[44:47], s3 offen
    s_add_u32 s3, s52, 100352
    buffer_load_dwordx4 v[156:159], v21, s[44:47], s3 offen
    v_mfma_f32_32x32x16_bf16 a[16:31], v[36:39], v[116:119], a[16:31]
    ds_read_b64_tr_b16 v[56:57], v3 offset:18624
    ds_read_b64_tr_b16 v[58:59], v3 offset:23232
    s_waitcnt lgkmcnt(8)
    v_mfma_f32_32x32x16_bf16 a[32:47], v[40:43], v[96:99], a[32:47]
    v_mfma_f32_32x32x16_bf16 a[48:63], v[40:43], v[112:115], a[48:63]
    ds_read_b64_tr_b16 v[60:61], v3 offset:27840
    ds_read_b64_tr_b16 v[62:63], v3 offset:32448
    s_waitcnt lgkmcnt(8)
    v_mfma_f32_32x32x16_bf16 a[32:47], v[44:47], v[100:103], a[32:47]
    s_add_u32 s3, s52, 114688
    buffer_load_dwordx4 v[160:163], v21, s[44:47], s3 offen
    s_add_u32 s3, s52, 129024
    buffer_load_dwordx4 v[164:167], v21, s[44:47], s3 offen
    s_add_u32 s3, s52, 143360
    buffer_load_dwordx4 v[168:171], v21, s[44:47], s3 offen
    s_add_u32 s3, s52, 157696
    buffer_load_dwordx4 v[172:175], v21, s[44:47], s3 offen
    v_mfma_f32_32x32x16_bf16 a[48:63], v[44:47], v[116:119], a[48:63]
    ds_read_b64_tr_b16 v[32:33], v2 offset:18688
    ds_read_b64_tr_b16 v[34:35], v2 offset:23296
    s_waitcnt lgkmcnt(8)
    v_mfma_f32_32x32x16_bf16 a[64:79], v[48:51], v[96:99], a[64:79]
    v_mfma_f32_32x32x16_bf16 a[80:95], v[48:51], v[112:115], a[80:95]
    ds_read_b64_tr_b16 v[36:37], v2 offset:27904
    ds_read_b64_tr_b16 v[38:39], v2 offset:32512
    s_waitcnt lgkmcnt(8)
    v_mfma_f32_32x32x16_bf16 a[64:79], v[52:55], v[100:103], a[64:79]
    s_add_u32 s3, s52, 172032
    buffer_load_dwordx4 v[176:179], v21, s[44:47], s3 offen
    s_add_u32 s3, s52, 186368
    buffer_load_dwordx4 v[180:183], v21, s[44:47], s3 offen
    s_add_u32 s3, s52, 200704
    buffer_load_dwordx4 v[184:187], v21, s[44:47], s3 offen
    s_add_u32 s3, s52, 215040
    buffer_load_dwordx4 v[188:191], v21, s[44:47], s3 offen
    v_mfma_f32_32x32x16_bf16 a[80:95], v[52:55], v[116:119], a[80:95]
    ds_read_b64_tr_b16 v[40:41], v3 offset:18752
    ds_read_b64_tr_b16 v[42:43], v3 offset:23360
    s_waitcnt lgkmcnt(8)
    v_mfma_f32_32x32x16_bf16 a[96:111], v[56:59], v[96:99], a[96:111]
    ds_read_b64_tr_b16 v[44:45], v3 offset:27968
    ds_read_b64_tr_b16 v[46:47], v3 offset:32576
    v_mfma_f32_32x32x16_bf16 a[112:127], v[56:59], v[112:115], a[112:127]
    s_add_u32 s3, s52, 229376
    buffer_load_dwordx4 v[192:195], v21, s[44:47], s3 offen
    s_add_u32 s3, s52, 243712
    buffer_load_dwordx4 v[196:199], v21, s[44:47], s3 offen
    s_add_u32 s3, s52, 258048
    buffer_load_dwordx4 v[200:203], v21, s[44:47], s3 offen
    s_add_u32 s3, s52, 272384
    buffer_load_dwordx4 v[204:207], v21, s[44:47], s3 offen
    s_waitcnt lgkmcnt(8)
    v_mfma_f32_32x32x16_bf16 a[96:111], v[60:63], v[100:103], a[96:111]
    ds_read_b64_tr_b16 v[48:49], v2 offset:18816
    ds_read_b64_tr_b16 v[50:51], v2 offset:23424
    v_mfma_f32_32x32x16_bf16 a[112:127], v[60:63], v[116:119], a[112:127]
    ds_read_b64_tr_b16 v[52:53], v2 offset:28032
    ds_read_b64_tr_b16 v[54:55], v2 offset:32640
    s_waitcnt lgkmcnt(10)
    v_mfma_f32_32x32x16_bf16 a[128:143], v[32:35], v[96:99], a[128:143]
    v_mfma_f32_32x32x16_bf16 a[144:159], v[32:35], v[112:115], a[144:159]
    ds_read_b64_tr_b16 v[56:57], v3 offset:18880
    ds_read_b64_tr_b16 v[58:59], v3 offset:23488
    s_waitcnt lgkmcnt(10)
    v_mfma_f32_32x32x16_bf16 a[128:143], v[36:39], v[100:103], a[128:143]
    ds_read_b64_tr_b16 v[60:61], v3 offset:28096
    ds_read_b64_tr_b16 v[62:63], v3 offset:32704
    v_mfma_f32_32x32x16_bf16 a[144:159], v[36:39], v[116:119], a[144:159]
    s_add_u32 s3, s52, 286720
    buffer_load_dwordx4 v[208:211], v21, s[44:47], s3 offen
    s_add_u32 s3, s52, 301056
    buffer_load_dwordx4 v[212:215], v21, s[44:47], s3 offen
    s_add_u32 s3, s52, 315392
    buffer_load_dwordx4 v[216:219], v21, s[44:47], s3 offen
    s_add_u32 s3, s52, 329728
    buffer_load_dwordx4 v[220:223], v21, s[44:47], s3 offen
    s_waitcnt lgkmcnt(10)
    v_mfma_f32_32x32x16_bf16 a[160:175], v[40:43], v[96:99], a[160:175]
    v_mfma_f32_32x32x16_bf16 a[176:191], v[40:43], v[112:115], a[176:191]
    s_add_u32 s3, s52, 344064
    buffer_load_dwordx4 v[224:227], v21, s[44:47], s3 offen
    s_add_u32 s3, s52, 358400
    buffer_load_dwordx4 v[228:231], v21, s[44:47], s3 offen
    s_add_u32 s3, s52, 372736
    buffer_load_dwordx4 v[232:235], v21, s[44:47], s3 offen
    s_add_u32 s3, s52, 387072
    buffer_load_dwordx4 v[236:239], v21, s[44:47], s3 offen
    s_waitcnt lgkmcnt(8)
    v_mfma_f32_32x32x16_bf16 a[160:175], v[44:47], v[100:103], a[160:175]
    v_mfma_f32_32x32x16_bf16 a[176:191], v[44:47], v[116:119], a[176:191]
    s_waitcnt lgkmcnt(6)
    v_mfma_f32_32x32x16_bf16 a[192:207], v[48:51], v[96:99], a[192:207]
    v_mfma_f32_32x32x16_bf16 a[208:223], v[48:51], v[112:115], a[208:223]
    s_waitcnt lgkmcnt(4)
    v_mfma_f32_32x32x16_bf16 a[192:207], v[52:55], v[100:103], a[192:207]
    v_mfma_f32_32x32x16_bf16 a[208:223], v[52:55], v[116:119], a[208:223]
    s_waitcnt lgkmcnt(2)
    v_mfma_f32_32x32x16_bf16 a[224:239], v[56:59], v[96:99], a[224:239]
    v_mfma_f32_32x32x16_bf16 a[240:255], v[56:59], v[112:115], a[240:255]
    s_waitcnt lgkmcnt(0)
    v_mfma_f32_32x32x16_bf16 a[224:239], v[60:63], v[100:103], a[224:239]
    v_mfma_f32_32x32x16_bf16 a[240:255], v[60:63], v[116:119], a[240:255]
    v_mov_b32 v10, v8
    v_mov_b32 v11, v9
    s_lshl_b32 s3, s36, 10
    v_permlane32_swap_b32 v8, v10
    v_permlane32_swap_b32 v9, v11
    s_add_u32 s3, s3, 131072
    v_add_u32 v26, s3, v21
    v_add_f32 v8, v8, v10
    v_add_f32 v9, v9, v11
    s_xor_b32 s3, s3, 2048
    v_add_u32 v27, s3, v21
    ds_write_b128 v26, v[6:9]
    s_lshl_b32 s3, s36, 15
    v_add_u32 v24, s3, v21
    s_xor_b32 s3, s3, 65536
    v_add_u32 v25, s3, v21
    s_nop 7
    s_barrier
    s_cmp_eq_u32 s41, 0
    s_cbranch_scc0 EPI1
    ds_write_b128 v24, a[128:131] offset:0
    ds_write_b128 v24, a[132:135] offset:1024
    ds_write_b128 v24, a[136:139] offset:2048
    ds_write_b128 v24, a[140:143] offset:3072
    ds_write_b128 v24, a[144:147] offset:4096
    ds_write_b128 v24, a[148:151] offset:5120
    ds_write_b128 v24, a[152:155] offset:6144
    ds_write_b128 v24, a[156:159] offset:7168
    ds_write_b128 v24, a[160:163] offset:8192
    ds_write_b128 v24, a[164:167] offset:9216
    ds_write_b128 v24, a[168:171] offset:10240
    ds_write_b128 v24, a[172:175] offset:11264
    ds_write_b128 v24, a[176:179] offset:12288
    ds_write_b128 v24, a[180:183] offset:13312
    ds_write_b128 v24, a[184:187] offset:14336
    ds_write_b128 v24, a[188:191] offset:15360
    ds_write_b128 v24, a[192:195] offset:16384
    ds_write_b128 v24, a[196:199] offset:17408
    ds_write_b128 v24, a[200:203] offset:18432
    ds_write_b128 v24, a[204:207] offset:19456
    ds_write_b128 v24, a[208:211] offset:20480
    ds_write_b128 v24, a[212:215] offset:21504
    ds_write_b128 v24, a[216:219] offset:22528
    ds_write_b128 v24, a[220:223] offset:23552
    ds_write_b128 v24, a[224:227] offset:24576
    ds_write_b128 v24, a[228:231] offset:25600
    ds_write_b128 v24, a[232:235] offset:26624
    ds_write_b128 v24, a[236:239] offset:27648
    ds_write_b128 v24, a[240:243] offset:28672
    ds_write_b128 v24, a[244:247] offset:29696
    ds_write_b128 v24, a[248:251] offset:30720
    ds_write_b128 v24, a[252:255] offset:31744
    s_waitcnt lgkmcnt(0)
    s_barrier
    ds_read_b128 v[12:15], v27
    ds_read_b128 v[64:67], v25 offset:0
    ds_read_b128 v[68:71], v25 offset:1024
    ds_read_b128 v[72:75], v25 offset:2048
    ds_read_b128 v[76:79], v25 offset:3072
    ds_read_b128 v[80:83], v25 offset:4096
    ds_read_b128 v[84:87], v25 offset:5120
    ds_read_b128 v[88:91], v25 offset:6144
    ds_read_b128 v[92:95], v25 offset:7168
    ds_read_b128 v[96:99], v25 offset:8192
    ds_read_b128 v[100:103], v25 offset:9216
    ds_read_b128 v[104:107], v25 offset:10240
    ds_read_b128 v[108:111], v25 offset:11264
    s_waitcnt lgkmcnt(12)
    v_max_f32 v10, v6, v12
    v_sub_f32 v11, v6, v10
    v_sub_f32 v10, v12, v10
    v_exp_f32 v11, v11
    v_exp_f32 v10, v10
    s_nop 0
    v_mul_f32 v28, v10, v14
    v_fma_f32 v28, v11, v8, v28
    v_rcp_f32 v29, v28
    s_nop 0
    v_mul_f32 v30, v10, v29
    v_mul_f32 v31, v10, v29
    v_mul_f32 v28, v11, v29
    v_mul_f32 v29, v11, v29
    v_max_f32 v10, v7, v13
    v_sub_f32 v11, v7, v10
    v_sub_f32 v10, v13, v10
    v_exp_f32 v11, v11
    v_exp_f32 v10, v10
    s_nop 0
    v_mul_f32 v16, v10, v15
    v_fma_f32 v16, v11, v9, v16
    v_rcp_f32 v17, v16
    s_nop 0
    v_mul_f32 v18, v10, v17
    v_mul_f32 v19, v10, v17
    v_mul_f32 v16, v11, v17
    v_mul_f32 v17, v11, v17
    ds_read_b128 v[112:115], v25 offset:12288
    ds_read_b128 v[116:119], v25 offset:13312
    ds_read_b128 v[120:123], v25 offset:14336
    ds_read_b128 v[124:127], v25 offset:15360
    v_accvgpr_read_b32 v32, a0
    v_accvgpr_read_b32 v33, a1
    v_accvgpr_read_b32 v34, a2
    v_accvgpr_read_b32 v35, a3
    v_accvgpr_read_b32 v36, a4
    v_accvgpr_read_b32 v37, a5
    v_accvgpr_read_b32 v38, a6
    v_accvgpr_read_b32 v39, a7
    v_accvgpr_read_b32 v40, a8
    v_accvgpr_read_b32 v41, a9
    v_accvgpr_read_b32 v42, a10
    v_accvgpr_read_b32 v43, a11
    v_accvgpr_read_b32 v44, a12
    v_accvgpr_read_b32 v45, a13
    v_accvgpr_read_b32 v46, a14
    v_accvgpr_read_b32 v47, a15
    v_pk_mul_f32 v[32:33], v[32:33], v[28:29]
    v_pk_mul_f32 v[34:35], v[34:35], v[28:29]
    v_pk_mul_f32 v[36:37], v[36:37], v[28:29]
    v_pk_mul_f32 v[38:39], v[38:39], v[28:29]
    v_pk_mul_f32 v[40:41], v[40:41], v[28:29]
    v_pk_mul_f32 v[42:43], v[42:43], v[28:29]
    v_pk_mul_f32 v[44:45], v[44:45], v[28:29]
    v_pk_mul_f32 v[46:47], v[46:47], v[28:29]
    s_waitcnt lgkmcnt(12)
    v_pk_fma_f32 v[32:33], v[64:65], v[30:31], v[32:33]
    v_pk_fma_f32 v[34:35], v[66:67], v[30:31], v[34:35]
    v_pk_fma_f32 v[36:37], v[68:69], v[30:31], v[36:37]
    v_pk_fma_f32 v[38:39], v[70:71], v[30:31], v[38:39]
    v_pk_fma_f32 v[40:41], v[72:73], v[30:31], v[40:41]
    v_pk_fma_f32 v[42:43], v[74:75], v[30:31], v[42:43]
    v_pk_fma_f32 v[44:45], v[76:77], v[30:31], v[44:45]
    v_pk_fma_f32 v[46:47], v[78:79], v[30:31], v[46:47]
    v_cvt_pk_bf16_f32 v64, v32, v33
    v_cvt_pk_bf16_f32 v65, v34, v35
    v_cvt_pk_bf16_f32 v66, v36, v37
    v_cvt_pk_bf16_f32 v67, v38, v39
    v_cvt_pk_bf16_f32 v68, v40, v41
    v_cvt_pk_bf16_f32 v69, v42, v43
    v_cvt_pk_bf16_f32 v70, v44, v45
    v_cvt_pk_bf16_f32 v71, v46, v47
    ds_write_b128 v25, v[64:67] offset:0
    ds_write_b128 v25, v[68:71] offset:1024
    ds_read_b128 v[64:67], v25 offset:16384
    ds_read_b128 v[68:71], v25 offset:17408
    ds_read_b128 v[72:75], v25 offset:18432
    ds_read_b128 v[76:79], v25 offset:19456
    v_accvgpr_read_b32 v48, a16
    v_accvgpr_read_b32 v49, a17
    v_accvgpr_read_b32 v50, a18
    v_accvgpr_read_b32 v51, a19
    v_accvgpr_read_b32 v52, a20
    v_accvgpr_read_b32 v53, a21
    v_accvgpr_read_b32 v54, a22
    v_accvgpr_read_b32 v55, a23
    v_accvgpr_read_b32 v56, a24
    v_accvgpr_read_b32 v57, a25
    v_accvgpr_read_b32 v58, a26
    v_accvgpr_read_b32 v59, a27
    v_accvgpr_read_b32 v60, a28
    v_accvgpr_read_b32 v61, a29
    v_accvgpr_read_b32 v62, a30
    v_accvgpr_read_b32 v63, a31
    v_pk_mul_f32 v[48:49], v[48:49], v[16:17]
    v_pk_mul_f32 v[50:51], v[50:51], v[16:17]
    v_pk_mul_f32 v[52:53], v[52:53], v[16:17]
    v_pk_mul_f32 v[54:55], v[54:55], v[16:17]
    v_pk_mul_f32 v[56:57], v[56:57], v[16:17]
    v_pk_mul_f32 v[58:59], v[58:59], v[16:17]
    v_pk_mul_f32 v[60:61], v[60:61], v[16:17]
    v_pk_mul_f32 v[62:63], v[62:63], v[16:17]
    s_waitcnt lgkmcnt(14)
    v_pk_fma_f32 v[48:49], v[80:81], v[18:19], v[48:49]
    v_pk_fma_f32 v[50:51], v[82:83], v[18:19], v[50:51]
    v_pk_fma_f32 v[52:53], v[84:85], v[18:19], v[52:53]
    v_pk_fma_f32 v[54:55], v[86:87], v[18:19], v[54:55]
    v_pk_fma_f32 v[56:57], v[88:89], v[18:19], v[56:57]
    v_pk_fma_f32 v[58:59], v[90:91], v[18:19], v[58:59]
    v_pk_fma_f32 v[60:61], v[92:93], v[18:19], v[60:61]
    v_pk_fma_f32 v[62:63], v[94:95], v[18:19], v[62:63]
    v_cvt_pk_bf16_f32 v80, v48, v49
    v_cvt_pk_bf16_f32 v81, v50, v51
    v_cvt_pk_bf16_f32 v82, v52, v53
    v_cvt_pk_bf16_f32 v83, v54, v55
    v_cvt_pk_bf16_f32 v84, v56, v57
    v_cvt_pk_bf16_f32 v85, v58, v59
    v_cvt_pk_bf16_f32 v86, v60, v61
    v_cvt_pk_bf16_f32 v87, v62, v63
    ds_write_b128 v25, v[80:83] offset:4096
    ds_write_b128 v25, v[84:87] offset:5120
    ds_read_b128 v[80:83], v25 offset:20480
    ds_read_b128 v[84:87], v25 offset:21504
    ds_read_b128 v[88:91], v25 offset:22528
    ds_read_b128 v[92:95], v25 offset:23552
    v_accvgpr_read_b32 v32, a32
    v_accvgpr_read_b32 v33, a33
    v_accvgpr_read_b32 v34, a34
    v_accvgpr_read_b32 v35, a35
    v_accvgpr_read_b32 v36, a36
    v_accvgpr_read_b32 v37, a37
    v_accvgpr_read_b32 v38, a38
    v_accvgpr_read_b32 v39, a39
    v_accvgpr_read_b32 v40, a40
    v_accvgpr_read_b32 v41, a41
    v_accvgpr_read_b32 v42, a42
    v_accvgpr_read_b32 v43, a43
    v_accvgpr_read_b32 v44, a44
    v_accvgpr_read_b32 v45, a45
    v_accvgpr_read_b32 v46, a46
    v_accvgpr_read_b32 v47, a47
    v_pk_mul_f32 v[32:33], v[32:33], v[28:29]
    v_pk_mul_f32 v[34:35], v[34:35], v[28:29]
    v_pk_mul_f32 v[36:37], v[36:37], v[28:29]
    v_pk_mul_f32 v[38:39], v[38:39], v[28:29]
    v_pk_mul_f32 v[40:41], v[40:41], v[28:29]
    v_pk_mul_f32 v[42:43], v[42:43], v[28:29]
    v_pk_mul_f32 v[44:45], v[44:45], v[28:29]
    v_pk_mul_f32 v[46:47], v[46:47], v[28:29]
    s_waitcnt lgkmcnt(15)
    v_pk_fma_f32 v[32:33], v[96:97], v[30:31], v[32:33]
    v_pk_fma_f32 v[34:35], v[98:99], v[30:31], v[34:35]
    v_pk_fma_f32 v[36:37], v[100:101], v[30:31], v[36:37]
    v_pk_fma_f32 v[38:39], v[102:103], v[30:31], v[38:39]
    v_pk_fma_f32 v[40:41], v[104:105], v[30:31], v[40:41]
    v_pk_fma_f32 v[42:43], v[106:107], v[30:31], v[42:43]
    v_pk_fma_f32 v[44:45], v[108:109], v[30:31], v[44:45]
    v_pk_fma_f32 v[46:47], v[110:111], v[30:31], v[46:47]
    v_cvt_pk_bf16_f32 v96, v32, v33
    v_cvt_pk_bf16_f32 v97, v34, v35
    v_cvt_pk_bf16_f32 v98, v36, v37
    v_cvt_pk_bf16_f32 v99, v38, v39
    v_cvt_pk_bf16_f32 v100, v40, v41
    v_cvt_pk_bf16_f32 v101, v42, v43
    v_cvt_pk_bf16_f32 v102, v44, v45
    v_cvt_pk_bf16_f32 v103, v46, v47
    ds_write_b128 v25, v[96:99] offset:8192
    ds_write_b128 v25, v[100:103] offset:9216
    ds_read_b128 v[96:99], v25 offset:24576
    ds_read_b128 v[100:103], v25 offset:25600
    ds_read_b128 v[104:107], v25 offset:26624
    ds_read_b128 v[108:111], v25 offset:27648
    v_accvgpr_read_b32 v48, a48
    v_accvgpr_read_b32 v49, a49
    v_accvgpr_read_b32 v50, a50
    v_accvgpr_read_b32 v51, a51
    v_accvgpr_read_b32 v52, a52
    v_accvgpr_read_b32 v53, a53
    v_accvgpr_read_b32 v54, a54
    v_accvgpr_read_b32 v55, a55
    v_accvgpr_read_b32 v56, a56
    v_accvgpr_read_b32 v57, a57
    v_accvgpr_read_b32 v58, a58
    v_accvgpr_read_b32 v59, a59
    v_accvgpr_read_b32 v60, a60
    v_accvgpr_read_b32 v61, a61
    v_accvgpr_read_b32 v62, a62
    v_accvgpr_read_b32 v63, a63
    v_pk_mul_f32 v[48:49], v[48:49], v[16:17]
    v_pk_mul_f32 v[50:51], v[50:51], v[16:17]
    v_pk_mul_f32 v[52:53], v[52:53], v[16:17]
    v_pk_mul_f32 v[54:55], v[54:55], v[16:17]
    v_pk_mul_f32 v[56:57], v[56:57], v[16:17]
    v_pk_mul_f32 v[58:59], v[58:59], v[16:17]
    v_pk_mul_f32 v[60:61], v[60:61], v[16:17]
    v_pk_mul_f32 v[62:63], v[62:63], v[16:17]
    s_waitcnt lgkmcnt(15)
    v_pk_fma_f32 v[48:49], v[112:113], v[18:19], v[48:49]
    v_pk_fma_f32 v[50:51], v[114:115], v[18:19], v[50:51]
    v_pk_fma_f32 v[52:53], v[116:117], v[18:19], v[52:53]
    v_pk_fma_f32 v[54:55], v[118:119], v[18:19], v[54:55]
    v_pk_fma_f32 v[56:57], v[120:121], v[18:19], v[56:57]
    v_pk_fma_f32 v[58:59], v[122:123], v[18:19], v[58:59]
    v_pk_fma_f32 v[60:61], v[124:125], v[18:19], v[60:61]
    v_pk_fma_f32 v[62:63], v[126:127], v[18:19], v[62:63]
    v_cvt_pk_bf16_f32 v112, v48, v49
    v_cvt_pk_bf16_f32 v113, v50, v51
    v_cvt_pk_bf16_f32 v114, v52, v53
    v_cvt_pk_bf16_f32 v115, v54, v55
    v_cvt_pk_bf16_f32 v116, v56, v57
    v_cvt_pk_bf16_f32 v117, v58, v59
    v_cvt_pk_bf16_f32 v118, v60, v61
    v_cvt_pk_bf16_f32 v119, v62, v63
    ds_write_b128 v25, v[112:115] offset:12288
    ds_write_b128 v25, v[116:119] offset:13312
    ds_read_b128 v[112:115], v25 offset:28672
    ds_read_b128 v[116:119], v25 offset:29696
    ds_read_b128 v[120:123], v25 offset:30720
    ds_read_b128 v[124:127], v25 offset:31744
    v_accvgpr_read_b32 v32, a64
    v_accvgpr_read_b32 v33, a65
    v_accvgpr_read_b32 v34, a66
    v_accvgpr_read_b32 v35, a67
    v_accvgpr_read_b32 v36, a68
    v_accvgpr_read_b32 v37, a69
    v_accvgpr_read_b32 v38, a70
    v_accvgpr_read_b32 v39, a71
    v_accvgpr_read_b32 v40, a72
    v_accvgpr_read_b32 v41, a73
    v_accvgpr_read_b32 v42, a74
    v_accvgpr_read_b32 v43, a75
    v_accvgpr_read_b32 v44, a76
    v_accvgpr_read_b32 v45, a77
    v_accvgpr_read_b32 v46, a78
    v_accvgpr_read_b32 v47, a79
    v_pk_mul_f32 v[32:33], v[32:33], v[28:29]
    v_pk_mul_f32 v[34:35], v[34:35], v[28:29]
    v_pk_mul_f32 v[36:37], v[36:37], v[28:29]
    v_pk_mul_f32 v[38:39], v[38:39], v[28:29]
    v_pk_mul_f32 v[40:41], v[40:41], v[28:29]
    v_pk_mul_f32 v[42:43], v[42:43], v[28:29]
    v_pk_mul_f32 v[44:45], v[44:45], v[28:29]
    v_pk_mul_f32 v[46:47], v[46:47], v[28:29]
    s_waitcnt lgkmcnt(15)
    v_pk_fma_f32 v[32:33], v[64:65], v[30:31], v[32:33]
    v_pk_fma_f32 v[34:35], v[66:67], v[30:31], v[34:35]
    v_pk_fma_f32 v[36:37], v[68:69], v[30:31], v[36:37]
    v_pk_fma_f32 v[38:39], v[70:71], v[30:31], v[38:39]
    v_pk_fma_f32 v[40:41], v[72:73], v[30:31], v[40:41]
    v_pk_fma_f32 v[42:43], v[74:75], v[30:31], v[42:43]
    v_pk_fma_f32 v[44:45], v[76:77], v[30:31], v[44:45]
    v_pk_fma_f32 v[46:47], v[78:79], v[30:31], v[46:47]
    v_cvt_pk_bf16_f32 v64, v32, v33
    v_cvt_pk_bf16_f32 v65, v34, v35
    v_cvt_pk_bf16_f32 v66, v36, v37
    v_cvt_pk_bf16_f32 v67, v38, v39
    v_cvt_pk_bf16_f32 v68, v40, v41
    v_cvt_pk_bf16_f32 v69, v42, v43
    v_cvt_pk_bf16_f32 v70, v44, v45
    v_cvt_pk_bf16_f32 v71, v46, v47
    ds_write_b128 v25, v[64:67] offset:16384
    ds_write_b128 v25, v[68:71] offset:17408
    v_accvgpr_read_b32 v48, a80
    v_accvgpr_read_b32 v49, a81
    v_accvgpr_read_b32 v50, a82
    v_accvgpr_read_b32 v51, a83
    v_accvgpr_read_b32 v52, a84
    v_accvgpr_read_b32 v53, a85
    v_accvgpr_read_b32 v54, a86
    v_accvgpr_read_b32 v55, a87
    v_accvgpr_read_b32 v56, a88
    v_accvgpr_read_b32 v57, a89
    v_accvgpr_read_b32 v58, a90
    v_accvgpr_read_b32 v59, a91
    v_accvgpr_read_b32 v60, a92
    v_accvgpr_read_b32 v61, a93
    v_accvgpr_read_b32 v62, a94
    v_accvgpr_read_b32 v63, a95
    v_pk_mul_f32 v[48:49], v[48:49], v[16:17]
    v_pk_mul_f32 v[50:51], v[50:51], v[16:17]
    v_pk_mul_f32 v[52:53], v[52:53], v[16:17]
    v_pk_mul_f32 v[54:55], v[54:55], v[16:17]
    v_pk_mul_f32 v[56:57], v[56:57], v[16:17]
    v_pk_mul_f32 v[58:59], v[58:59], v[16:17]
    v_pk_mul_f32 v[60:61], v[60:61], v[16:17]
    v_pk_mul_f32 v[62:63], v[62:63], v[16:17]
    s_waitcnt lgkmcnt(14)
    v_pk_fma_f32 v[48:49], v[80:81], v[18:19], v[48:49]
    v_pk_fma_f32 v[50:51], v[82:83], v[18:19], v[50:51]
    v_pk_fma_f32 v[52:53], v[84:85], v[18:19], v[52:53]
    v_pk_fma_f32 v[54:55], v[86:87], v[18:19], v[54:55]
    v_pk_fma_f32 v[56:57], v[88:89], v[18:19], v[56:57]
    v_pk_fma_f32 v[58:59], v[90:91], v[18:19], v[58:59]
    v_pk_fma_f32 v[60:61], v[92:93], v[18:19], v[60:61]
    v_pk_fma_f32 v[62:63], v[94:95], v[18:19], v[62:63]
    v_cvt_pk_bf16_f32 v80, v48, v49
    v_cvt_pk_bf16_f32 v81, v50, v51
    v_cvt_pk_bf16_f32 v82, v52, v53
    v_cvt_pk_bf16_f32 v83, v54, v55
    v_cvt_pk_bf16_f32 v84, v56, v57
    v_cvt_pk_bf16_f32 v85, v58, v59
    v_cvt_pk_bf16_f32 v86, v60, v61
    v_cvt_pk_bf16_f32 v87, v62, v63
    ds_write_b128 v25, v[80:83] offset:20480
    ds_write_b128 v25, v[84:87] offset:21504
    v_accvgpr_read_b32 v32, a96
    v_accvgpr_read_b32 v33, a97
    v_accvgpr_read_b32 v34, a98
    v_accvgpr_read_b32 v35, a99
    v_accvgpr_read_b32 v36, a100
    v_accvgpr_read_b32 v37, a101
    v_accvgpr_read_b32 v38, a102
    v_accvgpr_read_b32 v39, a103
    v_accvgpr_read_b32 v40, a104
    v_accvgpr_read_b32 v41, a105
    v_accvgpr_read_b32 v42, a106
    v_accvgpr_read_b32 v43, a107
    v_accvgpr_read_b32 v44, a108
    v_accvgpr_read_b32 v45, a109
    v_accvgpr_read_b32 v46, a110
    v_accvgpr_read_b32 v47, a111
    v_pk_mul_f32 v[32:33], v[32:33], v[28:29]
    v_pk_mul_f32 v[34:35], v[34:35], v[28:29]
    v_pk_mul_f32 v[36:37], v[36:37], v[28:29]
    v_pk_mul_f32 v[38:39], v[38:39], v[28:29]
    v_pk_mul_f32 v[40:41], v[40:41], v[28:29]
    v_pk_mul_f32 v[42:43], v[42:43], v[28:29]
    v_pk_mul_f32 v[44:45], v[44:45], v[28:29]
    v_pk_mul_f32 v[46:47], v[46:47], v[28:29]
    s_waitcnt lgkmcnt(10)
    v_pk_fma_f32 v[32:33], v[96:97], v[30:31], v[32:33]
    v_pk_fma_f32 v[34:35], v[98:99], v[30:31], v[34:35]
    v_pk_fma_f32 v[36:37], v[100:101], v[30:31], v[36:37]
    v_pk_fma_f32 v[38:39], v[102:103], v[30:31], v[38:39]
    v_pk_fma_f32 v[40:41], v[104:105], v[30:31], v[40:41]
    v_pk_fma_f32 v[42:43], v[106:107], v[30:31], v[42:43]
    v_pk_fma_f32 v[44:45], v[108:109], v[30:31], v[44:45]
    v_pk_fma_f32 v[46:47], v[110:111], v[30:31], v[46:47]
    v_cvt_pk_bf16_f32 v96, v32, v33
    v_cvt_pk_bf16_f32 v97, v34, v35
    v_cvt_pk_bf16_f32 v98, v36, v37
    v_cvt_pk_bf16_f32 v99, v38, v39
    v_cvt_pk_bf16_f32 v100, v40, v41
    v_cvt_pk_bf16_f32 v101, v42, v43
    v_cvt_pk_bf16_f32 v102, v44, v45
    v_cvt_pk_bf16_f32 v103, v46, v47
    ds_write_b128 v25, v[96:99] offset:24576
    ds_write_b128 v25, v[100:103] offset:25600
    v_accvgpr_read_b32 v48, a112
    v_accvgpr_read_b32 v49, a113
    v_accvgpr_read_b32 v50, a114
    v_accvgpr_read_b32 v51, a115
    v_accvgpr_read_b32 v52, a116
    v_accvgpr_read_b32 v53, a117
    v_accvgpr_read_b32 v54, a118
    v_accvgpr_read_b32 v55, a119
    v_accvgpr_read_b32 v56, a120
    v_accvgpr_read_b32 v57, a121
    v_accvgpr_read_b32 v58, a122
    v_accvgpr_read_b32 v59, a123
    v_accvgpr_read_b32 v60, a124
    v_accvgpr_read_b32 v61, a125
    v_accvgpr_read_b32 v62, a126
    v_accvgpr_read_b32 v63, a127
    v_pk_mul_f32 v[48:49], v[48:49], v[16:17]
    v_pk_mul_f32 v[50:51], v[50:51], v[16:17]
    v_pk_mul_f32 v[52:53], v[52:53], v[16:17]
    v_pk_mul_f32 v[54:55], v[54:55], v[16:17]
    v_pk_mul_f32 v[56:57], v[56:57], v[16:17]
    v_pk_mul_f32 v[58:59], v[58:59], v[16:17]
    v_pk_mul_f32 v[60:61], v[60:61], v[16:17]
    v_pk_mul_f32 v[62:63], v[62:63], v[16:17]
    s_waitcnt lgkmcnt(6)
    v_pk_fma_f32 v[48:49], v[112:113], v[18:19], v[48:49]
    v_pk_fma_f32 v[50:51], v[114:115], v[18:19], v[50:51]
    v_pk_fma_f32 v[52:53], v[116:117], v[18:19], v[52:53]
    v_pk_fma_f32 v[54:55], v[118:119], v[18:19], v[54:55]
    v_pk_fma_f32 v[56:57], v[120:121], v[18:19], v[56:57]
    v_pk_fma_f32 v[58:59], v[122:123], v[18:19], v[58:59]
    v_pk_fma_f32 v[60:61], v[124:125], v[18:19], v[60:61]
    v_pk_fma_f32 v[62:63], v[126:127], v[18:19], v[62:63]
    v_cvt_pk_bf16_f32 v112, v48, v49
    v_cvt_pk_bf16_f32 v113, v50, v51
    v_cvt_pk_bf16_f32 v114, v52, v53
    v_cvt_pk_bf16_f32 v115, v54, v55
    v_cvt_pk_bf16_f32 v116, v56, v57
    v_cvt_pk_bf16_f32 v117, v58, v59
    v_cvt_pk_bf16_f32 v118, v60, v61
    v_cvt_pk_bf16_f32 v119, v62, v63
    ds_write_b128 v25, v[112:115] offset:28672
    ds_write_b128 v25, v[116:119] offset:29696
    s_branch EPI2
EPI1:
    ds_write_b128 v24, a[0:3] offset:0
    ds_write_b128 v24, a[4:7] offset:1024
    ds_write_b128 v24, a[8:11] offset:2048
    ds_write_b128 v24, a[12:15] offset:3072
    ds_write_b128 v24, a[16:19] offset:4096
    ds_write_b128 v24, a[20:23] offset:5120
    ds_write_b128 v24, a[24:27] offset:6144
    ds_write_b128 v24, a[28:31] offset:7168
    ds_write_b128 v24, a[32:35] offset:8192
    ds_write_b128 v24, a[36:39] offset:9216
    ds_write_b128 v24, a[40:43] offset:10240
    ds_write_b128 v24, a[44:47] offset:11264
    ds_write_b128 v24, a[48:51] offset:12288
    ds_write_b128 v24, a[52:55] offset:13312
    ds_write_b128 v24, a[56:59] offset:14336
    ds_write_b128 v24, a[60:63] offset:15360
    ds_write_b128 v24, a[64:67] offset:16384
    ds_write_b128 v24, a[68:71] offset:17408
    ds_write_b128 v24, a[72:75] offset:18432
    ds_write_b128 v24, a[76:79] offset:19456
    ds_write_b128 v24, a[80:83] offset:20480
    ds_write_b128 v24, a[84:87] offset:21504
    ds_write_b128 v24, a[88:91] offset:22528
    ds_write_b128 v24, a[92:95] offset:23552
    ds_write_b128 v24, a[96:99] offset:24576
    ds_write_b128 v24, a[100:103] offset:25600
    ds_write_b128 v24, a[104:107] offset:26624
    ds_write_b128 v24, a[108:111] offset:27648
    ds_write_b128 v24, a[112:115] offset:28672
    ds_write_b128 v24, a[116:119] offset:29696
    ds_write_b128 v24, a[120:123] offset:30720
    ds_write_b128 v24, a[124:127] offset:31744
    s_waitcnt lgkmcnt(0)
    s_barrier
    ds_read_b128 v[12:15], v27
    ds_read_b128 v[64:67], v25 offset:0
    ds_read_b128 v[68:71], v25 offset:1024
    ds_read_b128 v[72:75], v25 offset:2048
    ds_read_b128 v[76:79], v25 offset:3072
    ds_read_b128 v[80:83], v25 offset:4096
    ds_read_b128 v[84:87], v25 offset:5120
    ds_read_b128 v[88:91], v25 offset:6144
    ds_read_b128 v[92:95], v25 offset:7168
    ds_read_b128 v[96:99], v25 offset:8192
    ds_read_b128 v[100:103], v25 offset:9216
    ds_read_b128 v[104:107], v25 offset:10240
    ds_read_b128 v[108:111], v25 offset:11264
    s_waitcnt lgkmcnt(12)
    v_max_f32 v10, v6, v12
    v_sub_f32 v11, v6, v10
    v_sub_f32 v10, v12, v10
    v_exp_f32 v11, v11
    v_exp_f32 v10, v10
    s_nop 0
    v_mul_f32 v28, v10, v14
    v_fma_f32 v28, v11, v8, v28
    v_rcp_f32 v29, v28
    s_nop 0
    v_mul_f32 v30, v10, v29
    v_mul_f32 v31, v10, v29
    v_mul_f32 v28, v11, v29
    v_mul_f32 v29, v11, v29
    v_max_f32 v10, v7, v13
    v_sub_f32 v11, v7, v10
    v_sub_f32 v10, v13, v10
    v_exp_f32 v11, v11
    v_exp_f32 v10, v10
    s_nop 0
    v_mul_f32 v16, v10, v15
    v_fma_f32 v16, v11, v9, v16
    v_rcp_f32 v17, v16
    s_nop 0
    v_mul_f32 v18, v10, v17
    v_mul_f32 v19, v10, v17
    v_mul_f32 v16, v11, v17
    v_mul_f32 v17, v11, v17
    ds_read_b128 v[112:115], v25 offset:12288
    ds_read_b128 v[116:119], v25 offset:13312
    ds_read_b128 v[120:123], v25 offset:14336
    ds_read_b128 v[124:127], v25 offset:15360
    v_accvgpr_read_b32 v32, a128
    v_accvgpr_read_b32 v33, a129
    v_accvgpr_read_b32 v34, a130
    v_accvgpr_read_b32 v35, a131
    v_accvgpr_read_b32 v36, a132
    v_accvgpr_read_b32 v37, a133
    v_accvgpr_read_b32 v38, a134
    v_accvgpr_read_b32 v39, a135
    v_accvgpr_read_b32 v40, a136
    v_accvgpr_read_b32 v41, a137
    v_accvgpr_read_b32 v42, a138
    v_accvgpr_read_b32 v43, a139
    v_accvgpr_read_b32 v44, a140
    v_accvgpr_read_b32 v45, a141
    v_accvgpr_read_b32 v46, a142
    v_accvgpr_read_b32 v47, a143
    v_pk_mul_f32 v[32:33], v[32:33], v[28:29]
    v_pk_mul_f32 v[34:35], v[34:35], v[28:29]
    v_pk_mul_f32 v[36:37], v[36:37], v[28:29]
    v_pk_mul_f32 v[38:39], v[38:39], v[28:29]
    v_pk_mul_f32 v[40:41], v[40:41], v[28:29]
    v_pk_mul_f32 v[42:43], v[42:43], v[28:29]
    v_pk_mul_f32 v[44:45], v[44:45], v[28:29]
    v_pk_mul_f32 v[46:47], v[46:47], v[28:29]
    s_waitcnt lgkmcnt(12)
    v_pk_fma_f32 v[32:33], v[64:65], v[30:31], v[32:33]
    v_pk_fma_f32 v[34:35], v[66:67], v[30:31], v[34:35]
    v_pk_fma_f32 v[36:37], v[68:69], v[30:31], v[36:37]
    v_pk_fma_f32 v[38:39], v[70:71], v[30:31], v[38:39]
    v_pk_fma_f32 v[40:41], v[72:73], v[30:31], v[40:41]
    v_pk_fma_f32 v[42:43], v[74:75], v[30:31], v[42:43]
    v_pk_fma_f32 v[44:45], v[76:77], v[30:31], v[44:45]
    v_pk_fma_f32 v[46:47], v[78:79], v[30:31], v[46:47]
    v_cvt_pk_bf16_f32 v64, v32, v33
    v_cvt_pk_bf16_f32 v65, v34, v35
    v_cvt_pk_bf16_f32 v66, v36, v37
    v_cvt_pk_bf16_f32 v67, v38, v39
    v_cvt_pk_bf16_f32 v68, v40, v41
    v_cvt_pk_bf16_f32 v69, v42, v43
    v_cvt_pk_bf16_f32 v70, v44, v45
    v_cvt_pk_bf16_f32 v71, v46, v47
    ds_write_b128 v25, v[64:67] offset:0
    ds_write_b128 v25, v[68:71] offset:1024
    ds_read_b128 v[64:67], v25 offset:16384
    ds_read_b128 v[68:71], v25 offset:17408
    ds_read_b128 v[72:75], v25 offset:18432
    ds_read_b128 v[76:79], v25 offset:19456
    v_accvgpr_read_b32 v48, a144
    v_accvgpr_read_b32 v49, a145
    v_accvgpr_read_b32 v50, a146
    v_accvgpr_read_b32 v51, a147
    v_accvgpr_read_b32 v52, a148
    v_accvgpr_read_b32 v53, a149
    v_accvgpr_read_b32 v54, a150
    v_accvgpr_read_b32 v55, a151
    v_accvgpr_read_b32 v56, a152
    v_accvgpr_read_b32 v57, a153
    v_accvgpr_read_b32 v58, a154
    v_accvgpr_read_b32 v59, a155
    v_accvgpr_read_b32 v60, a156
    v_accvgpr_read_b32 v61, a157
    v_accvgpr_read_b32 v62, a158
    v_accvgpr_read_b32 v63, a159
    v_pk_mul_f32 v[48:49], v[48:49], v[16:17]
    v_pk_mul_f32 v[50:51], v[50:51], v[16:17]
    v_pk_mul_f32 v[52:53], v[52:53], v[16:17]
    v_pk_mul_f32 v[54:55], v[54:55], v[16:17]
    v_pk_mul_f32 v[56:57], v[56:57], v[16:17]
    v_pk_mul_f32 v[58:59], v[58:59], v[16:17]
    v_pk_mul_f32 v[60:61], v[60:61], v[16:17]
    v_pk_mul_f32 v[62:63], v[62:63], v[16:17]
    s_waitcnt lgkmcnt(14)
    v_pk_fma_f32 v[48:49], v[80:81], v[18:19], v[48:49]
    v_pk_fma_f32 v[50:51], v[82:83], v[18:19], v[50:51]
    v_pk_fma_f32 v[52:53], v[84:85], v[18:19], v[52:53]
    v_pk_fma_f32 v[54:55], v[86:87], v[18:19], v[54:55]
    v_pk_fma_f32 v[56:57], v[88:89], v[18:19], v[56:57]
    v_pk_fma_f32 v[58:59], v[90:91], v[18:19], v[58:59]
    v_pk_fma_f32 v[60:61], v[92:93], v[18:19], v[60:61]
    v_pk_fma_f32 v[62:63], v[94:95], v[18:19], v[62:63]
    v_cvt_pk_bf16_f32 v80, v48, v49
    v_cvt_pk_bf16_f32 v81, v50, v51
    v_cvt_pk_bf16_f32 v82, v52, v53
    v_cvt_pk_bf16_f32 v83, v54, v55
    v_cvt_pk_bf16_f32 v84, v56, v57
    v_cvt_pk_bf16_f32 v85, v58, v59
    v_cvt_pk_bf16_f32 v86, v60, v61
    v_cvt_pk_bf16_f32 v87, v62, v63
    ds_write_b128 v25, v[80:83] offset:4096
    ds_write_b128 v25, v[84:87] offset:5120
    ds_read_b128 v[80:83], v25 offset:20480
    ds_read_b128 v[84:87], v25 offset:21504
    ds_read_b128 v[88:91], v25 offset:22528
    ds_read_b128 v[92:95], v25 offset:23552
    v_accvgpr_read_b32 v32, a160
    v_accvgpr_read_b32 v33, a161
    v_accvgpr_read_b32 v34, a162
    v_accvgpr_read_b32 v35, a163
    v_accvgpr_read_b32 v36, a164
    v_accvgpr_read_b32 v37, a165
    v_accvgpr_read_b32 v38, a166
    v_accvgpr_read_b32 v39, a167
    v_accvgpr_read_b32 v40, a168
    v_accvgpr_read_b32 v41, a169
    v_accvgpr_read_b32 v42, a170
    v_accvgpr_read_b32 v43, a171
    v_accvgpr_read_b32 v44, a172
    v_accvgpr_read_b32 v45, a173
    v_accvgpr_read_b32 v46, a174
    v_accvgpr_read_b32 v47, a175
    v_pk_mul_f32 v[32:33], v[32:33], v[28:29]
    v_pk_mul_f32 v[34:35], v[34:35], v[28:29]
    v_pk_mul_f32 v[36:37], v[36:37], v[28:29]
    v_pk_mul_f32 v[38:39], v[38:39], v[28:29]
    v_pk_mul_f32 v[40:41], v[40:41], v[28:29]
    v_pk_mul_f32 v[42:43], v[42:43], v[28:29]
    v_pk_mul_f32 v[44:45], v[44:45], v[28:29]
    v_pk_mul_f32 v[46:47], v[46:47], v[28:29]
    s_waitcnt lgkmcnt(15)
    v_pk_fma_f32 v[32:33], v[96:97], v[30:31], v[32:33]
    v_pk_fma_f32 v[34:35], v[98:99], v[30:31], v[34:35]
    v_pk_fma_f32 v[36:37], v[100:101], v[30:31], v[36:37]
    v_pk_fma_f32 v[38:39], v[102:103], v[30:31], v[38:39]
    v_pk_fma_f32 v[40:41], v[104:105], v[30:31], v[40:41]
    v_pk_fma_f32 v[42:43], v[106:107], v[30:31], v[42:43]
    v_pk_fma_f32 v[44:45], v[108:109], v[30:31], v[44:45]
    v_pk_fma_f32 v[46:47], v[110:111], v[30:31], v[46:47]
    v_cvt_pk_bf16_f32 v96, v32, v33
    v_cvt_pk_bf16_f32 v97, v34, v35
    v_cvt_pk_bf16_f32 v98, v36, v37
    v_cvt_pk_bf16_f32 v99, v38, v39
    v_cvt_pk_bf16_f32 v100, v40, v41
    v_cvt_pk_bf16_f32 v101, v42, v43
    v_cvt_pk_bf16_f32 v102, v44, v45
    v_cvt_pk_bf16_f32 v103, v46, v47
    ds_write_b128 v25, v[96:99] offset:8192
    ds_write_b128 v25, v[100:103] offset:9216
    ds_read_b128 v[96:99], v25 offset:24576
    ds_read_b128 v[100:103], v25 offset:25600
    ds_read_b128 v[104:107], v25 offset:26624
    ds_read_b128 v[108:111], v25 offset:27648
    v_accvgpr_read_b32 v48, a176
    v_accvgpr_read_b32 v49, a177
    v_accvgpr_read_b32 v50, a178
    v_accvgpr_read_b32 v51, a179
    v_accvgpr_read_b32 v52, a180
    v_accvgpr_read_b32 v53, a181
    v_accvgpr_read_b32 v54, a182
    v_accvgpr_read_b32 v55, a183
    v_accvgpr_read_b32 v56, a184
    v_accvgpr_read_b32 v57, a185
    v_accvgpr_read_b32 v58, a186
    v_accvgpr_read_b32 v59, a187
    v_accvgpr_read_b32 v60, a188
    v_accvgpr_read_b32 v61, a189
    v_accvgpr_read_b32 v62, a190
    v_accvgpr_read_b32 v63, a191
    v_pk_mul_f32 v[48:49], v[48:49], v[16:17]
    v_pk_mul_f32 v[50:51], v[50:51], v[16:17]
    v_pk_mul_f32 v[52:53], v[52:53], v[16:17]
    v_pk_mul_f32 v[54:55], v[54:55], v[16:17]
    v_pk_mul_f32 v[56:57], v[56:57], v[16:17]
    v_pk_mul_f32 v[58:59], v[58:59], v[16:17]
    v_pk_mul_f32 v[60:61], v[60:61], v[16:17]
    v_pk_mul_f32 v[62:63], v[62:63], v[16:17]
    s_waitcnt lgkmcnt(15)
    v_pk_fma_f32 v[48:49], v[112:113], v[18:19], v[48:49]
    v_pk_fma_f32 v[50:51], v[114:115], v[18:19], v[50:51]
    v_pk_fma_f32 v[52:53], v[116:117], v[18:19], v[52:53]
    v_pk_fma_f32 v[54:55], v[118:119], v[18:19], v[54:55]
    v_pk_fma_f32 v[56:57], v[120:121], v[18:19], v[56:57]
    v_pk_fma_f32 v[58:59], v[122:123], v[18:19], v[58:59]
    v_pk_fma_f32 v[60:61], v[124:125], v[18:19], v[60:61]
    v_pk_fma_f32 v[62:63], v[126:127], v[18:19], v[62:63]
    v_cvt_pk_bf16_f32 v112, v48, v49
    v_cvt_pk_bf16_f32 v113, v50, v51
    v_cvt_pk_bf16_f32 v114, v52, v53
    v_cvt_pk_bf16_f32 v115, v54, v55
    v_cvt_pk_bf16_f32 v116, v56, v57
    v_cvt_pk_bf16_f32 v117, v58, v59
    v_cvt_pk_bf16_f32 v118, v60, v61
    v_cvt_pk_bf16_f32 v119, v62, v63
    ds_write_b128 v25, v[112:115] offset:12288
    ds_write_b128 v25, v[116:119] offset:13312
    ds_read_b128 v[112:115], v25 offset:28672
    ds_read_b128 v[116:119], v25 offset:29696
    ds_read_b128 v[120:123], v25 offset:30720
    ds_read_b128 v[124:127], v25 offset:31744
    v_accvgpr_read_b32 v32, a192
    v_accvgpr_read_b32 v33, a193
    v_accvgpr_read_b32 v34, a194
    v_accvgpr_read_b32 v35, a195
    v_accvgpr_read_b32 v36, a196
    v_accvgpr_read_b32 v37, a197
    v_accvgpr_read_b32 v38, a198
    v_accvgpr_read_b32 v39, a199
    v_accvgpr_read_b32 v40, a200
    v_accvgpr_read_b32 v41, a201
    v_accvgpr_read_b32 v42, a202
    v_accvgpr_read_b32 v43, a203
    v_accvgpr_read_b32 v44, a204
    v_accvgpr_read_b32 v45, a205
    v_accvgpr_read_b32 v46, a206
    v_accvgpr_read_b32 v47, a207
    v_pk_mul_f32 v[32:33], v[32:33], v[28:29]
    v_pk_mul_f32 v[34:35], v[34:35], v[28:29]
    v_pk_mul_f32 v[36:37], v[36:37], v[28:29]
    v_pk_mul_f32 v[38:39], v[38:39], v[28:29]
    v_pk_mul_f32 v[40:41], v[40:41], v[28:29]
    v_pk_mul_f32 v[42:43], v[42:43], v[28:29]
    v_pk_mul_f32 v[44:45], v[44:45], v[28:29]
    v_pk_mul_f32 v[46:47], v[46:47], v[28:29]
    s_waitcnt lgkmcnt(15)
    v_pk_fma_f32 v[32:33], v[64:65], v[30:31], v[32:33]
    v_pk_fma_f32 v[34:35], v[66:67], v[30:31], v[34:35]
    v_pk_fma_f32 v[36:37], v[68:69], v[30:31], v[36:37]
    v_pk_fma_f32 v[38:39], v[70:71], v[30:31], v[38:39]
    v_pk_fma_f32 v[40:41], v[72:73], v[30:31], v[40:41]
    v_pk_fma_f32 v[42:43], v[74:75], v[30:31], v[42:43]
    v_pk_fma_f32 v[44:45], v[76:77], v[30:31], v[44:45]
    v_pk_fma_f32 v[46:47], v[78:79], v[30:31], v[46:47]
    v_cvt_pk_bf16_f32 v64, v32, v33
    v_cvt_pk_bf16_f32 v65, v34, v35
    v_cvt_pk_bf16_f32 v66, v36, v37
    v_cvt_pk_bf16_f32 v67, v38, v39
    v_cvt_pk_bf16_f32 v68, v40, v41
    v_cvt_pk_bf16_f32 v69, v42, v43
    v_cvt_pk_bf16_f32 v70, v44, v45
    v_cvt_pk_bf16_f32 v71, v46, v47
    ds_write_b128 v25, v[64:67] offset:16384
    ds_write_b128 v25, v[68:71] offset:17408
    v_accvgpr_read_b32 v48, a208
    v_accvgpr_read_b32 v49, a209
    v_accvgpr_read_b32 v50, a210
    v_accvgpr_read_b32 v51, a211
    v_accvgpr_read_b32 v52, a212
    v_accvgpr_read_b32 v53, a213
    v_accvgpr_read_b32 v54, a214
    v_accvgpr_read_b32 v55, a215
    v_accvgpr_read_b32 v56, a216
    v_accvgpr_read_b32 v57, a217
    v_accvgpr_read_b32 v58, a218
    v_accvgpr_read_b32 v59, a219
    v_accvgpr_read_b32 v60, a220
    v_accvgpr_read_b32 v61, a221
    v_accvgpr_read_b32 v62, a222
    v_accvgpr_read_b32 v63, a223
    v_pk_mul_f32 v[48:49], v[48:49], v[16:17]
    v_pk_mul_f32 v[50:51], v[50:51], v[16:17]
    v_pk_mul_f32 v[52:53], v[52:53], v[16:17]
    v_pk_mul_f32 v[54:55], v[54:55], v[16:17]
    v_pk_mul_f32 v[56:57], v[56:57], v[16:17]
    v_pk_mul_f32 v[58:59], v[58:59], v[16:17]
    v_pk_mul_f32 v[60:61], v[60:61], v[16:17]
    v_pk_mul_f32 v[62:63], v[62:63], v[16:17]
    s_waitcnt lgkmcnt(14)
    v_pk_fma_f32 v[48:49], v[80:81], v[18:19], v[48:49]
    v_pk_fma_f32 v[50:51], v[82:83], v[18:19], v[50:51]
    v_pk_fma_f32 v[52:53], v[84:85], v[18:19], v[52:53]
    v_pk_fma_f32 v[54:55], v[86:87], v[18:19], v[54:55]
    v_pk_fma_f32 v[56:57], v[88:89], v[18:19], v[56:57]
    v_pk_fma_f32 v[58:59], v[90:91], v[18:19], v[58:59]
    v_pk_fma_f32 v[60:61], v[92:93], v[18:19], v[60:61]
    v_pk_fma_f32 v[62:63], v[94:95], v[18:19], v[62:63]
    v_cvt_pk_bf16_f32 v80, v48, v49
    v_cvt_pk_bf16_f32 v81, v50, v51
    v_cvt_pk_bf16_f32 v82, v52, v53
    v_cvt_pk_bf16_f32 v83, v54, v55
    v_cvt_pk_bf16_f32 v84, v56, v57
    v_cvt_pk_bf16_f32 v85, v58, v59
    v_cvt_pk_bf16_f32 v86, v60, v61
    v_cvt_pk_bf16_f32 v87, v62, v63
    ds_write_b128 v25, v[80:83] offset:20480
    ds_write_b128 v25, v[84:87] offset:21504
    v_accvgpr_read_b32 v32, a224
    v_accvgpr_read_b32 v33, a225
    v_accvgpr_read_b32 v34, a226
    v_accvgpr_read_b32 v35, a227
    v_accvgpr_read_b32 v36, a228
    v_accvgpr_read_b32 v37, a229
    v_accvgpr_read_b32 v38, a230
    v_accvgpr_read_b32 v39, a231
    v_accvgpr_read_b32 v40, a232
    v_accvgpr_read_b32 v41, a233
    v_accvgpr_read_b32 v42, a234
    v_accvgpr_read_b32 v43, a235
    v_accvgpr_read_b32 v44, a236
    v_accvgpr_read_b32 v45, a237
    v_accvgpr_read_b32 v46, a238
    v_accvgpr_read_b32 v47, a239
    v_pk_mul_f32 v[32:33], v[32:33], v[28:29]
    v_pk_mul_f32 v[34:35], v[34:35], v[28:29]
    v_pk_mul_f32 v[36:37], v[36:37], v[28:29]
    v_pk_mul_f32 v[38:39], v[38:39], v[28:29]
    v_pk_mul_f32 v[40:41], v[40:41], v[28:29]
    v_pk_mul_f32 v[42:43], v[42:43], v[28:29]
    v_pk_mul_f32 v[44:45], v[44:45], v[28:29]
    v_pk_mul_f32 v[46:47], v[46:47], v[28:29]
    s_waitcnt lgkmcnt(10)
    v_pk_fma_f32 v[32:33], v[96:97], v[30:31], v[32:33]
    v_pk_fma_f32 v[34:35], v[98:99], v[30:31], v[34:35]
    v_pk_fma_f32 v[36:37], v[100:101], v[30:31], v[36:37]
    v_pk_fma_f32 v[38:39], v[102:103], v[30:31], v[38:39]
    v_pk_fma_f32 v[40:41], v[104:105], v[30:31], v[40:41]
    v_pk_fma_f32 v[42:43], v[106:107], v[30:31], v[42:43]
    v_pk_fma_f32 v[44:45], v[108:109], v[30:31], v[44:45]
    v_pk_fma_f32 v[46:47], v[110:111], v[30:31], v[46:47]
    v_cvt_pk_bf16_f32 v96, v32, v33
    v_cvt_pk_bf16_f32 v97, v34, v35
    v_cvt_pk_bf16_f32 v98, v36, v37
    v_cvt_pk_bf16_f32 v99, v38, v39
    v_cvt_pk_bf16_f32 v100, v40, v41
    v_cvt_pk_bf16_f32 v101, v42, v43
    v_cvt_pk_bf16_f32 v102, v44, v45
    v_cvt_pk_bf16_f32 v103, v46, v47
    ds_write_b128 v25, v[96:99] offset:24576
    ds_write_b128 v25, v[100:103] offset:25600
    v_accvgpr_read_b32 v48, a240
    v_accvgpr_read_b32 v49, a241
    v_accvgpr_read_b32 v50, a242
    v_accvgpr_read_b32 v51, a243
    v_accvgpr_read_b32 v52, a244
    v_accvgpr_read_b32 v53, a245
    v_accvgpr_read_b32 v54, a246
    v_accvgpr_read_b32 v55, a247
    v_accvgpr_read_b32 v56, a248
    v_accvgpr_read_b32 v57, a249
    v_accvgpr_read_b32 v58, a250
    v_accvgpr_read_b32 v59, a251
    v_accvgpr_read_b32 v60, a252
    v_accvgpr_read_b32 v61, a253
    v_accvgpr_read_b32 v62, a254
    v_accvgpr_read_b32 v63, a255
    v_pk_mul_f32 v[48:49], v[48:49], v[16:17]
    v_pk_mul_f32 v[50:51], v[50:51], v[16:17]
    v_pk_mul_f32 v[52:53], v[52:53], v[16:17]
    v_pk_mul_f32 v[54:55], v[54:55], v[16:17]
    v_pk_mul_f32 v[56:57], v[56:57], v[16:17]
    v_pk_mul_f32 v[58:59], v[58:59], v[16:17]
    v_pk_mul_f32 v[60:61], v[60:61], v[16:17]
    v_pk_mul_f32 v[62:63], v[62:63], v[16:17]
    s_waitcnt lgkmcnt(6)
    v_pk_fma_f32 v[48:49], v[112:113], v[18:19], v[48:49]
    v_pk_fma_f32 v[50:51], v[114:115], v[18:19], v[50:51]
    v_pk_fma_f32 v[52:53], v[116:117], v[18:19], v[52:53]
    v_pk_fma_f32 v[54:55], v[118:119], v[18:19], v[54:55]
    v_pk_fma_f32 v[56:57], v[120:121], v[18:19], v[56:57]
    v_pk_fma_f32 v[58:59], v[122:123], v[18:19], v[58:59]
    v_pk_fma_f32 v[60:61], v[124:125], v[18:19], v[60:61]
    v_pk_fma_f32 v[62:63], v[126:127], v[18:19], v[62:63]
    v_cvt_pk_bf16_f32 v112, v48, v49
    v_cvt_pk_bf16_f32 v113, v50, v51
    v_cvt_pk_bf16_f32 v114, v52, v53
    v_cvt_pk_bf16_f32 v115, v54, v55
    v_cvt_pk_bf16_f32 v116, v56, v57
    v_cvt_pk_bf16_f32 v117, v58, v59
    v_cvt_pk_bf16_f32 v118, v60, v61
    v_cvt_pk_bf16_f32 v119, v62, v63
    ds_write_b128 v25, v[112:115] offset:28672
    ds_write_b128 v25, v[116:119] offset:29696
EPI2:
    v_add_u32 v26, 65536, v21
    s_lshl_b32 s3, s40, 12
    v_add_u32 v27, s3, v21
    v_add_u32 v28, s3, v26
    v_and_b32 v24, 31, v0
    v_lshlrev_b32 v24, 2, v24
    v_lshrrev_b32 v22, 5, v0
    v_mul_u32_u24 v22, 3584, v22
    v_add_u32 v24, v22, v24
    s_mul_i32 s42, s37, 1835008
    s_mul_i32 s3, s38, 57344
    s_add_u32 s42, s42, s3
    s_mul_i32 s3, s40, 28672
    s_add_u32 s43, s42, s3
    s_lshl_b32 s3, s41, 7
    s_add_u32 s43, s43, s3
    s_add_u32 s43, s43, 1536
    s_lshl_b32 s3, s56, 7
    s_add_u32 s42, s42, s3
    s_waitcnt lgkmcnt(0)
    s_barrier
    ds_read_b128 v[32:35], v26 offset:0
    ds_read_b128 v[36:39], v26 offset:4096
    ds_read_b128 v[40:43], v26 offset:1024
    ds_read_b128 v[44:47], v26 offset:5120
    ds_read_b128 v[48:51], v26 offset:8192
    ds_read_b128 v[52:55], v26 offset:12288
    s_add_u32 s3, s52, 401408
    buffer_load_dwordx4 v[240:243], v21, s[44:47], s3 offen
    s_waitcnt vmcnt(28) lgkmcnt(4)
    v_mfma_f32_32x32x16_bf16 a[0:15], v[32:35], v[128:131], 0
    v_mfma_f32_32x32x16_bf16 a[16:31], v[36:39], v[128:131], 0
    ds_read_b128 v[56:59], v26 offset:9216
    ds_read_b128 v[60:63], v26 offset:13312
    s_add_u32 s3, s52, 415744
    buffer_load_dwordx4 v[244:247], v21, s[44:47], s3 offen
    s_waitcnt vmcnt(28) lgkmcnt(4)
    v_mfma_f32_32x32x16_bf16 a[0:15], v[40:43], v[132:135], a[0:15]
    v_mfma_f32_32x32x16_bf16 a[16:31], v[44:47], v[132:135], a[16:31]
    ds_read_b128 v[32:35], v26 offset:16384
    ds_read_b128 v[36:39], v26 offset:20480
    s_add_u32 s3, s52, 430080
    buffer_load_dwordx4 v[248:251], v21, s[44:47], s3 offen
    s_waitcnt vmcnt(28) lgkmcnt(4)
    v_mfma_f32_32x32x16_bf16 a[0:15], v[48:51], v[136:139], a[0:15]
    v_mfma_f32_32x32x16_bf16 a[16:31], v[52:55], v[136:139], a[16:31]
    ds_read_b128 v[40:43], v26 offset:17408
    ds_read_b128 v[44:47], v26 offset:21504
    s_add_u32 s3, s52, 444416
    buffer_load_dwordx4 v[252:255], v21, s[44:47], s3 offen
    s_waitcnt vmcnt(28) lgkmcnt(4)
    v_mfma_f32_32x32x16_bf16 a[0:15], v[56:59], v[140:143], a[0:15]
    v_mfma_f32_32x32x16_bf16 a[16:31], v[60:63], v[140:143], a[16:31]
    ds_read_b128 v[48:51], v26 offset:24576
    ds_read_b128 v[52:55], v26 offset:28672
    s_add_u32 s3, s52, 1024
    buffer_load_dwordx4 v[128:131], v21, s[44:47], s3 offen
    s_waitcnt vmcnt(28) lgkmcnt(4)
    v_mfma_f32_32x32x16_bf16 a[0:15], v[32:35], v[144:147], a[0:15]
    v_mfma_f32_32x32x16_bf16 a[16:31], v[36:39], v[144:147], a[16:31]
    ds_read_b128 v[56:59], v26 offset:25600
    ds_read_b128 v[60:63], v26 offset:29696
    s_add_u32 s3, s52, 15360
    buffer_load_dwordx4 v[132:135], v21, s[44:47], s3 offen
    s_waitcnt vmcnt(28) lgkmcnt(4)
    v_mfma_f32_32x32x16_bf16 a[0:15], v[40:43], v[148:151], a[0:15]
    v_mfma_f32_32x32x16_bf16 a[16:31], v[44:47], v[148:151], a[16:31]
    ds_read_b128 v[32:35], v21 offset:0
    ds_read_b128 v[36:39], v21 offset:4096
    s_add_u32 s3, s52, 29696
    buffer_load_dwordx4 v[136:139], v21, s[44:47], s3 offen
    s_waitcnt vmcnt(28) lgkmcnt(4)
    v_mfma_f32_32x32x16_bf16 a[0:15], v[48:51], v[152:155], a[0:15]
    v_mfma_f32_32x32x16_bf16 a[16:31], v[52:55], v[152:155], a[16:31]
    ds_read_b128 v[40:43], v21 offset:1024
    ds_read_b128 v[44:47], v21 offset:5120
    s_add_u32 s3, s52, 44032
    buffer_load_dwordx4 v[140:143], v21, s[44:47], s3 offen
    s_waitcnt vmcnt(28) lgkmcnt(4)
    v_mfma_f32_32x32x16_bf16 a[0:15], v[56:59], v[156:159], a[0:15]
    v_mfma_f32_32x32x16_bf16 a[16:31], v[60:63], v[156:159], a[16:31]
    ds_read_b128 v[48:51], v21 offset:8192
    ds_read_b128 v[52:55], v21 offset:12288
    s_add_u32 s3, s52, 58368
    buffer_load_dwordx4 v[144:147], v21, s[44:47], s3 offen
    s_waitcnt vmcnt(28) lgkmcnt(4)
    v_mfma_f32_32x32x16_bf16 a[0:15], v[32:35], v[160:163], a[0:15]
    v_mfma_f32_32x32x16_bf16 a[16:31], v[36:39], v[160:163], a[16:31]
    ds_read_b128 v[56:59], v21 offset:9216
    ds_read_b128 v[60:63], v21 offset:13312
    s_add_u32 s3, s52, 72704
    buffer_load_dwordx4 v[148:151], v21, s[44:47], s3 offen
    s_waitcnt vmcnt(28) lgkmcnt(4)
    v_mfma_f32_32x32x16_bf16 a[0:15], v[40:43], v[164:167], a[0:15]
    v_mfma_f32_32x32x16_bf16 a[16:31], v[44:47], v[164:167], a[16:31]
    ds_read_b128 v[32:35], v21 offset:16384
    ds_read_b128 v[36:39], v21 offset:20480
    s_add_u32 s3, s52, 87040
    buffer_load_dwordx4 v[152:155], v21, s[44:47], s3 offen
    s_waitcnt vmcnt(28) lgkmcnt(4)
    v_mfma_f32_32x32x16_bf16 a[0:15], v[48:51], v[168:171], a[0:15]
    v_mfma_f32_32x32x16_bf16 a[16:31], v[52:55], v[168:171], a[16:31]
    ds_read_b128 v[40:43], v21 offset:17408
    ds_read_b128 v[44:47], v21 offset:21504
    s_add_u32 s3, s52, 101376
    buffer_load_dwordx4 v[156:159], v21, s[44:47], s3 offen
    s_waitcnt vmcnt(28) lgkmcnt(4)
    v_mfma_f32_32x32x16_bf16 a[0:15], v[56:59], v[172:175], a[0:15]
    v_mfma_f32_32x32x16_bf16 a[16:31], v[60:63], v[172:175], a[16:31]
    ds_read_b128 v[48:51], v21 offset:24576
    ds_read_b128 v[52:55], v21 offset:28672
    s_add_u32 s3, s52, 115712
    buffer_load_dwordx4 v[160:163], v21, s[44:47], s3 offen
    s_waitcnt vmcnt(28) lgkmcnt(4)
    v_mfma_f32_32x32x16_bf16 a[0:15], v[32:35], v[176:179], a[0:15]
    v_mfma_f32_32x32x16_bf16 a[16:31], v[36:39], v[176:179], a[16:31]
    ds_read_b128 v[56:59], v21 offset:25600
    ds_read_b128 v[60:63], v21 offset:29696
    s_add_u32 s3, s52, 130048
    buffer_load_dwordx4 v[164:167], v21, s[44:47], s3 offen
    s_waitcnt vmcnt(28) lgkmcnt(4)
    v_mfma_f32_32x32x16_bf16 a[0:15], v[40:43], v[180:183], a[0:15]
    v_mfma_f32_32x32x16_bf16 a[16:31], v[44:47], v[180:183], a[16:31]
    ds_read_b128 v[32:35], v26 offset:32768
    ds_read_b128 v[36:39], v26 offset:36864
    s_add_u32 s3, s52, 144384
    buffer_load_dwordx4 v[168:171], v21, s[44:47], s3 offen
    s_waitcnt vmcnt(28) lgkmcnt(4)
    v_mfma_f32_32x32x16_bf16 a[0:15], v[48:51], v[184:187], a[0:15]
    v_mfma_f32_32x32x16_bf16 a[16:31], v[52:55], v[184:187], a[16:31]
    ds_read_b128 v[40:43], v26 offset:33792
    ds_read_b128 v[44:47], v26 offset:37888
    s_add_u32 s3, s52, 158720
    buffer_load_dwordx4 v[172:175], v21, s[44:47], s3 offen
    s_waitcnt vmcnt(28) lgkmcnt(4)
    v_mfma_f32_32x32x16_bf16 a[0:15], v[56:59], v[188:191], a[0:15]
    v_mfma_f32_32x32x16_bf16 a[16:31], v[60:63], v[188:191], a[16:31]
    ds_read_b128 v[48:51], v26 offset:40960
    ds_read_b128 v[52:55], v26 offset:45056
    s_add_u32 s3, s52, 173056
    buffer_load_dwordx4 v[176:179], v21, s[44:47], s3 offen
    s_waitcnt vmcnt(28) lgkmcnt(4)
    v_mfma_f32_32x32x16_bf16 a[0:15], v[32:35], v[192:195], a[0:15]
    v_mfma_f32_32x32x16_bf16 a[16:31], v[36:39], v[192:195], a[16:31]
    ds_read_b128 v[56:59], v26 offset:41984
    ds_read_b128 v[60:63], v26 offset:46080
    s_add_u32 s3, s52, 187392
    buffer_load_dwordx4 v[180:183], v21, s[44:47], s3 offen
    s_waitcnt vmcnt(28) lgkmcnt(4)
    v_mfma_f32_32x32x16_bf16 a[0:15], v[40:43], v[196:199], a[0:15]
    v_mfma_f32_32x32x16_bf16 a[16:31], v[44:47], v[196:199], a[16:31]
    ds_read_b128 v[32:35], v26 offset:49152
    ds_read_b128 v[36:39], v26 offset:53248
    s_add_u32 s3, s52, 201728
    buffer_load_dwordx4 v[184:187], v21, s[44:47], s3 offen
    s_waitcnt vmcnt(28) lgkmcnt(4)
    v_mfma_f32_32x32x16_bf16 a[0:15], v[48:51], v[200:203], a[0:15]
    v_mfma_f32_32x32x16_bf16 a[16:31], v[52:55], v[200:203], a[16:31]
    ds_read_b128 v[40:43], v26 offset:50176
    ds_read_b128 v[44:47], v26 offset:54272
    s_add_u32 s3, s52, 216064
    buffer_load_dwordx4 v[188:191], v21, s[44:47], s3 offen
    s_waitcnt vmcnt(28) lgkmcnt(4)
    v_mfma_f32_32x32x16_bf16 a[0:15], v[56:59], v[204:207], a[0:15]
    v_mfma_f32_32x32x16_bf16 a[16:31], v[60:63], v[204:207], a[16:31]
    ds_read_b128 v[48:51], v26 offset:57344
    ds_read_b128 v[52:55], v26 offset:61440
    s_add_u32 s3, s52, 230400
    buffer_load_dwordx4 v[192:195], v21, s[44:47], s3 offen
    s_waitcnt vmcnt(28) lgkmcnt(4)
    v_mfma_f32_32x32x16_bf16 a[0:15], v[32:35], v[208:211], a[0:15]
    v_mfma_f32_32x32x16_bf16 a[16:31], v[36:39], v[208:211], a[16:31]
    ds_read_b128 v[56:59], v26 offset:58368
    ds_read_b128 v[60:63], v26 offset:62464
    s_add_u32 s3, s52, 244736
    buffer_load_dwordx4 v[196:199], v21, s[44:47], s3 offen
    s_waitcnt vmcnt(28) lgkmcnt(4)
    v_mfma_f32_32x32x16_bf16 a[0:15], v[40:43], v[212:215], a[0:15]
    v_mfma_f32_32x32x16_bf16 a[16:31], v[44:47], v[212:215], a[16:31]
    ds_read_b128 v[32:35], v21 offset:32768
    ds_read_b128 v[36:39], v21 offset:36864
    s_add_u32 s3, s52, 259072
    buffer_load_dwordx4 v[200:203], v21, s[44:47], s3 offen
    s_waitcnt vmcnt(28) lgkmcnt(4)
    v_mfma_f32_32x32x16_bf16 a[0:15], v[48:51], v[216:219], a[0:15]
    v_mfma_f32_32x32x16_bf16 a[16:31], v[52:55], v[216:219], a[16:31]
    ds_read_b128 v[40:43], v21 offset:33792
    ds_read_b128 v[44:47], v21 offset:37888
    s_add_u32 s3, s52, 273408
    buffer_load_dwordx4 v[204:207], v21, s[44:47], s3 offen
    s_waitcnt vmcnt(28) lgkmcnt(4)
    v_mfma_f32_32x32x16_bf16 a[0:15], v[56:59], v[220:223], a[0:15]
    v_mfma_f32_32x32x16_bf16 a[16:31], v[60:63], v[220:223], a[16:31]
    ds_read_b128 v[48:51], v21 offset:40960
    ds_read_b128 v[52:55], v21 offset:45056
    s_add_u32 s3, s52, 287744
    buffer_load_dwordx4 v[208:211], v21, s[44:47], s3 offen
    s_waitcnt vmcnt(28) lgkmcnt(4)
    v_mfma_f32_32x32x16_bf16 a[0:15], v[32:35], v[224:227], a[0:15]
    v_mfma_f32_32x32x16_bf16 a[16:31], v[36:39], v[224:227], a[16:31]
    ds_read_b128 v[56:59], v21 offset:41984
    ds_read_b128 v[60:63], v21 offset:46080
    s_add_u32 s3, s52, 302080
    buffer_load_dwordx4 v[212:215], v21, s[44:47], s3 offen
    s_waitcnt vmcnt(28) lgkmcnt(4)
    v_mfma_f32_32x32x16_bf16 a[0:15], v[40:43], v[228:231], a[0:15]
    v_mfma_f32_32x32x16_bf16 a[16:31], v[44:47], v[228:231], a[16:31]
    ds_read_b128 v[32:35], v21 offset:49152
    ds_read_b128 v[36:39], v21 offset:53248
    s_add_u32 s3, s52, 316416
    buffer_load_dwordx4 v[216:219], v21, s[44:47], s3 offen
    s_waitcnt vmcnt(28) lgkmcnt(4)
    v_mfma_f32_32x32x16_bf16 a[0:15], v[48:51], v[232:235], a[0:15]
    v_mfma_f32_32x32x16_bf16 a[16:31], v[52:55], v[232:235], a[16:31]
    ds_read_b128 v[40:43], v21 offset:50176
    ds_read_b128 v[44:47], v21 offset:54272
    s_add_u32 s3, s52, 330752
    buffer_load_dwordx4 v[220:223], v21, s[44:47], s3 offen
    s_waitcnt vmcnt(28) lgkmcnt(4)
    v_mfma_f32_32x32x16_bf16 a[0:15], v[56:59], v[236:239], a[0:15]
    v_mfma_f32_32x32x16_bf16 a[16:31], v[60:63], v[236:239], a[16:31]
    ds_read_b128 v[48:51], v21 offset:57344
    ds_read_b128 v[52:55], v21 offset:61440
    s_add_u32 s3, s52, 345088
    buffer_load_dwordx4 v[224:227], v21, s[44:47], s3 offen
    s_waitcnt vmcnt(28) lgkmcnt(4)
    v_mfma_f32_32x32x16_bf16 a[0:15], v[32:35], v[240:243], a[0:15]
    v_mfma_f32_32x32x16_bf16 a[16:31], v[36:39], v[240:243], a[16:31]
    ds_read_b128 v[56:59], v21 offset:58368
    ds_read_b128 v[60:63], v21 offset:62464
    s_add_u32 s3, s52, 359424
    buffer_load_dwordx4 v[228:231], v21, s[44:47], s3 offen
    s_waitcnt vmcnt(28) lgkmcnt(4)
    v_mfma_f32_32x32x16_bf16 a[0:15], v[40:43], v[244:247], a[0:15]
    v_mfma_f32_32x32x16_bf16 a[16:31], v[44:47], v[244:247], a[16:31]
    ds_read_b128 v[32:35], v26 offset:0
    ds_read_b128 v[36:39], v26 offset:4096
    s_add_u32 s3, s52, 373760
    buffer_load_dwordx4 v[232:235], v21, s[44:47], s3 offen
    s_waitcnt vmcnt(28) lgkmcnt(4)
    v_mfma_f32_32x32x16_bf16 a[0:15], v[48:51], v[248:251], a[0:15]
    v_mfma_f32_32x32x16_bf16 a[16:31], v[52:55], v[248:251], a[16:31]
    ds_read_b128 v[40:43], v26 offset:1024
    ds_read_b128 v[44:47], v26 offset:5120
    s_add_u32 s3, s52, 388096
    buffer_load_dwordx4 v[236:239], v21, s[44:47], s3 offen
    s_waitcnt vmcnt(28) lgkmcnt(4)
    v_mfma_f32_32x32x16_bf16 a[0:15], v[56:59], v[252:255], a[0:15]
    v_mfma_f32_32x32x16_bf16 a[16:31], v[60:63], v[252:255], a[16:31]
    ds_read_b128 v[48:51], v26 offset:8192
    ds_read_b128 v[52:55], v26 offset:12288
    s_add_u32 s3, s52, 402432
    buffer_load_dwordx4 v[240:243], v21, s[44:47], s3 offen
    s_waitcnt vmcnt(28) lgkmcnt(4)
    v_mfma_f32_32x32x16_bf16 a[32:47], v[32:35], v[128:131], 0
    v_mfma_f32_32x32x16_bf16 a[48:63], v[36:39], v[128:131], 0
    ds_read_b128 v[56:59], v26 offset:9216
    ds_read_b128 v[60:63], v26 offset:13312
    s_add_u32 s3, s52, 416768
    buffer_load_dwordx4 v[244:247], v21, s[44:47], s3 offen
    s_waitcnt vmcnt(28) lgkmcnt(4)
    v_mfma_f32_32x32x16_bf16 a[32:47], v[40:43], v[132:135], a[32:47]
    v_mfma_f32_32x32x16_bf16 a[48:63], v[44:47], v[132:135], a[48:63]
    ds_read_b128 v[32:35], v26 offset:16384
    ds_read_b128 v[36:39], v26 offset:20480
    s_add_u32 s3, s52, 431104
    buffer_load_dwordx4 v[248:251], v21, s[44:47], s3 offen
    s_waitcnt vmcnt(28) lgkmcnt(4)
    v_mfma_f32_32x32x16_bf16 a[32:47], v[48:51], v[136:139], a[32:47]
    v_mfma_f32_32x32x16_bf16 a[48:63], v[52:55], v[136:139], a[48:63]
    ds_read_b128 v[40:43], v26 offset:17408
    ds_read_b128 v[44:47], v26 offset:21504
    s_add_u32 s3, s52, 445440
    buffer_load_dwordx4 v[252:255], v21, s[44:47], s3 offen
    s_waitcnt vmcnt(28) lgkmcnt(4)
    v_mfma_f32_32x32x16_bf16 a[32:47], v[56:59], v[140:143], a[32:47]
    v_mfma_f32_32x32x16_bf16 a[48:63], v[60:63], v[140:143], a[48:63]
    ds_read_b128 v[48:51], v26 offset:24576
    ds_read_b128 v[52:55], v26 offset:28672
    s_add_u32 s3, s52, 2048
    buffer_load_dwordx4 v[128:131], v21, s[44:47], s3 offen
    s_waitcnt vmcnt(28) lgkmcnt(4)
    v_mfma_f32_32x32x16_bf16 a[32:47], v[32:35], v[144:147], a[32:47]
    v_mfma_f32_32x32x16_bf16 a[48:63], v[36:39], v[144:147], a[48:63]
    ds_read_b128 v[56:59], v26 offset:25600
    ds_read_b128 v[60:63], v26 offset:29696
    s_add_u32 s3, s52, 16384
    buffer_load_dwordx4 v[132:135], v21, s[44:47], s3 offen
    s_waitcnt vmcnt(28) lgkmcnt(4)
    v_mfma_f32_32x32x16_bf16 a[32:47], v[40:43], v[148:151], a[32:47]
    v_mfma_f32_32x32x16_bf16 a[48:63], v[44:47], v[148:151], a[48:63]
    ds_read_b128 v[32:35], v21 offset:0
    ds_read_b128 v[36:39], v21 offset:4096
    s_add_u32 s3, s52, 30720
    buffer_load_dwordx4 v[136:139], v21, s[44:47], s3 offen
    s_waitcnt vmcnt(28) lgkmcnt(4)
    v_mfma_f32_32x32x16_bf16 a[32:47], v[48:51], v[152:155], a[32:47]
    v_mfma_f32_32x32x16_bf16 a[48:63], v[52:55], v[152:155], a[48:63]
    ds_read_b128 v[40:43], v21 offset:1024
    ds_read_b128 v[44:47], v21 offset:5120
    s_add_u32 s3, s52, 45056
    buffer_load_dwordx4 v[140:143], v21, s[44:47], s3 offen
    s_waitcnt vmcnt(28) lgkmcnt(4)
    v_mfma_f32_32x32x16_bf16 a[32:47], v[56:59], v[156:159], a[32:47]
    v_mfma_f32_32x32x16_bf16 a[48:63], v[60:63], v[156:159], a[48:63]
    ds_read_b128 v[48:51], v21 offset:8192
    ds_read_b128 v[52:55], v21 offset:12288
    s_add_u32 s3, s52, 59392
    buffer_load_dwordx4 v[144:147], v21, s[44:47], s3 offen
    v_accvgpr_read_b32 v64, a0
    v_accvgpr_read_b32 v65, a1
    s_add_u32 s3, s42, 0
    v_cvt_pk_bf16_f32 v64, v64, v65
    buffer_store_dword v64, v24, s[48:51], s3 offen nt
    s_waitcnt vmcnt(29) lgkmcnt(4)
    v_mfma_f32_32x32x16_bf16 a[32:47], v[32:35], v[160:163], a[32:47]
    v_mfma_f32_32x32x16_bf16 a[48:63], v[36:39], v[160:163], a[48:63]
    ds_read_b128 v[56:59], v21 offset:9216
    ds_read_b128 v[60:63], v21 offset:13312
    s_add_u32 s3, s52, 73728
    buffer_load_dwordx4 v[148:151], v21, s[44:47], s3 offen
    v_accvgpr_read_b32 v66, a2
    v_accvgpr_read_b32 v67, a3
    s_add_u32 s3, s42, 1792
    v_cvt_pk_bf16_f32 v66, v66, v67
    buffer_store_dword v66, v24, s[48:51], s3 offen nt
    s_waitcnt vmcnt(30) lgkmcnt(4)
    v_mfma_f32_32x32x16_bf16 a[32:47], v[40:43], v[164:167], a[32:47]
    v_mfma_f32_32x32x16_bf16 a[48:63], v[44:47], v[164:167], a[48:63]
    ds_read_b128 v[32:35], v21 offset:16384
    ds_read_b128 v[36:39], v21 offset:20480
    s_add_u32 s3, s52, 88064
    buffer_load_dwordx4 v[152:155], v21, s[44:47], s3 offen
    v_accvgpr_read_b32 v68, a4
    v_accvgpr_read_b32 v69, a5
    s_add_u32 s3, s42, 7168
    v_cvt_pk_bf16_f32 v68, v68, v69
    buffer_store_dword v68, v24, s[48:51], s3 offen nt
    s_waitcnt vmcnt(31) lgkmcnt(4)
    v_mfma_f32_32x32x16_bf16 a[32:47], v[48:51], v[168:171], a[32:47]
    v_mfma_f32_32x32x16_bf16 a[48:63], v[52:55], v[168:171], a[48:63]
    ds_read_b128 v[40:43], v21 offset:17408
    ds_read_b128 v[44:47], v21 offset:21504
    s_add_u32 s3, s52, 102400
    buffer_load_dwordx4 v[156:159], v21, s[44:47], s3 offen
    v_accvgpr_read_b32 v70, a6
    v_accvgpr_read_b32 v71, a7
    s_add_u32 s3, s42, 8960
    v_cvt_pk_bf16_f32 v70, v70, v71
    buffer_store_dword v70, v24, s[48:51], s3 offen nt
    s_waitcnt vmcnt(32) lgkmcnt(4)
    v_mfma_f32_32x32x16_bf16 a[32:47], v[56:59], v[172:175], a[32:47]
    v_mfma_f32_32x32x16_bf16 a[48:63], v[60:63], v[172:175], a[48:63]
    ds_read_b128 v[48:51], v21 offset:24576
    ds_read_b128 v[52:55], v21 offset:28672
    s_add_u32 s3, s52, 116736
    buffer_load_dwordx4 v[160:163], v21, s[44:47], s3 offen
    v_accvgpr_read_b32 v72, a8
    v_accvgpr_read_b32 v73, a9
    s_add_u32 s3, s42, 14336
    v_cvt_pk_bf16_f32 v72, v72, v73
    buffer_store_dword v72, v24, s[48:51], s3 offen nt
    s_waitcnt vmcnt(33) lgkmcnt(4)
    v_mfma_f32_32x32x16_bf16 a[32:47], v[32:35], v[176:179], a[32:47]
    v_mfma_f32_32x32x16_bf16 a[48:63], v[36:39], v[176:179], a[48:63]
    ds_read_b128 v[56:59], v21 offset:25600
    ds_read_b128 v[60:63], v21 offset:29696
    s_add_u32 s3, s52, 131072
    buffer_load_dwordx4 v[164:167], v21, s[44:47], s3 offen
    v_accvgpr_read_b32 v74, a10
    v_accvgpr_read_b32 v75, a11
    s_add_u32 s3, s42, 16128
    v_cvt_pk_bf16_f32 v74, v74, v75
    buffer_store_dword v74, v24, s[48:51], s3 offen nt
    s_waitcnt vmcnt(34) lgkmcnt(4)
    v_mfma_f32_32x32x16_bf16 a[32:47], v[40:43], v[180:183], a[32:47]
    v_mfma_f32_32x32x16_bf16 a[48:63], v[44:47], v[180:183], a[48:63]
    ds_read_b128 v[32:35], v26 offset:32768
    ds_read_b128 v[36:39], v26 offset:36864
    s_add_u32 s3, s52, 145408
    buffer_load_dwordx4 v[168:171], v21, s[44:47], s3 offen
    v_accvgpr_read_b32 v76, a12
    v_accvgpr_read_b32 v77, a13
    s_add_u32 s3, s42, 21504
    v_cvt_pk_bf16_f32 v76, v76, v77
    buffer_store_dword v76, v24, s[48:51], s3 offen nt
    s_waitcnt vmcnt(35) lgkmcnt(4)
    v_mfma_f32_32x32x16_bf16 a[32:47], v[48:51], v[184:187], a[32:47]
    v_mfma_f32_32x32x16_bf16 a[48:63], v[52:55], v[184:187], a[48:63]
    ds_read_b128 v[40:43], v26 offset:33792
    ds_read_b128 v[44:47], v26 offset:37888
    s_add_u32 s3, s52, 159744
    buffer_load_dwordx4 v[172:175], v21, s[44:47], s3 offen
    v_accvgpr_read_b32 v78, a14
    v_accvgpr_read_b32 v79, a15
    s_add_u32 s3, s42, 23296
    v_cvt_pk_bf16_f32 v78, v78, v79
    buffer_store_dword v78, v24, s[48:51], s3 offen nt
    s_waitcnt vmcnt(36) lgkmcnt(4)
    v_mfma_f32_32x32x16_bf16 a[32:47], v[56:59], v[188:191], a[32:47]
    v_mfma_f32_32x32x16_bf16 a[48:63], v[60:63], v[188:191], a[48:63]
    ds_read_b128 v[48:51], v26 offset:40960
    ds_read_b128 v[52:55], v26 offset:45056
    s_add_u32 s3, s52, 174080
    buffer_load_dwordx4 v[176:179], v21, s[44:47], s3 offen
    v_accvgpr_read_b32 v64, a16
    v_accvgpr_read_b32 v65, a17
    s_add_u32 s3, s42, 28672
    v_cvt_pk_bf16_f32 v64, v64, v65
    buffer_store_dword v64, v24, s[48:51], s3 offen nt
    s_waitcnt vmcnt(37) lgkmcnt(4)
    v_mfma_f32_32x32x16_bf16 a[32:47], v[32:35], v[192:195], a[32:47]
    v_mfma_f32_32x32x16_bf16 a[48:63], v[36:39], v[192:195], a[48:63]
    ds_read_b128 v[56:59], v26 offset:41984
    ds_read_b128 v[60:63], v26 offset:46080
    s_add_u32 s3, s52, 188416
    buffer_load_dwordx4 v[180:183], v21, s[44:47], s3 offen
    v_accvgpr_read_b32 v66, a18
    v_accvgpr_read_b32 v67, a19
    s_add_u32 s3, s42, 30464
    v_cvt_pk_bf16_f32 v66, v66, v67
    buffer_store_dword v66, v24, s[48:51], s3 offen nt
    s_waitcnt vmcnt(38) lgkmcnt(4)
    v_mfma_f32_32x32x16_bf16 a[32:47], v[40:43], v[196:199], a[32:47]
    v_mfma_f32_32x32x16_bf16 a[48:63], v[44:47], v[196:199], a[48:63]
    ds_read_b128 v[32:35], v26 offset:49152
    ds_read_b128 v[36:39], v26 offset:53248
    s_add_u32 s3, s52, 202752
    buffer_load_dwordx4 v[184:187], v21, s[44:47], s3 offen
    v_accvgpr_read_b32 v68, a20
    v_accvgpr_read_b32 v69, a21
    s_add_u32 s3, s42, 35840
    v_cvt_pk_bf16_f32 v68, v68, v69
    buffer_store_dword v68, v24, s[48:51], s3 offen nt
    s_waitcnt vmcnt(39) lgkmcnt(4)
    v_mfma_f32_32x32x16_bf16 a[32:47], v[48:51], v[200:203], a[32:47]
    v_mfma_f32_32x32x16_bf16 a[48:63], v[52:55], v[200:203], a[48:63]
    ds_read_b128 v[40:43], v26 offset:50176
    ds_read_b128 v[44:47], v26 offset:54272
    s_add_u32 s3, s52, 217088
    buffer_load_dwordx4 v[188:191], v21, s[44:47], s3 offen
    v_accvgpr_read_b32 v70, a22
    v_accvgpr_read_b32 v71, a23
    s_add_u32 s3, s42, 37632
    v_cvt_pk_bf16_f32 v70, v70, v71
    buffer_store_dword v70, v24, s[48:51], s3 offen nt
    s_waitcnt vmcnt(40) lgkmcnt(4)
    v_mfma_f32_32x32x16_bf16 a[32:47], v[56:59], v[204:207], a[32:47]
    v_mfma_f32_32x32x16_bf16 a[48:63], v[60:63], v[204:207], a[48:63]
    ds_read_b128 v[48:51], v26 offset:57344
    ds_read_b128 v[52:55], v26 offset:61440
    s_add_u32 s3, s52, 231424
    buffer_load_dwordx4 v[192:195], v21, s[44:47], s3 offen
    v_accvgpr_read_b32 v72, a24
    v_accvgpr_read_b32 v73, a25
    s_add_u32 s3, s42, 43008
    v_cvt_pk_bf16_f32 v72, v72, v73
    buffer_store_dword v72, v24, s[48:51], s3 offen nt
    s_waitcnt vmcnt(41) lgkmcnt(4)
    v_mfma_f32_32x32x16_bf16 a[32:47], v[32:35], v[208:211], a[32:47]
    v_mfma_f32_32x32x16_bf16 a[48:63], v[36:39], v[208:211], a[48:63]
    ds_read_b128 v[56:59], v26 offset:58368
    ds_read_b128 v[60:63], v26 offset:62464
    s_add_u32 s3, s52, 245760
    buffer_load_dwordx4 v[196:199], v21, s[44:47], s3 offen
    v_accvgpr_read_b32 v74, a26
    v_accvgpr_read_b32 v75, a27
    s_add_u32 s3, s42, 44800
    v_cvt_pk_bf16_f32 v74, v74, v75
    buffer_store_dword v74, v24, s[48:51], s3 offen nt
    s_waitcnt vmcnt(42) lgkmcnt(4)
    v_mfma_f32_32x32x16_bf16 a[32:47], v[40:43], v[212:215], a[32:47]
    v_mfma_f32_32x32x16_bf16 a[48:63], v[44:47], v[212:215], a[48:63]
    ds_read_b128 v[32:35], v21 offset:32768
    ds_read_b128 v[36:39], v21 offset:36864
    s_add_u32 s3, s52, 260096
    buffer_load_dwordx4 v[200:203], v21, s[44:47], s3 offen
    v_accvgpr_read_b32 v76, a28
    v_accvgpr_read_b32 v77, a29
    s_add_u32 s3, s42, 50176
    v_cvt_pk_bf16_f32 v76, v76, v77
    buffer_store_dword v76, v24, s[48:51], s3 offen nt
    s_waitcnt vmcnt(43) lgkmcnt(4)
    v_mfma_f32_32x32x16_bf16 a[32:47], v[48:51], v[216:219], a[32:47]
    v_mfma_f32_32x32x16_bf16 a[48:63], v[52:55], v[216:219], a[48:63]
    ds_read_b128 v[40:43], v21 offset:33792
    ds_read_b128 v[44:47], v21 offset:37888
    s_add_u32 s3, s52, 274432
    buffer_load_dwordx4 v[204:207], v21, s[44:47], s3 offen
    v_accvgpr_read_b32 v78, a30
    v_accvgpr_read_b32 v79, a31
    s_add_u32 s3, s42, 51968
    v_cvt_pk_bf16_f32 v78, v78, v79
    buffer_store_dword v78, v24, s[48:51], s3 offen nt
    s_waitcnt vmcnt(44) lgkmcnt(4)
    v_mfma_f32_32x32x16_bf16 a[32:47], v[56:59], v[220:223], a[32:47]
    v_mfma_f32_32x32x16_bf16 a[48:63], v[60:63], v[220:223], a[48:63]
    ds_read_b128 v[48:51], v21 offset:40960
    ds_read_b128 v[52:55], v21 offset:45056
    s_add_u32 s3, s52, 288768
    buffer_load_dwordx4 v[208:211], v21, s[44:47], s3 offen
    s_waitcnt vmcnt(44) lgkmcnt(4)
    v_mfma_f32_32x32x16_bf16 a[32:47], v[32:35], v[224:227], a[32:47]
    v_mfma_f32_32x32x16_bf16 a[48:63], v[36:39], v[224:227], a[48:63]
    ds_read_b128 v[56:59], v21 offset:41984
    ds_read_b128 v[60:63], v21 offset:46080
    s_add_u32 s3, s52, 303104
    buffer_load_dwordx4 v[212:215], v21, s[44:47], s3 offen
    s_waitcnt vmcnt(44) lgkmcnt(4)
    v_mfma_f32_32x32x16_bf16 a[32:47], v[40:43], v[228:231], a[32:47]
    v_mfma_f32_32x32x16_bf16 a[48:63], v[44:47], v[228:231], a[48:63]
    ds_read_b128 v[32:35], v21 offset:49152
    ds_read_b128 v[36:39], v21 offset:53248
    s_add_u32 s3, s52, 317440
    buffer_load_dwordx4 v[216:219], v21, s[44:47], s3 offen
    s_waitcnt vmcnt(44) lgkmcnt(4)
    v_mfma_f32_32x32x16_bf16 a[32:47], v[48:51], v[232:235], a[32:47]
    v_mfma_f32_32x32x16_bf16 a[48:63], v[52:55], v[232:235], a[48:63]
    ds_read_b128 v[40:43], v21 offset:50176
    ds_read_b128 v[44:47], v21 offset:54272
    s_add_u32 s3, s52, 331776
    buffer_load_dwordx4 v[220:223], v21, s[44:47], s3 offen
    s_waitcnt vmcnt(44) lgkmcnt(4)
    v_mfma_f32_32x32x16_bf16 a[32:47], v[56:59], v[236:239], a[32:47]
    v_mfma_f32_32x32x16_bf16 a[48:63], v[60:63], v[236:239], a[48:63]
    ds_read_b128 v[48:51], v21 offset:57344
    ds_read_b128 v[52:55], v21 offset:61440
    s_add_u32 s3, s52, 346112
    buffer_load_dwordx4 v[224:227], v21, s[44:47], s3 offen
    s_waitcnt vmcnt(44) lgkmcnt(4)
    v_mfma_f32_32x32x16_bf16 a[32:47], v[32:35], v[240:243], a[32:47]
    v_mfma_f32_32x32x16_bf16 a[48:63], v[36:39], v[240:243], a[48:63]
    ds_read_b128 v[56:59], v21 offset:58368
    ds_read_b128 v[60:63], v21 offset:62464
    s_add_u32 s3, s52, 360448
    buffer_load_dwordx4 v[228:231], v21, s[44:47], s3 offen
    s_waitcnt vmcnt(44) lgkmcnt(4)
    v_mfma_f32_32x32x16_bf16 a[32:47], v[40:43], v[244:247], a[32:47]
    v_mfma_f32_32x32x16_bf16 a[48:63], v[44:47], v[244:247], a[48:63]
    ds_read_b128 v[32:35], v26 offset:0
    ds_read_b128 v[36:39], v26 offset:4096
    s_add_u32 s3, s52, 374784
    buffer_load_dwordx4 v[232:235], v21, s[44:47], s3 offen
    s_waitcnt vmcnt(44) lgkmcnt(4)
    v_mfma_f32_32x32x16_bf16 a[32:47], v[48:51], v[248:251], a[32:47]
    v_mfma_f32_32x32x16_bf16 a[48:63], v[52:55], v[248:251], a[48:63]
    ds_read_b128 v[40:43], v26 offset:1024
    ds_read_b128 v[44:47], v26 offset:5120
    s_add_u32 s3, s52, 389120
    buffer_load_dwordx4 v[236:239], v21, s[44:47], s3 offen
    s_waitcnt vmcnt(44) lgkmcnt(4)
    v_mfma_f32_32x32x16_bf16 a[32:47], v[56:59], v[252:255], a[32:47]
    v_mfma_f32_32x32x16_bf16 a[48:63], v[60:63], v[252:255], a[48:63]
    ds_read_b128 v[48:51], v26 offset:8192
    ds_read_b128 v[52:55], v26 offset:12288
    s_add_u32 s3, s52, 403456
    buffer_load_dwordx4 v[240:243], v21, s[44:47], s3 offen
    s_waitcnt vmcnt(44) lgkmcnt(4)
    v_mfma_f32_32x32x16_bf16 a[64:79], v[32:35], v[128:131], 0
    v_mfma_f32_32x32x16_bf16 a[80:95], v[36:39], v[128:131], 0
    ds_read_b128 v[56:59], v26 offset:9216
    ds_read_b128 v[60:63], v26 offset:13312
    s_add_u32 s3, s52, 417792
    buffer_load_dwordx4 v[244:247], v21, s[44:47], s3 offen
    s_waitcnt vmcnt(44) lgkmcnt(4)
    v_mfma_f32_32x32x16_bf16 a[64:79], v[40:43], v[132:135], a[64:79]
    v_mfma_f32_32x32x16_bf16 a[80:95], v[44:47], v[132:135], a[80:95]
    ds_read_b128 v[32:35], v26 offset:16384
    ds_read_b128 v[36:39], v26 offset:20480
    s_add_u32 s3, s52, 432128
    buffer_load_dwordx4 v[248:251], v21, s[44:47], s3 offen
    s_waitcnt vmcnt(44) lgkmcnt(4)
    v_mfma_f32_32x32x16_bf16 a[64:79], v[48:51], v[136:139], a[64:79]
    v_mfma_f32_32x32x16_bf16 a[80:95], v[52:55], v[136:139], a[80:95]
    ds_read_b128 v[40:43], v26 offset:17408
    ds_read_b128 v[44:47], v26 offset:21504
    s_add_u32 s3, s52, 446464
    buffer_load_dwordx4 v[252:255], v21, s[44:47], s3 offen
    s_waitcnt vmcnt(44) lgkmcnt(4)
    v_mfma_f32_32x32x16_bf16 a[64:79], v[56:59], v[140:143], a[64:79]
    v_mfma_f32_32x32x16_bf16 a[80:95], v[60:63], v[140:143], a[80:95]
    ds_read_b128 v[48:51], v26 offset:24576
    ds_read_b128 v[52:55], v26 offset:28672
    s_add_u32 s3, s53, 0
    buffer_load_dwordx4 v[128:131], v21, s[44:47], s3 offen
    s_waitcnt vmcnt(44) lgkmcnt(4)
    v_mfma_f32_32x32x16_bf16 a[64:79], v[32:35], v[144:147], a[64:79]
    v_mfma_f32_32x32x16_bf16 a[80:95], v[36:39], v[144:147], a[80:95]
    ds_read_b128 v[56:59], v26 offset:25600
    ds_read_b128 v[60:63], v26 offset:29696
    s_add_u32 s3, s53, 14336
    buffer_load_dwordx4 v[132:135], v21, s[44:47], s3 offen
    s_waitcnt vmcnt(43) lgkmcnt(4)
    v_mfma_f32_32x32x16_bf16 a[64:79], v[40:43], v[148:151], a[64:79]
    v_mfma_f32_32x32x16_bf16 a[80:95], v[44:47], v[148:151], a[80:95]
    ds_read_b128 v[32:35], v21 offset:0
    ds_read_b128 v[36:39], v21 offset:4096
    s_add_u32 s3, s53, 28672
    buffer_load_dwordx4 v[136:139], v21, s[44:47], s3 offen
    s_waitcnt vmcnt(42) lgkmcnt(4)
    v_mfma_f32_32x32x16_bf16 a[64:79], v[48:51], v[152:155], a[64:79]
    v_mfma_f32_32x32x16_bf16 a[80:95], v[52:55], v[152:155], a[80:95]
    ds_read_b128 v[40:43], v21 offset:1024
    ds_read_b128 v[44:47], v21 offset:5120
    s_add_u32 s3, s53, 43008
    buffer_load_dwordx4 v[140:143], v21, s[44:47], s3 offen
    s_waitcnt vmcnt(41) lgkmcnt(4)
    v_mfma_f32_32x32x16_bf16 a[64:79], v[56:59], v[156:159], a[64:79]
    v_mfma_f32_32x32x16_bf16 a[80:95], v[60:63], v[156:159], a[80:95]
    ds_read_b128 v[48:51], v21 offset:8192
    ds_read_b128 v[52:55], v21 offset:12288
    s_add_u32 s3, s53, 57344
    buffer_load_dwordx4 v[144:147], v21, s[44:47], s3 offen
    v_accvgpr_read_b32 v64, a32
    v_accvgpr_read_b32 v65, a33
    s_add_u32 s3, s42, 128
    v_cvt_pk_bf16_f32 v64, v64, v65
    buffer_store_dword v64, v24, s[48:51], s3 offen nt
    s_waitcnt vmcnt(41) lgkmcnt(4)
    v_mfma_f32_32x32x16_bf16 a[64:79], v[32:35], v[160:163], a[64:79]
    v_mfma_f32_32x32x16_bf16 a[80:95], v[36:39], v[160:163], a[80:95]
    ds_read_b128 v[56:59], v21 offset:9216
    ds_read_b128 v[60:63], v21 offset:13312
    s_add_u32 s3, s53, 71680
    buffer_load_dwordx4 v[148:151], v21, s[44:47], s3 offen
    v_accvgpr_read_b32 v66, a34
    v_accvgpr_read_b32 v67, a35
    s_add_u32 s3, s42, 1920
    v_cvt_pk_bf16_f32 v66, v66, v67
    buffer_store_dword v66, v24, s[48:51], s3 offen nt
    s_waitcnt vmcnt(41) lgkmcnt(4)
    v_mfma_f32_32x32x16_bf16 a[64:79], v[40:43], v[164:167], a[64:79]
    v_mfma_f32_32x32x16_bf16 a[80:95], v[44:47], v[164:167], a[80:95]
    ds_read_b128 v[32:35], v21 offset:16384
    ds_read_b128 v[36:39], v21 offset:20480
    s_add_u32 s3, s53, 86016
    buffer_load_dwordx4 v[152:155], v21, s[44:47], s3 offen
    v_accvgpr_read_b32 v68, a36
    v_accvgpr_read_b32 v69, a37
    s_add_u32 s3, s42, 7296
    v_cvt_pk_bf16_f32 v68, v68, v69
    buffer_store_dword v68, v24, s[48:51], s3 offen nt
    s_waitcnt vmcnt(41) lgkmcnt(4)
    v_mfma_f32_32x32x16_bf16 a[64:79], v[48:51], v[168:171], a[64:79]
    v_mfma_f32_32x32x16_bf16 a[80:95], v[52:55], v[168:171], a[80:95]
    ds_read_b128 v[40:43], v21 offset:17408
    ds_read_b128 v[44:47], v21 offset:21504
    s_add_u32 s3, s53, 100352
    buffer_load_dwordx4 v[156:159], v21, s[44:47], s3 offen
    v_accvgpr_read_b32 v70, a38
    v_accvgpr_read_b32 v71, a39
    s_add_u32 s3, s42, 9088
    v_cvt_pk_bf16_f32 v70, v70, v71
    buffer_store_dword v70, v24, s[48:51], s3 offen nt
    s_waitcnt vmcnt(41) lgkmcnt(4)
    v_mfma_f32_32x32x16_bf16 a[64:79], v[56:59], v[172:175], a[64:79]
    v_mfma_f32_32x32x16_bf16 a[80:95], v[60:63], v[172:175], a[80:95]
    ds_read_b128 v[48:51], v21 offset:24576
    ds_read_b128 v[52:55], v21 offset:28672
    s_add_u32 s3, s53, 114688
    buffer_load_dwordx4 v[160:163], v21, s[44:47], s3 offen
    v_accvgpr_read_b32 v72, a40
    v_accvgpr_read_b32 v73, a41
    s_add_u32 s3, s42, 14464
    v_cvt_pk_bf16_f32 v72, v72, v73
    buffer_store_dword v72, v24, s[48:51], s3 offen nt
    s_waitcnt vmcnt(41) lgkmcnt(4)
    v_mfma_f32_32x32x16_bf16 a[64:79], v[32:35], v[176:179], a[64:79]
    v_mfma_f32_32x32x16_bf16 a[80:95], v[36:39], v[176:179], a[80:95]
    ds_read_b128 v[56:59], v21 offset:25600
    ds_read_b128 v[60:63], v21 offset:29696
    s_add_u32 s3, s53, 129024
    buffer_load_dwordx4 v[164:167], v21, s[44:47], s3 offen
    v_accvgpr_read_b32 v74, a42
    v_accvgpr_read_b32 v75, a43
    s_add_u32 s3, s42, 16256
    v_cvt_pk_bf16_f32 v74, v74, v75
    buffer_store_dword v74, v24, s[48:51], s3 offen nt
    s_waitcnt vmcnt(41) lgkmcnt(4)
    v_mfma_f32_32x32x16_bf16 a[64:79], v[40:43], v[180:183], a[64:79]
    v_mfma_f32_32x32x16_bf16 a[80:95], v[44:47], v[180:183], a[80:95]
    ds_read_b128 v[32:35], v26 offset:32768
    ds_read_b128 v[36:39], v26 offset:36864
    s_add_u32 s3, s53, 143360
    buffer_load_dwordx4 v[168:171], v21, s[44:47], s3 offen
    v_accvgpr_read_b32 v76, a44
    v_accvgpr_read_b32 v77, a45
    s_add_u32 s3, s42, 21632
    v_cvt_pk_bf16_f32 v76, v76, v77
    buffer_store_dword v76, v24, s[48:51], s3 offen nt
    s_waitcnt vmcnt(41) lgkmcnt(4)
    v_mfma_f32_32x32x16_bf16 a[64:79], v[48:51], v[184:187], a[64:79]
    v_mfma_f32_32x32x16_bf16 a[80:95], v[52:55], v[184:187], a[80:95]
    ds_read_b128 v[40:43], v26 offset:33792
    ds_read_b128 v[44:47], v26 offset:37888
    s_add_u32 s3, s53, 157696
    buffer_load_dwordx4 v[172:175], v21, s[44:47], s3 offen
    v_accvgpr_read_b32 v78, a46
    v_accvgpr_read_b32 v79, a47
    s_add_u32 s3, s42, 23424
    v_cvt_pk_bf16_f32 v78, v78, v79
    buffer_store_dword v78, v24, s[48:51], s3 offen nt
    s_waitcnt vmcnt(41) lgkmcnt(4)
    v_mfma_f32_32x32x16_bf16 a[64:79], v[56:59], v[188:191], a[64:79]
    v_mfma_f32_32x32x16_bf16 a[80:95], v[60:63], v[188:191], a[80:95]
    ds_read_b128 v[48:51], v26 offset:40960
    ds_read_b128 v[52:55], v26 offset:45056
    s_add_u32 s3, s53, 172032
    buffer_load_dwordx4 v[176:179], v21, s[44:47], s3 offen
    v_accvgpr_read_b32 v64, a48
    v_accvgpr_read_b32 v65, a49
    s_add_u32 s3, s42, 28800
    v_cvt_pk_bf16_f32 v64, v64, v65
    buffer_store_dword v64, v24, s[48:51], s3 offen nt
    s_waitcnt vmcnt(41) lgkmcnt(4)
    v_mfma_f32_32x32x16_bf16 a[64:79], v[32:35], v[192:195], a[64:79]
    v_mfma_f32_32x32x16_bf16 a[80:95], v[36:39], v[192:195], a[80:95]
    ds_read_b128 v[56:59], v26 offset:41984
    ds_read_b128 v[60:63], v26 offset:46080
    s_add_u32 s3, s53, 186368
    buffer_load_dwordx4 v[180:183], v21, s[44:47], s3 offen
    v_accvgpr_read_b32 v66, a50
    v_accvgpr_read_b32 v67, a51
    s_add_u32 s3, s42, 30592
    v_cvt_pk_bf16_f32 v66, v66, v67
    buffer_store_dword v66, v24, s[48:51], s3 offen nt
    s_waitcnt vmcnt(41) lgkmcnt(4)
    v_mfma_f32_32x32x16_bf16 a[64:79], v[40:43], v[196:199], a[64:79]
    v_mfma_f32_32x32x16_bf16 a[80:95], v[44:47], v[196:199], a[80:95]
    ds_read_b128 v[32:35], v26 offset:49152
    ds_read_b128 v[36:39], v26 offset:53248
    s_add_u32 s3, s53, 200704
    buffer_load_dwordx4 v[184:187], v21, s[44:47], s3 offen
    v_accvgpr_read_b32 v68, a52
    v_accvgpr_read_b32 v69, a53
    s_add_u32 s3, s42, 35968
    v_cvt_pk_bf16_f32 v68, v68, v69
    buffer_store_dword v68, v24, s[48:51], s3 offen nt
    s_waitcnt vmcnt(41) lgkmcnt(4)
    v_mfma_f32_32x32x16_bf16 a[64:79], v[48:51], v[200:203], a[64:79]
    v_mfma_f32_32x32x16_bf16 a[80:95], v[52:55], v[200:203], a[80:95]
    ds_read_b128 v[40:43], v26 offset:50176
    ds_read_b128 v[44:47], v26 offset:54272
    s_add_u32 s3, s53, 215040
    buffer_load_dwordx4 v[188:191], v21, s[44:47], s3 offen
    v_accvgpr_read_b32 v70, a54
    v_accvgpr_read_b32 v71, a55
    s_add_u32 s3, s42, 37760
    v_cvt_pk_bf16_f32 v70, v70, v71
    buffer_store_dword v70, v24, s[48:51], s3 offen nt
    s_waitcnt vmcnt(41) lgkmcnt(4)
    v_mfma_f32_32x32x16_bf16 a[64:79], v[56:59], v[204:207], a[64:79]
    v_mfma_f32_32x32x16_bf16 a[80:95], v[60:63], v[204:207], a[80:95]
    ds_read_b128 v[48:51], v26 offset:57344
    ds_read_b128 v[52:55], v26 offset:61440
    s_add_u32 s3, s53, 229376
    buffer_load_dwordx4 v[192:195], v21, s[44:47], s3 offen
    v_accvgpr_read_b32 v72, a56
    v_accvgpr_read_b32 v73, a57
    s_add_u32 s3, s42, 43136
    v_cvt_pk_bf16_f32 v72, v72, v73
    buffer_store_dword v72, v24, s[48:51], s3 offen nt
    s_waitcnt vmcnt(41) lgkmcnt(4)
    v_mfma_f32_32x32x16_bf16 a[64:79], v[32:35], v[208:211], a[64:79]
    v_mfma_f32_32x32x16_bf16 a[80:95], v[36:39], v[208:211], a[80:95]
    ds_read_b128 v[56:59], v26 offset:58368
    ds_read_b128 v[60:63], v26 offset:62464
    s_add_u32 s3, s53, 243712
    buffer_load_dwordx4 v[196:199], v21, s[44:47], s3 offen
    v_accvgpr_read_b32 v74, a58
    v_accvgpr_read_b32 v75, a59
    s_add_u32 s3, s42, 44928
    v_cvt_pk_bf16_f32 v74, v74, v75
    buffer_store_dword v74, v24, s[48:51], s3 offen nt
    s_waitcnt vmcnt(42) lgkmcnt(4)
    v_mfma_f32_32x32x16_bf16 a[64:79], v[40:43], v[212:215], a[64:79]
    v_mfma_f32_32x32x16_bf16 a[80:95], v[44:47], v[212:215], a[80:95]
    ds_read_b128 v[32:35], v21 offset:32768
    ds_read_b128 v[36:39], v21 offset:36864
    s_add_u32 s3, s53, 258048
    buffer_load_dwordx4 v[200:203], v21, s[44:47], s3 offen
    v_accvgpr_read_b32 v76, a60
    v_accvgpr_read_b32 v77, a61
    s_add_u32 s3, s42, 50304
    v_cvt_pk_bf16_f32 v76, v76, v77
    buffer_store_dword v76, v24, s[48:51], s3 offen nt
    s_waitcnt vmcnt(43) lgkmcnt(4)
    v_mfma_f32_32x32x16_bf16 a[64:79], v[48:51], v[216:219], a[64:79]
    v_mfma_f32_32x32x16_bf16 a[80:95], v[52:55], v[216:219], a[80:95]
    ds_read_b128 v[40:43], v21 offset:33792
    ds_read_b128 v[44:47], v21 offset:37888
    s_add_u32 s3, s53, 272384
    buffer_load_dwordx4 v[204:207], v21, s[44:47], s3 offen
    v_accvgpr_read_b32 v78, a62
    v_accvgpr_read_b32 v79, a63
    s_add_u32 s3, s42, 52096
    v_cvt_pk_bf16_f32 v78, v78, v79
    buffer_store_dword v78, v24, s[48:51], s3 offen nt
    s_waitcnt vmcnt(44) lgkmcnt(4)
    v_mfma_f32_32x32x16_bf16 a[64:79], v[56:59], v[220:223], a[64:79]
    v_mfma_f32_32x32x16_bf16 a[80:95], v[60:63], v[220:223], a[80:95]
    ds_read_b128 v[48:51], v21 offset:40960
    ds_read_b128 v[52:55], v21 offset:45056
    s_add_u32 s3, s53, 286720
    buffer_load_dwordx4 v[208:211], v21, s[44:47], s3 offen
    s_waitcnt vmcnt(44) lgkmcnt(4)
    v_mfma_f32_32x32x16_bf16 a[64:79], v[32:35], v[224:227], a[64:79]
    v_mfma_f32_32x32x16_bf16 a[80:95], v[36:39], v[224:227], a[80:95]
    ds_read_b128 v[56:59], v21 offset:41984
    ds_read_b128 v[60:63], v21 offset:46080
    s_add_u32 s3, s53, 301056
    buffer_load_dwordx4 v[212:215], v21, s[44:47], s3 offen
    s_waitcnt vmcnt(44) lgkmcnt(4)
    v_mfma_f32_32x32x16_bf16 a[64:79], v[40:43], v[228:231], a[64:79]
    v_mfma_f32_32x32x16_bf16 a[80:95], v[44:47], v[228:231], a[80:95]
    ds_read_b128 v[32:35], v21 offset:49152
    ds_read_b128 v[36:39], v21 offset:53248
    s_add_u32 s3, s53, 315392
    buffer_load_dwordx4 v[216:219], v21, s[44:47], s3 offen
    s_waitcnt vmcnt(44) lgkmcnt(4)
    v_mfma_f32_32x32x16_bf16 a[64:79], v[48:51], v[232:235], a[64:79]
    v_mfma_f32_32x32x16_bf16 a[80:95], v[52:55], v[232:235], a[80:95]
    ds_read_b128 v[40:43], v21 offset:50176
    ds_read_b128 v[44:47], v21 offset:54272
    s_add_u32 s3, s53, 329728
    buffer_load_dwordx4 v[220:223], v21, s[44:47], s3 offen
    s_waitcnt vmcnt(44) lgkmcnt(4)
    v_mfma_f32_32x32x16_bf16 a[64:79], v[56:59], v[236:239], a[64:79]
    v_mfma_f32_32x32x16_bf16 a[80:95], v[60:63], v[236:239], a[80:95]
    ds_read_b128 v[48:51], v21 offset:57344
    ds_read_b128 v[52:55], v21 offset:61440
    s_add_u32 s3, s53, 344064
    buffer_load_dwordx4 v[224:227], v21, s[44:47], s3 offen
    s_waitcnt vmcnt(44) lgkmcnt(4)
    v_mfma_f32_32x32x16_bf16 a[64:79], v[32:35], v[240:243], a[64:79]
    v_mfma_f32_32x32x16_bf16 a[80:95], v[36:39], v[240:243], a[80:95]
    ds_read_b128 v[56:59], v21 offset:58368
    ds_read_b128 v[60:63], v21 offset:62464
    s_add_u32 s3, s53, 358400
    buffer_load_dwordx4 v[228:231], v21, s[44:47], s3 offen
    s_waitcnt vmcnt(44) lgkmcnt(4)
    v_mfma_f32_32x32x16_bf16 a[64:79], v[40:43], v[244:247], a[64:79]
    v_mfma_f32_32x32x16_bf16 a[80:95], v[44:47], v[244:247], a[80:95]
    ds_read_b128 v[32:35], v28 offset:0
    s_add_u32 s3, s53, 372736
    buffer_load_dwordx4 v[232:235], v21, s[44:47], s3 offen
    s_waitcnt vmcnt(44) lgkmcnt(3)
    v_mfma_f32_32x32x16_bf16 a[64:79], v[48:51], v[248:251], a[64:79]
    v_mfma_f32_32x32x16_bf16 a[80:95], v[52:55], v[248:251], a[80:95]
    ds_read_b128 v[40:43], v28 offset:1024
    s_add_u32 s3, s53, 387072
    buffer_load_dwordx4 v[236:239], v21, s[44:47], s3 offen
    s_waitcnt vmcnt(44) lgkmcnt(2)
    v_mfma_f32_32x32x16_bf16 a[64:79], v[56:59], v[252:255], a[64:79]
    v_mfma_f32_32x32x16_bf16 a[80:95], v[60:63], v[252:255], a[80:95]
    ds_read_b128 v[48:51], v28 offset:8192
    s_add_u32 s3, s53, 401408
    buffer_load_dwordx4 v[240:243], v21, s[44:47], s3 offen
    s_waitcnt vmcnt(44) lgkmcnt(2)
    v_mfma_f32_32x32x16_bf16 a[96:111], v[32:35], v[128:131], 0
    ds_read_b128 v[56:59], v28 offset:9216
    s_add_u32 s3, s53, 415744
    buffer_load_dwordx4 v[244:247], v21, s[44:47], s3 offen
    s_waitcnt vmcnt(44) lgkmcnt(2)
    v_mfma_f32_32x32x16_bf16 a[96:111], v[40:43], v[132:135], a[96:111]
    ds_read_b128 v[32:35], v28 offset:16384
    s_add_u32 s3, s53, 430080
    buffer_load_dwordx4 v[248:251], v21, s[44:47], s3 offen
    s_waitcnt vmcnt(44) lgkmcnt(2)
    v_mfma_f32_32x32x16_bf16 a[96:111], v[48:51], v[136:139], a[96:111]
    ds_read_b128 v[40:43], v28 offset:17408
    s_add_u32 s3, s53, 444416
    buffer_load_dwordx4 v[252:255], v21, s[44:47], s3 offen
    s_waitcnt vmcnt(44) lgkmcnt(2)
    v_mfma_f32_32x32x16_bf16 a[96:111], v[56:59], v[140:143], a[96:111]
    ds_read_b128 v[48:51], v28 offset:24576
    s_waitcnt vmcnt(43) lgkmcnt(2)
    v_mfma_f32_32x32x16_bf16 a[96:111], v[32:35], v[144:147], a[96:111]
    ds_read_b128 v[56:59], v28 offset:25600
    s_waitcnt vmcnt(41) lgkmcnt(2)
    v_mfma_f32_32x32x16_bf16 a[96:111], v[40:43], v[148:151], a[96:111]
    ds_read_b128 v[32:35], v27 offset:0
    s_waitcnt vmcnt(39) lgkmcnt(2)
    v_mfma_f32_32x32x16_bf16 a[96:111], v[48:51], v[152:155], a[96:111]
    ds_read_b128 v[40:43], v27 offset:1024
    s_waitcnt vmcnt(37) lgkmcnt(2)
    v_mfma_f32_32x32x16_bf16 a[96:111], v[56:59], v[156:159], a[96:111]
    ds_read_b128 v[48:51], v27 offset:8192
    v_accvgpr_read_b32 v64, a64
    v_accvgpr_read_b32 v65, a65
    s_add_u32 s3, s42, 256
    v_cvt_pk_bf16_f32 v64, v64, v65
    buffer_store_dword v64, v24, s[48:51], s3 offen nt
    s_waitcnt vmcnt(36) lgkmcnt(2)
    v_mfma_f32_32x32x16_bf16 a[96:111], v[32:35], v[160:163], a[96:111]
    ds_read_b128 v[56:59], v27 offset:9216
    v_accvgpr_read_b32 v66, a66
    v_accvgpr_read_b32 v67, a67
    s_add_u32 s3, s42, 2048
    v_cvt_pk_bf16_f32 v66, v66, v67
    buffer_store_dword v66, v24, s[48:51], s3 offen nt
    s_waitcnt vmcnt(35) lgkmcnt(2)
    v_mfma_f32_32x32x16_bf16 a[96:111], v[40:43], v[164:167], a[96:111]
    ds_read_b128 v[32:35], v27 offset:16384
    v_accvgpr_read_b32 v68, a68
    v_accvgpr_read_b32 v69, a69
    s_add_u32 s3, s42, 7424
    v_cvt_pk_bf16_f32 v68, v68, v69
    buffer_store_dword v68, v24, s[48:51], s3 offen nt
    s_waitcnt vmcnt(34) lgkmcnt(2)
    v_mfma_f32_32x32x16_bf16 a[96:111], v[48:51], v[168:171], a[96:111]
    ds_read_b128 v[40:43], v27 offset:17408
    v_accvgpr_read_b32 v70, a70
    v_accvgpr_read_b32 v71, a71
    s_add_u32 s3, s42, 9216
    v_cvt_pk_bf16_f32 v70, v70, v71
    buffer_store_dword v70, v24, s[48:51], s3 offen nt
    s_waitcnt vmcnt(33) lgkmcnt(2)
    v_mfma_f32_32x32x16_bf16 a[96:111], v[56:59], v[172:175], a[96:111]
    ds_read_b128 v[48:51], v27 offset:24576
    v_accvgpr_read_b32 v72, a72
    v_accvgpr_read_b32 v73, a73
    s_add_u32 s3, s42, 14592
    v_cvt_pk_bf16_f32 v72, v72, v73
    buffer_store_dword v72, v24, s[48:51], s3 offen nt
    s_waitcnt vmcnt(32) lgkmcnt(2)
    v_mfma_f32_32x32x16_bf16 a[96:111], v[32:35], v[176:179], a[96:111]
    ds_read_b128 v[56:59], v27 offset:25600
    v_accvgpr_read_b32 v74, a74
    v_accvgpr_read_b32 v75, a75
    s_add_u32 s3, s42, 16384
    v_cvt_pk_bf16_f32 v74, v74, v75
    buffer_store_dword v74, v24, s[48:51], s3 offen nt
    s_waitcnt vmcnt(31) lgkmcnt(2)
    v_mfma_f32_32x32x16_bf16 a[96:111], v[40:43], v[180:183], a[96:111]
    ds_read_b128 v[32:35], v28 offset:32768
    v_accvgpr_read_b32 v76, a76
    v_accvgpr_read_b32 v77, a77
    s_add_u32 s3, s42, 21760
    v_cvt_pk_bf16_f32 v76, v76, v77
    buffer_store_dword v76, v24, s[48:51], s3 offen nt
    s_waitcnt vmcnt(30) lgkmcnt(2)
    v_mfma_f32_32x32x16_bf16 a[96:111], v[48:51], v[184:187], a[96:111]
    ds_read_b128 v[40:43], v28 offset:33792
    v_accvgpr_read_b32 v78, a78
    v_accvgpr_read_b32 v79, a79
    s_add_u32 s3, s42, 23552
    v_cvt_pk_bf16_f32 v78, v78, v79
    buffer_store_dword v78, v24, s[48:51], s3 offen nt
    s_waitcnt vmcnt(29) lgkmcnt(2)
    v_mfma_f32_32x32x16_bf16 a[96:111], v[56:59], v[188:191], a[96:111]
    ds_read_b128 v[48:51], v28 offset:40960
    v_accvgpr_read_b32 v64, a80
    v_accvgpr_read_b32 v65, a81
    s_add_u32 s3, s42, 28928
    v_cvt_pk_bf16_f32 v64, v64, v65
    buffer_store_dword v64, v24, s[48:51], s3 offen nt
    s_waitcnt vmcnt(28) lgkmcnt(2)
    v_mfma_f32_32x32x16_bf16 a[96:111], v[32:35], v[192:195], a[96:111]
    ds_read_b128 v[56:59], v28 offset:41984
    v_accvgpr_read_b32 v66, a82
    v_accvgpr_read_b32 v67, a83
    s_add_u32 s3, s42, 30720
    v_cvt_pk_bf16_f32 v66, v66, v67
    buffer_store_dword v66, v24, s[48:51], s3 offen nt
    s_waitcnt vmcnt(27) lgkmcnt(2)
    v_mfma_f32_32x32x16_bf16 a[96:111], v[40:43], v[196:199], a[96:111]
    ds_read_b128 v[32:35], v28 offset:49152
    v_accvgpr_read_b32 v68, a84
    v_accvgpr_read_b32 v69, a85
    s_add_u32 s3, s42, 36096
    v_cvt_pk_bf16_f32 v68, v68, v69
    buffer_store_dword v68, v24, s[48:51], s3 offen nt
    s_waitcnt vmcnt(26) lgkmcnt(2)
    v_mfma_f32_32x32x16_bf16 a[96:111], v[48:51], v[200:203], a[96:111]
    ds_read_b128 v[40:43], v28 offset:50176
    v_accvgpr_read_b32 v70, a86
    v_accvgpr_read_b32 v71, a87
    s_add_u32 s3, s42, 37888
    v_cvt_pk_bf16_f32 v70, v70, v71
    buffer_store_dword v70, v24, s[48:51], s3 offen nt
    s_waitcnt vmcnt(25) lgkmcnt(2)
    v_mfma_f32_32x32x16_bf16 a[96:111], v[56:59], v[204:207], a[96:111]
    ds_read_b128 v[48:51], v28 offset:57344
    v_accvgpr_read_b32 v72, a88
    v_accvgpr_read_b32 v73, a89
    s_add_u32 s3, s42, 43264
    v_cvt_pk_bf16_f32 v72, v72, v73
    buffer_store_dword v72, v24, s[48:51], s3 offen nt
    s_waitcnt vmcnt(24) lgkmcnt(2)
    v_mfma_f32_32x32x16_bf16 a[96:111], v[32:35], v[208:211], a[96:111]
    ds_read_b128 v[56:59], v28 offset:58368
    v_accvgpr_read_b32 v74, a90
    v_accvgpr_read_b32 v75, a91
    s_add_u32 s3, s42, 45056
    v_cvt_pk_bf16_f32 v74, v74, v75
    buffer_store_dword v74, v24, s[48:51], s3 offen nt
    s_waitcnt vmcnt(24) lgkmcnt(2)
    v_mfma_f32_32x32x16_bf16 a[96:111], v[40:43], v[212:215], a[96:111]
    ds_read_b128 v[32:35], v27 offset:32768
    v_accvgpr_read_b32 v76, a92
    v_accvgpr_read_b32 v77, a93
    s_add_u32 s3, s42, 50432
    v_cvt_pk_bf16_f32 v76, v76, v77
    buffer_store_dword v76, v24, s[48:51], s3 offen nt
    s_waitcnt vmcnt(24) lgkmcnt(2)
    v_mfma_f32_32x32x16_bf16 a[96:111], v[48:51], v[216:219], a[96:111]
    ds_read_b128 v[40:43], v27 offset:33792
    v_accvgpr_read_b32 v78, a94
    v_accvgpr_read_b32 v79, a95
    s_add_u32 s3, s42, 52224
    v_cvt_pk_bf16_f32 v78, v78, v79
    buffer_store_dword v78, v24, s[48:51], s3 offen nt
    s_waitcnt vmcnt(24) lgkmcnt(2)
    v_mfma_f32_32x32x16_bf16 a[96:111], v[56:59], v[220:223], a[96:111]
    ds_read_b128 v[48:51], v27 offset:40960
    s_waitcnt vmcnt(23) lgkmcnt(2)
    v_mfma_f32_32x32x16_bf16 a[96:111], v[32:35], v[224:227], a[96:111]
    ds_read_b128 v[56:59], v27 offset:41984
    s_waitcnt vmcnt(22) lgkmcnt(2)
    v_mfma_f32_32x32x16_bf16 a[96:111], v[40:43], v[228:231], a[96:111]
    ds_read_b128 v[32:35], v27 offset:49152
    s_waitcnt vmcnt(21) lgkmcnt(2)
    v_mfma_f32_32x32x16_bf16 a[96:111], v[48:51], v[232:235], a[96:111]
    ds_read_b128 v[40:43], v27 offset:50176
    s_waitcnt vmcnt(20) lgkmcnt(2)
    v_mfma_f32_32x32x16_bf16 a[96:111], v[56:59], v[236:239], a[96:111]
    ds_read_b128 v[48:51], v27 offset:57344
    s_waitcnt vmcnt(19) lgkmcnt(2)
    v_mfma_f32_32x32x16_bf16 a[96:111], v[32:35], v[240:243], a[96:111]
    ds_read_b128 v[56:59], v27 offset:58368
    s_waitcnt vmcnt(18) lgkmcnt(2)
    v_mfma_f32_32x32x16_bf16 a[96:111], v[40:43], v[244:247], a[96:111]
    s_waitcnt vmcnt(17) lgkmcnt(1)
    v_mfma_f32_32x32x16_bf16 a[96:111], v[48:51], v[248:251], a[96:111]
    s_waitcnt vmcnt(16) lgkmcnt(0)
    v_mfma_f32_32x32x16_bf16 a[96:111], v[56:59], v[252:255], a[96:111]
    s_nop 15
    v_accvgpr_read_b32 v64, a96
    v_accvgpr_read_b32 v65, a97
    s_add_u32 s3, s43, 0
    v_cvt_pk_bf16_f32 v64, v64, v65
    buffer_store_dword v64, v24, s[48:51], s3 offen nt
    v_accvgpr_read_b32 v66, a98
    v_accvgpr_read_b32 v67, a99
    s_add_u32 s3, s43, 1792
    v_cvt_pk_bf16_f32 v66, v66, v67
    buffer_store_dword v66, v24, s[48:51], s3 offen nt
    v_accvgpr_read_b32 v68, a100
    v_accvgpr_read_b32 v69, a101
    s_add_u32 s3, s43, 7168
    v_cvt_pk_bf16_f32 v68, v68, v69
    buffer_store_dword v68, v24, s[48:51], s3 offen nt
    v_accvgpr_read_b32 v70, a102
    v_accvgpr_read_b32 v71, a103
    s_add_u32 s3, s43, 8960
    v_cvt_pk_bf16_f32 v70, v70, v71
    buffer_store_dword v70, v24, s[48:51], s3 offen nt
    v_accvgpr_read_b32 v72, a104
    v_accvgpr_read_b32 v73, a105
    s_add_u32 s3, s43, 14336
    v_cvt_pk_bf16_f32 v72, v72, v73
    buffer_store_dword v72, v24, s[48:51], s3 offen nt
    v_accvgpr_read_b32 v74, a106
    v_accvgpr_read_b32 v75, a107
    s_add_u32 s3, s43, 16128
    v_cvt_pk_bf16_f32 v74, v74, v75
    buffer_store_dword v74, v24, s[48:51], s3 offen nt
    v_accvgpr_read_b32 v76, a108
    v_accvgpr_read_b32 v77, a109
    s_add_u32 s3, s43, 21504
    v_cvt_pk_bf16_f32 v76, v76, v77
    buffer_store_dword v76, v24, s[48:51], s3 offen nt
    v_accvgpr_read_b32 v78, a110
    v_accvgpr_read_b32 v79, a111
    s_add_u32 s3, s43, 23296
    v_cvt_pk_bf16_f32 v78, v78, v79
    buffer_store_dword v78, v24, s[48:51], s3 offen nt
K3_END:
    s_endpgm
RB1_l1:
    v_mov_b32 v12, s57
    v_fmac_f32 v12, s28, v10
    v_max_f32 v12, v12, v6
    v_sub_f32 v18, v6, v12
    v_exp_f32 v18, v18
    v_mov_b32 v6, v12
    v_mul_f32 v8, v8, v18
    v_mov_b32 v16, s57
    v_fmac_f32 v16, s28, v14
    v_max_f32 v16, v16, v7
    v_sub_f32 v19, v7, v16
    v_exp_f32 v19, v19
    v_mov_b32 v7, v16
    v_mul_f32 v9, v9, v19
    s_mov_b32 s30, 1
    s_branch RB1R_l1
RB1_l0:
    v_mov_b32 v12, s57
    v_fmac_f32 v12, s28, v10
    v_max_f32 v12, v12, v6
    v_sub_f32 v18, v6, v12
    v_exp_f32 v18, v18
    v_mov_b32 v6, v12
    v_mul_f32 v8, v8, v18
    v_mov_b32 v16, s57
    v_fmac_f32 v16, s28, v14
    v_max_f32 v16, v16, v7
    v_sub_f32 v19, v7, v16
    v_exp_f32 v19, v19
    v_mov_b32 v7, v16
    v_mul_f32 v9, v9, v19
    s_mov_b32 s30, 1
    s_branch RB1R_l0
RB1_t:
    v_mov_b32 v12, s57
    v_fmac_f32 v12, s28, v10
    v_max_f32 v12, v12, v6
    v_sub_f32 v18, v6, v12
    v_exp_f32 v18, v18
    v_mov_b32 v6, v12
    v_mul_f32 v8, v8, v18
    v_mov_b32 v16, s57
    v_fmac_f32 v16, s28, v14
    v_max_f32 v16, v16, v7
    v_sub_f32 v19, v7, v16
    v_exp_f32 v19, v19
    v_mov_b32 v7, v16
    v_mul_f32 v9, v9, v19
    s_mov_b32 s30, 1
    s_branch RB1R_t
RESC:
    s_nop 15
    s_nop 15
    v_accvgpr_read_b32 v22, a0
    v_accvgpr_read_b32 v23, a1
    v_accvgpr_read_b32 v24, a2
    v_accvgpr_read_b32 v25, a3
    v_accvgpr_read_b32 v26, a4
    v_accvgpr_read_b32 v27, a5
    v_accvgpr_read_b32 v28, a6
    v_accvgpr_read_b32 v29, a7
    v_mul_f32 v22, v22, v18
    v_mul_f32 v23, v23, v18
    v_mul_f32 v24, v24, v18
    v_mul_f32 v25, v25, v18
    v_mul_f32 v26, v26, v18
    v_mul_f32 v27, v27, v18
    v_mul_f32 v28, v28, v18
    v_mul_f32 v29, v29, v18
    v_accvgpr_write_b32 a0, v22
    v_accvgpr_write_b32 a1, v23
    v_accvgpr_write_b32 a2, v24
    v_accvgpr_write_b32 a3, v25
    v_accvgpr_write_b32 a4, v26
    v_accvgpr_write_b32 a5, v27
    v_accvgpr_write_b32 a6, v28
    v_accvgpr_write_b32 a7, v29
    v_accvgpr_read_b32 v22, a8
    v_accvgpr_read_b32 v23, a9
    v_accvgpr_read_b32 v24, a10
    v_accvgpr_read_b32 v25, a11
    v_accvgpr_read_b32 v26, a12
    v_accvgpr_read_b32 v27, a13
    v_accvgpr_read_b32 v28, a14
    v_accvgpr_read_b32 v29, a15
    v_mul_f32 v22, v22, v18
    v_mul_f32 v23, v23, v18
    v_mul_f32 v24, v24, v18
    v_mul_f32 v25, v25, v18
    v_mul_f32 v26, v26, v18
    v_mul_f32 v27, v27, v18
    v_mul_f32 v28, v28, v18
    v_mul_f32 v29, v29, v18
    v_accvgpr_write_b32 a8, v22
    v_accvgpr_write_b32 a9, v23
    v_accvgpr_write_b32 a10, v24
    v_accvgpr_write_b32 a11, v25
    v_accvgpr_write_b32 a12, v26
    v_accvgpr_write_b32 a13, v27
    v_accvgpr_write_b32 a14, v28
    v_accvgpr_write_b32 a15, v29
    v_accvgpr_read_b32 v22, a16
    v_accvgpr_read_b32 v23, a17
    v_accvgpr_read_b32 v24, a18
    v_accvgpr_read_b32 v25, a19
    v_accvgpr_read_b32 v26, a20
    v_accvgpr_read_b32 v27, a21
    v_accvgpr_read_b32 v28, a22
    v_accvgpr_read_b32 v29, a23
    v_mul_f32 v22, v22, v19
    v_mul_f32 v23, v23, v19
    v_mul_f32 v24, v24, v19
    v_mul_f32 v25, v25, v19
    v_mul_f32 v26, v26, v19
    v_mul_f32 v27, v27, v19
    v_mul_f32 v28, v28, v19
    v_mul_f32 v29, v29, v19
    v_accvgpr_write_b32 a16, v22
    v_accvgpr_write_b32 a17, v23
    v_accvgpr_write_b32 a18, v24
    v_accvgpr_write_b32 a19, v25
    v_accvgpr_write_b32 a20, v26
    v_accvgpr_write_b32 a21, v27
    v_accvgpr_write_b32 a22, v28
    v_accvgpr_write_b32 a23, v29
    v_accvgpr_read_b32 v22, a24
    v_accvgpr_read_b32 v23, a25
    v_accvgpr_read_b32 v24, a26
    v_accvgpr_read_b32 v25, a27
    v_accvgpr_read_b32 v26, a28
    v_accvgpr_read_b32 v27, a29
    v_accvgpr_read_b32 v28, a30
    v_accvgpr_read_b32 v29, a31
    v_mul_f32 v22, v22, v19
    v_mul_f32 v23, v23, v19
    v_mul_f32 v24, v24, v19
    v_mul_f32 v25, v25, v19
    v_mul_f32 v26, v26, v19
    v_mul_f32 v27, v27, v19
    v_mul_f32 v28, v28, v19
    v_mul_f32 v29, v29, v19
    v_accvgpr_write_b32 a24, v22
    v_accvgpr_write_b32 a25, v23
    v_accvgpr_write_b32 a26, v24
    v_accvgpr_write_b32 a27, v25
    v_accvgpr_write_b32 a28, v26
    v_accvgpr_write_b32 a29, v27
    v_accvgpr_write_b32 a30, v28
    v_accvgpr_write_b32 a31, v29
    v_accvgpr_read_b32 v22, a32
    v_accvgpr_read_b32 v23, a33
    v_accvgpr_read_b32 v24, a34
    v_accvgpr_read_b32 v25, a35
    v_accvgpr_read_b32 v26, a36
    v_accvgpr_read_b32 v27, a37
    v_accvgpr_read_b32 v28, a38
    v_accvgpr_read_b32 v29, a39
    v_mul_f32 v22, v22, v18
    v_mul_f32 v23, v23, v18
    v_mul_f32 v24, v24, v18
    v_mul_f32 v25, v25, v18
    v_mul_f32 v26, v26, v18
    v_mul_f32 v27, v27, v18
    v_mul_f32 v28, v28, v18
    v_mul_f32 v29, v29, v18
    v_accvgpr_write_b32 a32, v22
    v_accvgpr_write_b32 a33, v23
    v_accvgpr_write_b32 a34, v24
    v_accvgpr_write_b32 a35, v25
    v_accvgpr_write_b32 a36, v26
    v_accvgpr_write_b32 a37, v27
    v_accvgpr_write_b32 a38, v28
    v_accvgpr_write_b32 a39, v29
    v_accvgpr_read_b32 v22, a40
    v_accvgpr_read_b32 v23, a41
    v_accvgpr_read_b32 v24, a42
    v_accvgpr_read_b32 v25, a43
    v_accvgpr_read_b32 v26, a44
    v_accvgpr_read_b32 v27, a45
    v_accvgpr_read_b32 v28, a46
    v_accvgpr_read_b32 v29, a47
    v_mul_f32 v22, v22, v18
    v_mul_f32 v23, v23, v18
    v_mul_f32 v24, v24, v18
    v_mul_f32 v25, v25, v18
    v_mul_f32 v26, v26, v18
    v_mul_f32 v27, v27, v18
    v_mul_f32 v28, v28, v18
    v_mul_f32 v29, v29, v18
    v_accvgpr_write_b32 a40, v22
    v_accvgpr_write_b32 a41, v23
    v_accvgpr_write_b32 a42, v24
    v_accvgpr_write_b32 a43, v25
    v_accvgpr_write_b32 a44, v26
    v_accvgpr_write_b32 a45, v27
    v_accvgpr_write_b32 a46, v28
    v_accvgpr_write_b32 a47, v29
    v_accvgpr_read_b32 v22, a48
    v_accvgpr_read_b32 v23, a49
    v_accvgpr_read_b32 v24, a50
    v_accvgpr_read_b32 v25, a51
    v_accvgpr_read_b32 v26, a52
    v_accvgpr_read_b32 v27, a53
    v_accvgpr_read_b32 v28, a54
    v_accvgpr_read_b32 v29, a55
    v_mul_f32 v22, v22, v19
    v_mul_f32 v23, v23, v19
    v_mul_f32 v24, v24, v19
    v_mul_f32 v25, v25, v19
    v_mul_f32 v26, v26, v19
    v_mul_f32 v27, v27, v19
    v_mul_f32 v28, v28, v19
    v_mul_f32 v29, v29, v19
    v_accvgpr_write_b32 a48, v22
    v_accvgpr_write_b32 a49, v23
    v_accvgpr_write_b32 a50, v24
    v_accvgpr_write_b32 a51, v25
    v_accvgpr_write_b32 a52, v26
    v_accvgpr_write_b32 a53, v27
    v_accvgpr_write_b32 a54, v28
    v_accvgpr_write_b32 a55, v29
    v_accvgpr_read_b32 v22, a56
    v_accvgpr_read_b32 v23, a57
    v_accvgpr_read_b32 v24, a58
    v_accvgpr_read_b32 v25, a59
    v_accvgpr_read_b32 v26, a60
    v_accvgpr_read_b32 v27, a61
    v_accvgpr_read_b32 v28, a62
    v_accvgpr_read_b32 v29, a63
    v_mul_f32 v22, v22, v19
    v_mul_f32 v23, v23, v19
    v_mul_f32 v24, v24, v19
    v_mul_f32 v25, v25, v19
    v_mul_f32 v26, v26, v19
    v_mul_f32 v27, v27, v19
    v_mul_f32 v28, v28, v19
    v_mul_f32 v29, v29, v19
    v_accvgpr_write_b32 a56, v22
    v_accvgpr_write_b32 a57, v23
    v_accvgpr_write_b32 a58, v24
    v_accvgpr_write_b32 a59, v25
    v_accvgpr_write_b32 a60, v26
    v_accvgpr_write_b32 a61, v27
    v_accvgpr_write_b32 a62, v28
    v_accvgpr_write_b32 a63, v29
    v_accvgpr_read_b32 v22, a64
    v_accvgpr_read_b32 v23, a65
    v_accvgpr_read_b32 v24, a66
    v_accvgpr_read_b32 v25, a67
    v_accvgpr_read_b32 v26, a68
    v_accvgpr_read_b32 v27, a69
    v_accvgpr_read_b32 v28, a70
    v_accvgpr_read_b32 v29, a71
    v_mul_f32 v22, v22, v18
    v_mul_f32 v23, v23, v18
    v_mul_f32 v24, v24, v18
    v_mul_f32 v25, v25, v18
    v_mul_f32 v26, v26, v18
    v_mul_f32 v27, v27, v18
    v_mul_f32 v28, v28, v18
    v_mul_f32 v29, v29, v18
    v_accvgpr_write_b32 a64, v22
    v_accvgpr_write_b32 a65, v23
    v_accvgpr_write_b32 a66, v24
    v_accvgpr_write_b32 a67, v25
    v_accvgpr_write_b32 a68, v26
    v_accvgpr_write_b32 a69, v27
    v_accvgpr_write_b32 a70, v28
    v_accvgpr_write_b32 a71, v29
    v_accvgpr_read_b32 v22, a72
    v_accvgpr_read_b32 v23, a73
    v_accvgpr_read_b32 v24, a74
    v_accvgpr_read_b32 v25, a75
    v_accvgpr_read_b32 v26, a76
    v_accvgpr_read_b32 v27, a77
    v_accvgpr_read_b32 v28, a78
    v_accvgpr_read_b32 v29, a79
    v_mul_f32 v22, v22, v18
    v_mul_f32 v23, v23, v18
    v_mul_f32 v24, v24, v18
    v_mul_f32 v25, v25, v18
    v_mul_f32 v26, v26, v18
    v_mul_f32 v27, v27, v18
    v_mul_f32 v28, v28, v18
    v_mul_f32 v29, v29, v18
    v_accvgpr_write_b32 a72, v22
    v_accvgpr_write_b32 a73, v23
    v_accvgpr_write_b32 a74, v24
    v_accvgpr_write_b32 a75, v25
    v_accvgpr_write_b32 a76, v26
    v_accvgpr_write_b32 a77, v27
    v_accvgpr_write_b32 a78, v28
    v_accvgpr_write_b32 a79, v29
    v_accvgpr_read_b32 v22, a80
    v_accvgpr_read_b32 v23, a81
    v_accvgpr_read_b32 v24, a82
    v_accvgpr_read_b32 v25, a83
    v_accvgpr_read_b32 v26, a84
    v_accvgpr_read_b32 v27, a85
    v_accvgpr_read_b32 v28, a86
    v_accvgpr_read_b32 v29, a87
    v_mul_f32 v22, v22, v19
    v_mul_f32 v23, v23, v19
    v_mul_f32 v24, v24, v19
    v_mul_f32 v25, v25, v19
    v_mul_f32 v26, v26, v19
    v_mul_f32 v27, v27, v19
    v_mul_f32 v28, v28, v19
    v_mul_f32 v29, v29, v19
    v_accvgpr_write_b32 a80, v22
    v_accvgpr_write_b32 a81, v23
    v_accvgpr_write_b32 a82, v24
    v_accvgpr_write_b32 a83, v25
    v_accvgpr_write_b32 a84, v26
    v_accvgpr_write_b32 a85, v27
    v_accvgpr_write_b32 a86, v28
    v_accvgpr_write_b32 a87, v29
    v_accvgpr_read_b32 v22, a88
    v_accvgpr_read_b32 v23, a89
    v_accvgpr_read_b32 v24, a90
    v_accvgpr_read_b32 v25, a91
    v_accvgpr_read_b32 v26, a92
    v_accvgpr_read_b32 v27, a93
    v_accvgpr_read_b32 v28, a94
    v_accvgpr_read_b32 v29, a95
    v_mul_f32 v22, v22, v19
    v_mul_f32 v23, v23, v19
    v_mul_f32 v24, v24, v19
    v_mul_f32 v25, v25, v19
    v_mul_f32 v26, v26, v19
    v_mul_f32 v27, v27, v19
    v_mul_f32 v28, v28, v19
    v_mul_f32 v29, v29, v19
    v_accvgpr_write_b32 a88, v22
    v_accvgpr_write_b32 a89, v23
    v_accvgpr_write_b32 a90, v24
    v_accvgpr_write_b32 a91, v25
    v_accvgpr_write_b32 a92, v26
    v_accvgpr_write_b32 a93, v27
    v_accvgpr_write_b32 a94, v28
    v_accvgpr_write_b32 a95, v29
    v_accvgpr_read_b32 v22, a96
    v_accvgpr_read_b32 v23, a97
    v_accvgpr_read_b32 v24, a98
    v_accvgpr_read_b32 v25, a99
    v_accvgpr_read_b32 v26, a100
    v_accvgpr_read_b32 v27, a101
    v_accvgpr_read_b32 v28, a102
    v_accvgpr_read_b32 v29, a103
    v_mul_f32 v22, v22, v18
    v_mul_f32 v23, v23, v18
    v_mul_f32 v24, v24, v18
    v_mul_f32 v25, v25, v18
    v_mul_f32 v26, v26, v18
    v_mul_f32 v27, v27, v18
    v_mul_f32 v28, v28, v18
    v_mul_f32 v29, v29, v18
    v_accvgpr_write_b32 a96, v22
    v_accvgpr_write_b32 a97, v23
    v_accvgpr_write_b32 a98, v24
    v_accvgpr_write_b32 a99, v25
    v_accvgpr_write_b32 a100, v26
    v_accvgpr_write_b32 a101, v27
    v_accvgpr_write_b32 a102, v28
    v_accvgpr_write_b32 a103, v29
    v_accvgpr_read_b32 v22, a104
    v_accvgpr_read_b32 v23, a105
    v_accvgpr_read_b32 v24, a106
    v_accvgpr_read_b32 v25, a107
    v_accvgpr_read_b32 v26, a108
    v_accvgpr_read_b32 v27, a109
    v_accvgpr_read_b32 v28, a110
    v_accvgpr_read_b32 v29, a111
    v_mul_f32 v22, v22, v18
    v_mul_f32 v23, v23, v18
    v_mul_f32 v24, v24, v18
    v_mul_f32 v25, v25, v18
    v_mul_f32 v26, v26, v18
    v_mul_f32 v27, v27, v18
    v_mul_f32 v28, v28, v18
    v_mul_f32 v29, v29, v18
    v_accvgpr_write_b32 a104, v22
    v_accvgpr_write_b32 a105, v23
    v_accvgpr_write_b32 a106, v24
    v_accvgpr_write_b32 a107, v25
    v_accvgpr_write_b32 a108, v26
    v_accvgpr_write_b32 a109, v27
    v_accvgpr_write_b32 a110, v28
    v_accvgpr_write_b32 a111, v29
    v_accvgpr_read_b32 v22, a112
    v_accvgpr_read_b32 v23, a113
    v_accvgpr_read_b32 v24, a114
    v_accvgpr_read_b32 v25, a115
    v_accvgpr_read_b32 v26, a116
    v_accvgpr_read_b32 v27, a117
    v_accvgpr_read_b32 v28, a118
    v_accvgpr_read_b32 v29, a119
    v_mul_f32 v22, v22, v19
    v_mul_f32 v23, v23, v19
    v_mul_f32 v24, v24, v19
    v_mul_f32 v25, v25, v19
    v_mul_f32 v26, v26, v19
    v_mul_f32 v27, v27, v19
    v_mul_f32 v28, v28, v19
    v_mul_f32 v29, v29, v19
    v_accvgpr_write_b32 a112, v22
    v_accvgpr_write_b32 a113, v23
    v_accvgpr_write_b32 a114, v24
    v_accvgpr_write_b32 a115, v25
    v_accvgpr_write_b32 a116, v26
    v_accvgpr_write_b32 a117, v27
    v_accvgpr_write_b32 a118, v28
    v_accvgpr_write_b32 a119, v29
    v_accvgpr_read_b32 v22, a120
    v_accvgpr_read_b32 v23, a121
    v_accvgpr_read_b32 v24, a122
    v_accvgpr_read_b32 v25, a123
    v_accvgpr_read_b32 v26, a124
    v_accvgpr_read_b32 v27, a125
    v_accvgpr_read_b32 v28, a126
    v_accvgpr_read_b32 v29, a127
    v_mul_f32 v22, v22, v19
    v_mul_f32 v23, v23, v19
    v_mul_f32 v24, v24, v19
    v_mul_f32 v25, v25, v19
    v_mul_f32 v26, v26, v19
    v_mul_f32 v27, v27, v19
    v_mul_f32 v28, v28, v19
    v_mul_f32 v29, v29, v19
    v_accvgpr_write_b32 a120, v22
    v_accvgpr_write_b32 a121, v23
    v_accvgpr_write_b32 a122, v24
    v_accvgpr_write_b32 a123, v25
    v_accvgpr_write_b32 a124, v26
    v_accvgpr_write_b32 a125, v27
    v_accvgpr_write_b32 a126, v28
    v_accvgpr_write_b32 a127, v29
    v_accvgpr_read_b32 v22, a128
    v_accvgpr_read_b32 v23, a129
    v_accvgpr_read_b32 v24, a130
    v_accvgpr_read_b32 v25, a131
    v_accvgpr_read_b32 v26, a132
    v_accvgpr_read_b32 v27, a133
    v_accvgpr_read_b32 v28, a134
    v_accvgpr_read_b32 v29, a135
    v_mul_f32 v22, v22, v18
    v_mul_f32 v23, v23, v18
    v_mul_f32 v24, v24, v18
    v_mul_f32 v25, v25, v18
    v_mul_f32 v26, v26, v18
    v_mul_f32 v27, v27, v18
    v_mul_f32 v28, v28, v18
    v_mul_f32 v29, v29, v18
    v_accvgpr_write_b32 a128, v22
    v_accvgpr_write_b32 a129, v23
    v_accvgpr_write_b32 a130, v24
    v_accvgpr_write_b32 a131, v25
    v_accvgpr_write_b32 a132, v26
    v_accvgpr_write_b32 a133, v27
    v_accvgpr_write_b32 a134, v28
    v_accvgpr_write_b32 a135, v29
    v_accvgpr_read_b32 v22, a136
    v_accvgpr_read_b32 v23, a137
    v_accvgpr_read_b32 v24, a138
    v_accvgpr_read_b32 v25, a139
    v_accvgpr_read_b32 v26, a140
    v_accvgpr_read_b32 v27, a141
    v_accvgpr_read_b32 v28, a142
    v_accvgpr_read_b32 v29, a143
    v_mul_f32 v22, v22, v18
    v_mul_f32 v23, v23, v18
    v_mul_f32 v24, v24, v18
    v_mul_f32 v25, v25, v18
    v_mul_f32 v26, v26, v18
    v_mul_f32 v27, v27, v18
    v_mul_f32 v28, v28, v18
    v_mul_f32 v29, v29, v18
    v_accvgpr_write_b32 a136, v22
    v_accvgpr_write_b32 a137, v23
    v_accvgpr_write_b32 a138, v24
    v_accvgpr_write_b32 a139, v25
    v_accvgpr_write_b32 a140, v26
    v_accvgpr_write_b32 a141, v27
    v_accvgpr_write_b32 a142, v28
    v_accvgpr_write_b32 a143, v29
    v_accvgpr_read_b32 v22, a144
    v_accvgpr_read_b32 v23, a145
    v_accvgpr_read_b32 v24, a146
    v_accvgpr_read_b32 v25, a147
    v_accvgpr_read_b32 v26, a148
    v_accvgpr_read_b32 v27, a149
    v_accvgpr_read_b32 v28, a150
    v_accvgpr_read_b32 v29, a151
    v_mul_f32 v22, v22, v19
    v_mul_f32 v23, v23, v19
    v_mul_f32 v24, v24, v19
    v_mul_f32 v25, v25, v19
    v_mul_f32 v26, v26, v19
    v_mul_f32 v27, v27, v19
    v_mul_f32 v28, v28, v19
    v_mul_f32 v29, v29, v19
    v_accvgpr_write_b32 a144, v22
    v_accvgpr_write_b32 a145, v23
    v_accvgpr_write_b32 a146, v24
    v_accvgpr_write_b32 a147, v25
    v_accvgpr_write_b32 a148, v26
    v_accvgpr_write_b32 a149, v27
    v_accvgpr_write_b32 a150, v28
    v_accvgpr_write_b32 a151, v29
    v_accvgpr_read_b32 v22, a152
    v_accvgpr_read_b32 v23, a153
    v_accvgpr_read_b32 v24, a154
    v_accvgpr_read_b32 v25, a155
    v_accvgpr_read_b32 v26, a156
    v_accvgpr_read_b32 v27, a157
    v_accvgpr_read_b32 v28, a158
    v_accvgpr_read_b32 v29, a159
    v_mul_f32 v22, v22, v19
    v_mul_f32 v23, v23, v19
    v_mul_f32 v24, v24, v19
    v_mul_f32 v25, v25, v19
    v_mul_f32 v26, v26, v19
    v_mul_f32 v27, v27, v19
    v_mul_f32 v28, v28, v19
    v_mul_f32 v29, v29, v19
    v_accvgpr_write_b32 a152, v22
    v_accvgpr_write_b32 a153, v23
    v_accvgpr_write_b32 a154, v24
    v_accvgpr_write_b32 a155, v25
    v_accvgpr_write_b32 a156, v26
    v_accvgpr_write_b32 a157, v27
    v_accvgpr_write_b32 a158, v28
    v_accvgpr_write_b32 a159, v29
    v_accvgpr_read_b32 v22, a160
    v_accvgpr_read_b32 v23, a161
    v_accvgpr_read_b32 v24, a162
    v_accvgpr_read_b32 v25, a163
    v_accvgpr_read_b32 v26, a164
    v_accvgpr_read_b32 v27, a165
    v_accvgpr_read_b32 v28, a166
    v_accvgpr_read_b32 v29, a167
    v_mul_f32 v22, v22, v18
    v_mul_f32 v23, v23, v18
    v_mul_f32 v24, v24, v18
    v_mul_f32 v25, v25, v18
    v_mul_f32 v26, v26, v18
    v_mul_f32 v27, v27, v18
    v_mul_f32 v28, v28, v18
    v_mul_f32 v29, v29, v18
    v_accvgpr_write_b32 a160, v22
    v_accvgpr_write_b32 a161, v23
    v_accvgpr_write_b32 a162, v24
    v_accvgpr_write_b32 a163, v25
    v_accvgpr_write_b32 a164, v26
    v_accvgpr_write_b32 a165, v27
    v_accvgpr_write_b32 a166, v28
    v_accvgpr_write_b32 a167, v29
    v_accvgpr_read_b32 v22, a168
    v_accvgpr_read_b32 v23, a169
    v_accvgpr_read_b32 v24, a170
    v_accvgpr_read_b32 v25, a171
    v_accvgpr_read_b32 v26, a172
    v_accvgpr_read_b32 v27, a173
    v_accvgpr_read_b32 v28, a174
    v_accvgpr_read_b32 v29, a175
    v_mul_f32 v22, v22, v18
    v_mul_f32 v23, v23, v18
    v_mul_f32 v24, v24, v18
    v_mul_f32 v25, v25, v18
    v_mul_f32 v26, v26, v18
    v_mul_f32 v27, v27, v18
    v_mul_f32 v28, v28, v18
    v_mul_f32 v29, v29, v18
    v_accvgpr_write_b32 a168, v22
    v_accvgpr_write_b32 a169, v23
    v_accvgpr_write_b32 a170, v24
    v_accvgpr_write_b32 a171, v25
    v_accvgpr_write_b32 a172, v26
    v_accvgpr_write_b32 a173, v27
    v_accvgpr_write_b32 a174, v28
    v_accvgpr_write_b32 a175, v29
    v_accvgpr_read_b32 v22, a176
    v_accvgpr_read_b32 v23, a177
    v_accvgpr_read_b32 v24, a178
    v_accvgpr_read_b32 v25, a179
    v_accvgpr_read_b32 v26, a180
    v_accvgpr_read_b32 v27, a181
    v_accvgpr_read_b32 v28, a182
    v_accvgpr_read_b32 v29, a183
    v_mul_f32 v22, v22, v19
    v_mul_f32 v23, v23, v19
    v_mul_f32 v24, v24, v19
    v_mul_f32 v25, v25, v19
    v_mul_f32 v26, v26, v19
    v_mul_f32 v27, v27, v19
    v_mul_f32 v28, v28, v19
    v_mul_f32 v29, v29, v19
    v_accvgpr_write_b32 a176, v22
    v_accvgpr_write_b32 a177, v23
    v_accvgpr_write_b32 a178, v24
    v_accvgpr_write_b32 a179, v25
    v_accvgpr_write_b32 a180, v26
    v_accvgpr_write_b32 a181, v27
    v_accvgpr_write_b32 a182, v28
    v_accvgpr_write_b32 a183, v29
    v_accvgpr_read_b32 v22, a184
    v_accvgpr_read_b32 v23, a185
    v_accvgpr_read_b32 v24, a186
    v_accvgpr_read_b32 v25, a187
    v_accvgpr_read_b32 v26, a188
    v_accvgpr_read_b32 v27, a189
    v_accvgpr_read_b32 v28, a190
    v_accvgpr_read_b32 v29, a191
    v_mul_f32 v22, v22, v19
    v_mul_f32 v23, v23, v19
    v_mul_f32 v24, v24, v19
    v_mul_f32 v25, v25, v19
    v_mul_f32 v26, v26, v19
    v_mul_f32 v27, v27, v19
    v_mul_f32 v28, v28, v19
    v_mul_f32 v29, v29, v19
    v_accvgpr_write_b32 a184, v22
    v_accvgpr_write_b32 a185, v23
    v_accvgpr_write_b32 a186, v24
    v_accvgpr_write_b32 a187, v25
    v_accvgpr_write_b32 a188, v26
    v_accvgpr_write_b32 a189, v27
    v_accvgpr_write_b32 a190, v28
    v_accvgpr_write_b32 a191, v29
    v_accvgpr_read_b32 v22, a192
    v_accvgpr_read_b32 v23, a193
    v_accvgpr_read_b32 v24, a194
    v_accvgpr_read_b32 v25, a195
    v_accvgpr_read_b32 v26, a196
    v_accvgpr_read_b32 v27, a197
    v_accvgpr_read_b32 v28, a198
    v_accvgpr_read_b32 v29, a199
    v_mul_f32 v22, v22, v18
    v_mul_f32 v23, v23, v18
    v_mul_f32 v24, v24, v18
    v_mul_f32 v25, v25, v18
    v_mul_f32 v26, v26, v18
    v_mul_f32 v27, v27, v18
    v_mul_f32 v28, v28, v18
    v_mul_f32 v29, v29, v18
    v_accvgpr_write_b32 a192, v22
    v_accvgpr_write_b32 a193, v23
    v_accvgpr_write_b32 a194, v24
    v_accvgpr_write_b32 a195, v25
    v_accvgpr_write_b32 a196, v26
    v_accvgpr_write_b32 a197, v27
    v_accvgpr_write_b32 a198, v28
    v_accvgpr_write_b32 a199, v29
    v_accvgpr_read_b32 v22, a200
    v_accvgpr_read_b32 v23, a201
    v_accvgpr_read_b32 v24, a202
    v_accvgpr_read_b32 v25, a203
    v_accvgpr_read_b32 v26, a204
    v_accvgpr_read_b32 v27, a205
    v_accvgpr_read_b32 v28, a206
    v_accvgpr_read_b32 v29, a207
    v_mul_f32 v22, v22, v18
    v_mul_f32 v23, v23, v18
    v_mul_f32 v24, v24, v18
    v_mul_f32 v25, v25, v18
    v_mul_f32 v26, v26, v18
    v_mul_f32 v27, v27, v18
    v_mul_f32 v28, v28, v18
    v_mul_f32 v29, v29, v18
    v_accvgpr_write_b32 a200, v22
    v_accvgpr_write_b32 a201, v23
    v_accvgpr_write_b32 a202, v24
    v_accvgpr_write_b32 a203, v25
    v_accvgpr_write_b32 a204, v26
    v_accvgpr_write_b32 a205, v27
    v_accvgpr_write_b32 a206, v28
    v_accvgpr_write_b32 a207, v29
    v_accvgpr_read_b32 v22, a208
    v_accvgpr_read_b32 v23, a209
    v_accvgpr_read_b32 v24, a210
    v_accvgpr_read_b32 v25, a211
    v_accvgpr_read_b32 v26, a212
    v_accvgpr_read_b32 v27, a213
    v_accvgpr_read_b32 v28, a214
    v_accvgpr_read_b32 v29, a215
    v_mul_f32 v22, v22, v19
    v_mul_f32 v23, v23, v19
    v_mul_f32 v24, v24, v19
    v_mul_f32 v25, v25, v19
    v_mul_f32 v26, v26, v19
    v_mul_f32 v27, v27, v19
    v_mul_f32 v28, v28, v19
    v_mul_f32 v29, v29, v19
    v_accvgpr_write_b32 a208, v22
    v_accvgpr_write_b32 a209, v23
    v_accvgpr_write_b32 a210, v24
    v_accvgpr_write_b32 a211, v25
    v_accvgpr_write_b32 a212, v26
    v_accvgpr_write_b32 a213, v27
    v_accvgpr_write_b32 a214, v28
    v_accvgpr_write_b32 a215, v29
    v_accvgpr_read_b32 v22, a216
    v_accvgpr_read_b32 v23, a217
    v_accvgpr_read_b32 v24, a218
    v_accvgpr_read_b32 v25, a219
    v_accvgpr_read_b32 v26, a220
    v_accvgpr_read_b32 v27, a221
    v_accvgpr_read_b32 v28, a222
    v_accvgpr_read_b32 v29, a223
    v_mul_f32 v22, v22, v19
    v_mul_f32 v23, v23, v19
    v_mul_f32 v24, v24, v19
    v_mul_f32 v25, v25, v19
    v_mul_f32 v26, v26, v19
    v_mul_f32 v27, v27, v19
    v_mul_f32 v28, v28, v19
    v_mul_f32 v29, v29, v19
    v_accvgpr_write_b32 a216, v22
    v_accvgpr_write_b32 a217, v23
    v_accvgpr_write_b32 a218, v24
    v_accvgpr_write_b32 a219, v25
    v_accvgpr_write_b32 a220, v26
    v_accvgpr_write_b32 a221, v27
    v_accvgpr_write_b32 a222, v28
    v_accvgpr_write_b32 a223, v29
    v_accvgpr_read_b32 v22, a224
    v_accvgpr_read_b32 v23, a225
    v_accvgpr_read_b32 v24, a226
    v_accvgpr_read_b32 v25, a227
    v_accvgpr_read_b32 v26, a228
    v_accvgpr_read_b32 v27, a229
    v_accvgpr_read_b32 v28, a230
    v_accvgpr_read_b32 v29, a231
    v_mul_f32 v22, v22, v18
    v_mul_f32 v23, v23, v18
    v_mul_f32 v24, v24, v18
    v_mul_f32 v25, v25, v18
    v_mul_f32 v26, v26, v18
    v_mul_f32 v27, v27, v18
    v_mul_f32 v28, v28, v18
    v_mul_f32 v29, v29, v18
    v_accvgpr_write_b32 a224, v22
    v_accvgpr_write_b32 a225, v23
    v_accvgpr_write_b32 a226, v24
    v_accvgpr_write_b32 a227, v25
    v_accvgpr_write_b32 a228, v26
    v_accvgpr_write_b32 a229, v27
    v_accvgpr_write_b32 a230, v28
    v_accvgpr_write_b32 a231, v29
    v_accvgpr_read_b32 v22, a232
    v_accvgpr_read_b32 v23, a233
    v_accvgpr_read_b32 v24, a234
    v_accvgpr_read_b32 v25, a235
    v_accvgpr_read_b32 v26, a236
    v_accvgpr_read_b32 v27, a237
    v_accvgpr_read_b32 v28, a238
    v_accvgpr_read_b32 v29, a239
    v_mul_f32 v22, v22, v18
    v_mul_f32 v23, v23, v18
    v_mul_f32 v24, v24, v18
    v_mul_f32 v25, v25, v18
    v_mul_f32 v26, v26, v18
    v_mul_f32 v27, v27, v18
    v_mul_f32 v28, v28, v18
    v_mul_f32 v29, v29, v18
    v_accvgpr_write_b32 a232, v22
    v_accvgpr_write_b32 a233, v23
    v_accvgpr_write_b32 a234, v24
    v_accvgpr_write_b32 a235, v25
    v_accvgpr_write_b32 a236, v26
    v_accvgpr_write_b32 a237, v27
    v_accvgpr_write_b32 a238, v28
    v_accvgpr_write_b32 a239, v29
    v_accvgpr_read_b32 v22, a240
    v_accvgpr_read_b32 v23, a241
    v_accvgpr_read_b32 v24, a242
    v_accvgpr_read_b32 v25, a243
    v_accvgpr_read_b32 v26, a244
    v_accvgpr_read_b32 v27, a245
    v_accvgpr_read_b32 v28, a246
    v_accvgpr_read_b32 v29, a247
    v_mul_f32 v22, v22, v19
    v_mul_f32 v23, v23, v19
    v_mul_f32 v24, v24, v19
    v_mul_f32 v25, v25, v19
    v_mul_f32 v26, v26, v19
    v_mul_f32 v27, v27, v19
    v_mul_f32 v28, v28, v19
    v_mul_f32 v29, v29, v19
    v_accvgpr_write_b32 a240, v22
    v_accvgpr_write_b32 a241, v23
    v_accvgpr_write_b32 a242, v24
    v_accvgpr_write_b32 a243, v25
    v_accvgpr_write_b32 a244, v26
    v_accvgpr_write_b32 a245, v27
    v_accvgpr_write_b32 a246, v28
    v_accvgpr_write_b32 a247, v29
    v_accvgpr_read_b32 v22, a248
    v_accvgpr_read_b32 v23, a249
    v_accvgpr_read_b32 v24, a250
    v_accvgpr_read_b32 v25, a251
    v_accvgpr_read_b32 v26, a252
    v_accvgpr_read_b32 v27, a253
    v_accvgpr_read_b32 v28, a254
    v_accvgpr_read_b32 v29, a255
    v_mul_f32 v22, v22, v19
    v_mul_f32 v23, v23, v19
    v_mul_f32 v24, v24, v19
    v_mul_f32 v25, v25, v19
    v_mul_f32 v26, v26, v19
    v_mul_f32 v27, v27, v19
    v_mul_f32 v28, v28, v19
    v_mul_f32 v29, v29, v19
    v_accvgpr_write_b32 a248, v22
    v_accvgpr_write_b32 a249, v23
    v_accvgpr_write_b32 a250, v24
    v_accvgpr_write_b32 a251, v25
    v_accvgpr_write_b32 a252, v26
    v_accvgpr_write_b32 a253, v27
    v_accvgpr_write_b32 a254, v28
    v_accvgpr_write_b32 a255, v29
    s_mov_b32 s30, 0
    s_nop 2
    s_setpc_b64 s[32:33]
    .globl k5_kernel
    .p2align 8
    .type k5_kernel,@function
k5_kernel:
    s_cmp_ge_u32 s2, 512
    s_cbranch_scc1 K5_END
    v_lshrrev_b32 v1, 6, v0
    s_nop 0
    v_readfirstlane_b32 s3, v1
    s_lshl_b32 s4, s2, 2
    s_add_u32 s3, s3, s4
    v_and_b32 v1, 63, v0
    v_cmp_gt_u32 vcc, 56, v1
    v_mov_b32 v2, 0
    s_nop 0
    v_cndmask_b32 v2, v2, 1.0, vcc
    s_load_dwordx2 s[4:5], s[0:1], 0
    s_load_dwordx2 s[8:9], s[0:1], 48
    s_load_dwordx2 s[10:11], s[0:1], 96
    s_load_dwordx2 s[12:13], s[0:1], 112
    s_load_dwordx2 s[56:57], s[0:1], 104
    s_waitcnt lgkmcnt(0)
    s_mov_b32 s16, s4
    s_mov_b32 s17, s5
    s_mov_b32 s18, 0x1c0000
    s_mov_b32 s19, 0x00020000
    s_mov_b32 s20, s12
    s_mov_b32 s21, s13
    s_mov_b32 s22, 0x2a00
    s_mov_b32 s23, 0x00020000
    s_add_u32 s24, s12, 0x1a00000
    s_addc_u32 s25, s13, 0
    s_mov_b32 s26, 0xe00000
    s_mov_b32 s27, 0x00020000
    s_mov_b32 s28, s8
    s_mov_b32 s29, s9
    s_mov_b32 s30, 0x380
    s_mov_b32 s31, 0x00020000
    s_mov_b32 s32, s10
    s_mov_b32 s33, s11
    s_mov_b32 s34, 0x1c0000
    s_mov_b32 s35, 0x00020000
    s_add_u32 s36, s12, 0x3800000
    s_addc_u32 s37, s13, 0
    s_mov_b32 s38, 0x1c0000
    s_mov_b32 s39, 0x00020000
    s_add_u32 s40, s12, 0x3a00000
    s_addc_u32 s41, s13, 0
    s_mov_b32 s42, 0x1c0000
    s_mov_b32 s43, 0x00020000
    s_add_u32 s44, s12, 0x3c00000
    s_addc_u32 s45, s13, 0
    s_mov_b32 s46, 0x2000
    s_mov_b32 s47, 0x00020000
    s_mov_b32 s60, s56
    s_mov_b32 s61, s57
    s_mov_b32 s62, 0x100
    s_mov_b32 s63, 0x00020000
    v_lshlrev_b32 v3, 4, v1
    v_lshlrev_b32 v8, 5, v1
    s_lshr_b32 s6, s3, 1
    s_mul_i32 s15, s6, 1792
    s_mul_i32 s6, s3, 896
    s_and_b32 s7, s3, 1
    s_mul_i32 s7, s7, 0x02020000
    s_add_u32 s52, s7, 0x01000c0c
    s_add_u32 s14, s15, 0
    buffer_load_dwordx4 v[16:19], v8, s[24:27], s14 offen
    buffer_load_dwordx4 v[20:23], v8, s[24:27], s14 offen offset:16
    s_add_u32 s14, s15, 1835008
    buffer_load_dwordx4 v[24:27], v8, s[24:27], s14 offen
    buffer_load_dwordx4 v[28:31], v8, s[24:27], s14 offen offset:16
    s_add_u32 s14, s15, 3670016
    buffer_load_dwordx4 v[32:35], v8, s[24:27], s14 offen
    buffer_load_dwordx4 v[36:39], v8, s[24:27], s14 offen offset:16
    s_add_u32 s14, s15, 5505024
    buffer_load_dwordx4 v[40:43], v8, s[24:27], s14 offen
    buffer_load_dwordx4 v[44:47], v8, s[24:27], s14 offen offset:16
    s_add_u32 s14, s15, 7340032
    buffer_load_dwordx4 v[64:67], v8, s[24:27], s14 offen
    buffer_load_dwordx4 v[68:71], v8, s[24:27], s14 offen offset:16
    s_add_u32 s14, s15, 9175040
    buffer_load_dwordx4 v[72:75], v8, s[24:27], s14 offen
    buffer_load_dwordx4 v[76:79], v8, s[24:27], s14 offen offset:16
    s_add_u32 s14, s15, 11010048
    buffer_load_dwordx4 v[80:83], v8, s[24:27], s14 offen
    buffer_load_dwordx4 v[84:87], v8, s[24:27], s14 offen offset:16
    s_add_u32 s14, s15, 12845056
    buffer_load_dwordx4 v[88:91], v8, s[24:27], s14 offen
    buffer_load_dwordx4 v[92:95], v8, s[24:27], s14 offen offset:16
    buffer_load_dwordx4 v[4:7], v3, s[16:19], s6 offen
    buffer_load_dwordx4 v[12:15], v3, s[28:31], 0 offen
    s_mov_b32 s14, 3584
    buffer_load_dwordx4 v[96:99], v8, s[20:23], s14 offen
    buffer_load_dwordx4 v[100:103], v8, s[20:23], s14 offen offset:16
    s_mov_b32 s14, 5376
    buffer_load_dwordx4 v[104:107], v8, s[20:23], s14 offen
    buffer_load_dwordx4 v[108:111], v8, s[20:23], s14 offen offset:16
    s_mov_b32 s14, 7168
    buffer_load_dwordx4 v[112:115], v8, s[20:23], s14 offen
    buffer_load_dwordx4 v[116:119], v8, s[20:23], s14 offen offset:16
    s_mov_b32 s14, 8960
    buffer_load_dwordx4 v[120:123], v8, s[20:23], s14 offen
    buffer_load_dwordx4 v[124:127], v8, s[20:23], s14 offen offset:16
    s_waitcnt vmcnt(24)
    v_perm_b32 v48, v16, v16, s52
    v_perm_b32 v49, v17, v17, s52
    v_perm_b32 v50, v18, v18, s52
    v_perm_b32 v51, v19, v19, s52
    v_perm_b32 v52, v20, v20, s52
    v_perm_b32 v53, v21, v21, s52
    v_perm_b32 v54, v22, v22, s52
    v_perm_b32 v55, v23, v23, s52
    s_waitcnt vmcnt(22)
    v_perm_b32 v24, v24, v24, s52
    v_add_f32 v48, v48, v24
    v_perm_b32 v25, v25, v25, s52
    v_add_f32 v49, v49, v25
    v_perm_b32 v26, v26, v26, s52
    v_add_f32 v50, v50, v26
    v_perm_b32 v27, v27, v27, s52
    v_add_f32 v51, v51, v27
    v_perm_b32 v28, v28, v28, s52
    v_add_f32 v52, v52, v28
    v_perm_b32 v29, v29, v29, s52
    v_add_f32 v53, v53, v29
    v_perm_b32 v30, v30, v30, s52
    v_add_f32 v54, v54, v30
    v_perm_b32 v31, v31, v31, s52
    v_add_f32 v55, v55, v31
    s_waitcnt vmcnt(20)
    v_perm_b32 v32, v32, v32, s52
    v_add_f32 v48, v48, v32
    v_perm_b32 v33, v33, v33, s52
    v_add_f32 v49, v49, v33
    v_perm_b32 v34, v34, v34, s52
    v_add_f32 v50, v50, v34
    v_perm_b32 v35, v35, v35, s52
    v_add_f32 v51, v51, v35
    v_perm_b32 v36, v36, v36, s52
    v_add_f32 v52, v52, v36
    v_perm_b32 v37, v37, v37, s52
    v_add_f32 v53, v53, v37
    v_perm_b32 v38, v38, v38, s52
    v_add_f32 v54, v54, v38
    v_perm_b32 v39, v39, v39, s52
    v_add_f32 v55, v55, v39
    s_waitcnt vmcnt(18)
    v_perm_b32 v40, v40, v40, s52
    v_add_f32 v48, v48, v40
    v_perm_b32 v41, v41, v41, s52
    v_add_f32 v49, v49, v41
    v_perm_b32 v42, v42, v42, s52
    v_add_f32 v50, v50, v42
    v_perm_b32 v43, v43, v43, s52
    v_add_f32 v51, v51, v43
    v_perm_b32 v44, v44, v44, s52
    v_add_f32 v52, v52, v44
    v_perm_b32 v45, v45, v45, s52
    v_add_f32 v53, v53, v45
    v_perm_b32 v46, v46, v46, s52
    v_add_f32 v54, v54, v46
    v_perm_b32 v47, v47, v47, s52
    v_add_f32 v55, v55, v47
    s_waitcnt vmcnt(16)
    v_perm_b32 v64, v64, v64, s52
    v_add_f32 v48, v48, v64
    v_perm_b32 v65, v65, v65, s52
    v_add_f32 v49, v49, v65
    v_perm_b32 v66, v66, v66, s52
    v_add_f32 v50, v50, v66
    v_perm_b32 v67, v67, v67, s52
    v_add_f32 v51, v51, v67
    v_perm_b32 v68, v68, v68, s52
    v_add_f32 v52, v52, v68
    v_perm_b32 v69, v69, v69, s52
    v_add_f32 v53, v53, v69
    v_perm_b32 v70, v70, v70, s52
    v_add_f32 v54, v54, v70
    v_perm_b32 v71, v71, v71, s52
    v_add_f32 v55, v55, v71
    s_waitcnt vmcnt(14)
    v_perm_b32 v72, v72, v72, s52
    v_add_f32 v48, v48, v72
    v_perm_b32 v73, v73, v73, s52
    v_add_f32 v49, v49, v73
    v_perm_b32 v74, v74, v74, s52
    v_add_f32 v50, v50, v74
    v_perm_b32 v75, v75, v75, s52
    v_add_f32 v51, v51, v75
    v_perm_b32 v76, v76, v76, s52
    v_add_f32 v52, v52, v76
    v_perm_b32 v77, v77, v77, s52
    v_add_f32 v53, v53, v77
    v_perm_b32 v78, v78, v78, s52
    v_add_f32 v54, v54, v78
    v_perm_b32 v79, v79, v79, s52
    v_add_f32 v55, v55, v79
    s_waitcnt vmcnt(12)
    v_perm_b32 v80, v80, v80, s52
    v_add_f32 v48, v48, v80
    v_perm_b32 v81, v81, v81, s52
    v_add_f32 v49, v49, v81
    v_perm_b32 v82, v82, v82, s52
    v_add_f32 v50, v50, v82
    v_perm_b32 v83, v83, v83, s52
    v_add_f32 v51, v51, v83
    v_perm_b32 v84, v84, v84, s52
    v_add_f32 v52, v52, v84
    v_perm_b32 v85, v85, v85, s52
    v_add_f32 v53, v53, v85
    v_perm_b32 v86, v86, v86, s52
    v_add_f32 v54, v54, v86
    v_perm_b32 v87, v87, v87, s52
    v_add_f32 v55, v55, v87
    s_waitcnt vmcnt(10)
    v_perm_b32 v88, v88, v88, s52
    v_add_f32 v48, v48, v88
    v_perm_b32 v89, v89, v89, s52
    v_add_f32 v49, v49, v89
    v_perm_b32 v90, v90, v90, s52
    v_add_f32 v50, v50, v90
    v_perm_b32 v91, v91, v91, s52
    v_add_f32 v51, v51, v91
    v_perm_b32 v92, v92, v92, s52
    v_add_f32 v52, v52, v92
    v_perm_b32 v93, v93, v93, s52
    v_add_f32 v53, v53, v93
    v_perm_b32 v94, v94, v94, s52
    v_add_f32 v54, v54, v94
    v_perm_b32 v95, v95, v95, s52
    v_add_f32 v55, v55, v95
    s_waitcnt vmcnt(0)
    v_lshlrev_b32 v40, 16, v12
    v_and_b32 v41, 0xffff0000, v12
    v_lshlrev_b32 v42, 16, v13
    v_and_b32 v43, 0xffff0000, v13
    v_lshlrev_b32 v44, 16, v14
    v_and_b32 v45, 0xffff0000, v14
    v_lshlrev_b32 v46, 16, v15
    v_and_b32 v47, 0xffff0000, v15
    v_add_f32 v112, 1.0, v112
    v_cvt_pk_bf16_f32 v112, 0, v112
    v_add_f32 v113, 1.0, v113
    v_cvt_pk_bf16_f32 v113, 0, v113
    v_add_f32 v114, 1.0, v114
    v_cvt_pk_bf16_f32 v114, 0, v114
    v_add_f32 v115, 1.0, v115
    v_cvt_pk_bf16_f32 v115, 0, v115
    v_add_f32 v116, 1.0, v116
    v_cvt_pk_bf16_f32 v116, 0, v116
    v_add_f32 v117, 1.0, v117
    v_cvt_pk_bf16_f32 v117, 0, v117
    v_add_f32 v118, 1.0, v118
    v_cvt_pk_bf16_f32 v118, 0, v118
    v_add_f32 v119, 1.0, v119
    v_cvt_pk_bf16_f32 v119, 0, v119
    v_cmp_gt_u32 s[48:49], 56, v1
    v_cmp_eq_u32 s[50:51], 0, v1
    v_lshlrev_b32 v16, 16, v4
    v_and_b32 v17, 0xffff0000, v4
    v_lshlrev_b32 v18, 16, v5
    v_and_b32 v19, 0xffff0000, v5
    v_lshlrev_b32 v20, 16, v6
    v_and_b32 v21, 0xffff0000, v6
    v_lshlrev_b32 v22, 16, v7
    v_and_b32 v23, 0xffff0000, v7
    v_cvt_pk_bf16_f32 v48, 0, v48
    v_mul_f32 v48, v48, v96
    v_cvt_pk_bf16_f32 v48, 0, v48
    v_add_f32 v16, v16, v48
    v_cvt_pk_bf16_f32 v16, 0, v16
    v_cvt_pk_bf16_f32 v49, 0, v49
    v_mul_f32 v49, v49, v97
    v_cvt_pk_bf16_f32 v49, 0, v49
    v_add_f32 v17, v17, v49
    v_cvt_pk_bf16_f32 v17, 0, v17
    v_cvt_pk_bf16_f32 v50, 0, v50
    v_mul_f32 v50, v50, v98
    v_cvt_pk_bf16_f32 v50, 0, v50
    v_add_f32 v18, v18, v50
    v_cvt_pk_bf16_f32 v18, 0, v18
    v_cvt_pk_bf16_f32 v51, 0, v51
    v_mul_f32 v51, v51, v99
    v_cvt_pk_bf16_f32 v51, 0, v51
    v_add_f32 v19, v19, v51
    v_cvt_pk_bf16_f32 v19, 0, v19
    v_cvt_pk_bf16_f32 v52, 0, v52
    v_mul_f32 v52, v52, v100
    v_cvt_pk_bf16_f32 v52, 0, v52
    v_add_f32 v20, v20, v52
    v_cvt_pk_bf16_f32 v20, 0, v20
    v_cvt_pk_bf16_f32 v53, 0, v53
    v_mul_f32 v53, v53, v101
    v_cvt_pk_bf16_f32 v53, 0, v53
    v_add_f32 v21, v21, v53
    v_cvt_pk_bf16_f32 v21, 0, v21
    v_cvt_pk_bf16_f32 v54, 0, v54
    v_mul_f32 v54, v54, v102
    v_cvt_pk_bf16_f32 v54, 0, v54
    v_add_f32 v22, v22, v54
    v_cvt_pk_bf16_f32 v22, 0, v22
    v_cvt_pk_bf16_f32 v55, 0, v55
    v_mul_f32 v55, v55, v103
    v_cvt_pk_bf16_f32 v55, 0, v55
    v_add_f32 v23, v23, v55
    v_cvt_pk_bf16_f32 v23, 0, v23
    v_add_f32 v32, v16, v17
    v_add_f32 v32, v32, v18
    v_add_f32 v32, v32, v19
    v_add_f32 v32, v32, v20
    v_add_f32 v32, v32, v21
    v_add_f32 v32, v32, v22
    v_add_f32 v32, v32, v23
    v_mul_f32 v32, v32, v2
    s_nop 1
    v_add_f32_dpp v32, v32, v32 quad_perm:[1,0,3,2] row_mask:0xf bank_mask:0xf
    s_nop 1
    v_add_f32_dpp v32, v32, v32 quad_perm:[2,3,0,1] row_mask:0xf bank_mask:0xf
    s_nop 1
    v_add_f32_dpp v32, v32, v32 row_half_mirror row_mask:0xf bank_mask:0xf
    s_nop 1
    v_add_f32_dpp v32, v32, v32 row_mirror row_mask:0xf bank_mask:0xf
    v_mov_b32 v33, v32
    s_nop 1
    v_permlane16_swap_b32 v32, v33
    s_nop 1
    v_add_f32 v32, v32, v33
    v_mov_b32 v33, v32
    s_nop 1
    v_permlane32_swap_b32 v32, v33
    s_nop 1
    v_add_f32 v32, v32, v33
    v_mul_f32 v32, 0x3b124925, v32
    v_sub_f32 v24, v16, v32
    v_sub_f32 v25, v17, v32
    v_sub_f32 v26, v18, v32
    v_sub_f32 v27, v19, v32
    v_sub_f32 v28, v20, v32
    v_sub_f32 v29, v21, v32
    v_sub_f32 v30, v22, v32
    v_sub_f32 v31, v23, v32
    v_mul_f32 v34, v24, v24
    v_fmac_f32 v34, v25, v25
    v_fmac_f32 v34, v26, v26
    v_fmac_f32 v34, v27, v27
    v_fmac_f32 v34, v28, v28
    v_fmac_f32 v34, v29, v29
    v_fmac_f32 v34, v30, v30
    v_fmac_f32 v34, v31, v31
    v_mul_f32 v34, v34, v2
    s_nop 1
    v_add_f32_dpp v34, v34, v34 quad_perm:[1,0,3,2] row_mask:0xf bank_mask:0xf
    s_nop 1
    v_add_f32_dpp v34, v34, v34 quad_perm:[2,3,0,1] row_mask:0xf bank_mask:0xf
    s_nop 1
    v_add_f32_dpp v34, v34, v34 row_half_mirror row_mask:0xf bank_mask:0xf
    s_nop 1
    v_add_f32_dpp v34, v34, v34 row_mirror row_mask:0xf bank_mask:0xf
    v_mov_b32 v33, v34
    s_nop 1
    v_permlane16_swap_b32 v34, v33
    s_nop 1
    v_add_f32 v34, v34, v33
    v_mov_b32 v33, v34
    s_nop 1
    v_permlane32_swap_b32 v34, v33
    s_nop 1
    v_add_f32 v34, v34, v33
    v_mul_f32 v34, 0x3b124925, v34
    v_cvt_pk_bf16_f32 v32, 0, v32
    v_cvt_pk_bf16_f32 v34, 0, v34
    v_add_f32 v34, 0x3727c5ac, v34
    v_cvt_pk_bf16_f32 v34, 0, v34
    v_sqrt_f32 v34, v34
    s_nop 0
    v_cvt_pk_bf16_f32 v34, 0, v34
    v_rcp_f32 v35, v34
    s_nop 0
    v_sub_f32 v24, v16, v32
    v_cvt_pk_bf16_f32 v24, 0, v24
    v_mul_f32 v33, v24, v35
    v_fma_f32 v24, -v33, v34, v24
    v_fma_f32 v24, v24, v35, v33
    v_cvt_pk_bf16_f32 v24, 0, v24
    v_sub_f32 v25, v17, v32
    v_cvt_pk_bf16_f32 v25, 0, v25
    v_mul_f32 v33, v25, v35
    v_fma_f32 v25, -v33, v34, v25
    v_fma_f32 v25, v25, v35, v33
    v_cvt_pk_bf16_f32 v25, 0, v25
    v_sub_f32 v26, v18, v32
    v_cvt_pk_bf16_f32 v26, 0, v26
    v_mul_f32 v33, v26, v35
    v_fma_f32 v26, -v33, v34, v26
    v_fma_f32 v26, v26, v35, v33
    v_cvt_pk_bf16_f32 v26, 0, v26
    v_sub_f32 v27, v19, v32
    v_cvt_pk_bf16_f32 v27, 0, v27
    v_mul_f32 v33, v27, v35
    v_fma_f32 v27, -v33, v34, v27
    v_fma_f32 v27, v27, v35, v33
    v_cvt_pk_bf16_f32 v27, 0, v27
    v_sub_f32 v28, v20, v32
    v_cvt_pk_bf16_f32 v28, 0, v28
    v_mul_f32 v33, v28, v35
    v_fma_f32 v28, -v33, v34, v28
    v_fma_f32 v28, v28, v35, v33
    v_cvt_pk_bf16_f32 v28, 0, v28
    v_sub_f32 v29, v21, v32
    v_cvt_pk_bf16_f32 v29, 0, v29
    v_mul_f32 v33, v29, v35
    v_fma_f32 v29, -v33, v34, v29
    v_fma_f32 v29, v29, v35, v33
    v_cvt_pk_bf16_f32 v29, 0, v29
    v_sub_f32 v30, v22, v32
    v_cvt_pk_bf16_f32 v30, 0, v30
    v_mul_f32 v33, v30, v35
    v_fma_f32 v30, -v33, v34, v30
    v_fma_f32 v30, v30, v35, v33
    v_cvt_pk_bf16_f32 v30, 0, v30
    v_sub_f32 v31, v23, v32
    v_cvt_pk_bf16_f32 v31, 0, v31
    v_mul_f32 v33, v31, v35
    v_fma_f32 v31, -v33, v34, v31
    v_fma_f32 v31, v31, v35, v33
    v_cvt_pk_bf16_f32 v31, 0, v31
    v_mov_b32 v36, 0
    v_mul_f32 v24, v24, v112
    v_cvt_pk_bf16_f32 v24, 0, v24
    v_add_f32 v24, v24, v104
    v_cvt_pk_bf16_f32 v24, 0, v24
    v_fmac_f32 v36, v24, v40
    v_mul_f32 v48, v24, v120
    v_cvt_pk_bf16_f32 v48, 0, v48
    v_add_f32 v48, v48, v16
    v_mul_f32 v25, v25, v113
    v_cvt_pk_bf16_f32 v25, 0, v25
    v_add_f32 v25, v25, v105
    v_cvt_pk_bf16_f32 v25, 0, v25
    v_fmac_f32 v36, v25, v41
    v_mul_f32 v49, v25, v121
    v_cvt_pk_bf16_f32 v49, 0, v49
    v_add_f32 v49, v49, v17
    v_mul_f32 v26, v26, v114
    v_cvt_pk_bf16_f32 v26, 0, v26
    v_add_f32 v26, v26, v106
    v_cvt_pk_bf16_f32 v26, 0, v26
    v_fmac_f32 v36, v26, v42
    v_mul_f32 v50, v26, v122
    v_cvt_pk_bf16_f32 v50, 0, v50
    v_add_f32 v50, v50, v18
    v_mul_f32 v27, v27, v115
    v_cvt_pk_bf16_f32 v27, 0, v27
    v_add_f32 v27, v27, v107
    v_cvt_pk_bf16_f32 v27, 0, v27
    v_fmac_f32 v36, v27, v43
    v_mul_f32 v51, v27, v123
    v_cvt_pk_bf16_f32 v51, 0, v51
    v_add_f32 v51, v51, v19
    v_mul_f32 v28, v28, v116
    v_cvt_pk_bf16_f32 v28, 0, v28
    v_add_f32 v28, v28, v108
    v_cvt_pk_bf16_f32 v28, 0, v28
    v_fmac_f32 v36, v28, v44
    v_mul_f32 v52, v28, v124
    v_cvt_pk_bf16_f32 v52, 0, v52
    v_add_f32 v52, v52, v20
    v_mul_f32 v29, v29, v117
    v_cvt_pk_bf16_f32 v29, 0, v29
    v_add_f32 v29, v29, v109
    v_cvt_pk_bf16_f32 v29, 0, v29
    v_fmac_f32 v36, v29, v45
    v_mul_f32 v53, v29, v125
    v_cvt_pk_bf16_f32 v53, 0, v53
    v_add_f32 v53, v53, v21
    v_mul_f32 v30, v30, v118
    v_cvt_pk_bf16_f32 v30, 0, v30
    v_add_f32 v30, v30, v110
    v_cvt_pk_bf16_f32 v30, 0, v30
    v_fmac_f32 v36, v30, v46
    v_mul_f32 v54, v30, v126
    v_cvt_pk_bf16_f32 v54, 0, v54
    v_add_f32 v54, v54, v22
    v_mul_f32 v31, v31, v119
    v_cvt_pk_bf16_f32 v31, 0, v31
    v_add_f32 v31, v31, v111
    v_cvt_pk_bf16_f32 v31, 0, v31
    v_fmac_f32 v36, v31, v47
    v_mul_f32 v55, v31, v127
    v_cvt_pk_bf16_f32 v55, 0, v55
    v_add_f32 v55, v55, v23
    v_mul_f32 v36, v36, v2
    v_cvt_pk_bf16_f32 v64, v48, v49
    v_cvt_pk_bf16_f32 v65, v50, v51
    v_cvt_pk_bf16_f32 v66, v52, v53
    v_cvt_pk_bf16_f32 v67, v54, v55
    v_cvt_pk_bf16_f32 v68, v16, v17
    v_cvt_pk_bf16_f32 v69, v18, v19
    v_cvt_pk_bf16_f32 v70, v20, v21
    v_cvt_pk_bf16_f32 v71, v22, v23
    v_cvt_pk_bf16_f32 v72, v24, v25
    v_cvt_pk_bf16_f32 v73, v26, v27
    v_cvt_pk_bf16_f32 v74, v28, v29
    v_cvt_pk_bf16_f32 v75, v30, v31
    s_mov_b64 exec, s[48:49]
    buffer_store_dwordx4 v[64:67], v3, s[32:35], s6 offen
    buffer_store_dwordx4 v[68:71], v3, s[36:39], s6 offen
    buffer_store_dwordx4 v[72:75], v3, s[40:43], s6 offen
    s_mov_b64 exec, -1
    s_nop 1
    v_add_f32_dpp v36, v36, v36 quad_perm:[1,0,3,2] row_mask:0xf bank_mask:0xf
    s_nop 1
    v_add_f32_dpp v36, v36, v36 quad_perm:[2,3,0,1] row_mask:0xf bank_mask:0xf
    s_nop 1
    v_add_f32_dpp v36, v36, v36 row_half_mirror row_mask:0xf bank_mask:0xf
    s_nop 1
    v_add_f32_dpp v36, v36, v36 row_mirror row_mask:0xf bank_mask:0xf
    v_mov_b32 v37, v36
    s_nop 1
    v_permlane16_swap_b32 v36, v37
    s_nop 1
    v_add_f32 v36, v36, v37
    v_mov_b32 v37, v36
    s_nop 1
    v_permlane32_swap_b32 v36, v37
    s_nop 1
    v_add_f32 v36, v36, v37
    v_cvt_pk_bf16_f32 v36, 0, v36
    v_ashrrev_i32 v37, 31, v36
    v_or_b32 v37, 0x80000000, v37
    v_xor_b32 v36, v36, v37
    v_and_b32 v36, 0xffff0000, v36
    s_sub_u32 s7, 2047, s3
    v_or_b32 v36, s7, v36
    s_and_b32 s7, s3, 3
    s_lshl_b32 s14, s7, 2
    v_mov_b32 v4, s14
    ds_write_b32 v4, v36
    s_waitcnt lgkmcnt(0)
    s_barrier
    s_cmp_lg_u32 s7, 0
    s_cbranch_scc1 K5_END
    ds_read_b128 v[4:7], v4
    s_waitcnt lgkmcnt(0)
    v_max3_u32 v4, v4, v5, v6
    v_max_u32 v4, v4, v7
    v_or_b32 v4, 0x8000, v4
    s_mov_b64 exec, s[50:51]
    s_lshl_b32 s7, s2, 2
    buffer_store_dword v4, v1, s[44:47], s7 offen
K5_END:
    s_endpgm
    .globl k6_kernel
    .p2align 8
    .type k6_kernel,@function
k6_kernel:
    s_cmp_ge_u32 s2, 56
    s_cbranch_scc1 K6_END
    s_load_dwordx4 s[4:7], s[0:1], 56
    s_load_dwordx2 s[8:9], s[0:1], 72
    s_load_dwordx4 s[48:51], s[0:1], 96
    s_load_dwordx2 s[12:13], s[0:1], 112
    s_waitcnt lgkmcnt(0)
    s_mov_b32 s16, s4
    s_mov_b32 s17, s5
    s_mov_b32 s18, 0x188000
    s_mov_b32 s19, 0x00020000
    s_mov_b32 s20, s6
    s_mov_b32 s21, s7
    s_mov_b32 s22, 0x188000
    s_mov_b32 s23, 0x00020000
    s_mov_b32 s24, s8
    s_mov_b32 s25, s9
    s_mov_b32 s26, 0x188000
    s_mov_b32 s27, 0x00020000
    s_add_u32 s28, s12, 0x3c00000
    s_addc_u32 s29, s13, 0
    s_mov_b32 s30, 0x2000
    s_mov_b32 s31, 0x00020000
    s_add_u32 s32, s12, 0x3a00000
    s_addc_u32 s33, s13, 0
    s_mov_b32 s34, 0x1c0000
    s_mov_b32 s35, 0x00020000
    s_add_u32 s36, s12, 0x3c10000
    s_addc_u32 s37, s13, 0
    s_mov_b32 s38, 0x18800
    s_mov_b32 s39, 0x00020000
    s_mov_b32 s40, s50
    s_mov_b32 s41, s51
    s_mov_b32 s42, 0x100
    s_mov_b32 s43, 0x00020000
    s_mov_b32 s44, s48
    s_mov_b32 s45, s49
    s_mov_b32 s46, 0x1c0000
    s_mov_b32 s47, 0x00020000
    s_add_u32 s52, s12, 0x3800000
    s_addc_u32 s53, s13, 0
    s_mov_b32 s54, 0x1c0000
    s_mov_b32 s55, 0x00020000
    s_mov_b32 s56, s12
    s_mov_b32 s57, s13
    s_mov_b32 s58, 0x2a00
    s_mov_b32 s59, 0x00020000
    v_and_b32 v2, 15, v0
    v_lshrrev_b32 v3, 4, v0
    v_mul_u32_u24 v12, 100352, v3
    v_lshl_add_u32 v12, v2, 2, v12
    s_lshl_b32 s3, s2, 6
    v_lshlrev_b32 v5, 2, v0
    v_lshlrev_b32 v14, 3, v0
    s_mul_i32 s15, s2, 28672
    buffer_load_dwordx2 v[6:7], v14, s[28:31], 0 offen
    s_add_u32 s14, s3, 0
    buffer_load_dword v24, v12, s[16:19], s14 offen
    buffer_load_dword v52, v12, s[20:23], s14 offen
    s_add_u32 s14, s3, 3584
    buffer_load_dword v25, v12, s[16:19], s14 offen
    buffer_load_dword v53, v12, s[20:23], s14 offen
    s_add_u32 s14, s3, 7168
    buffer_load_dword v26, v12, s[16:19], s14 offen
    buffer_load_dword v54, v12, s[20:23], s14 offen
    s_add_u32 s14, s3, 10752
    buffer_load_dword v27, v12, s[16:19], s14 offen
    buffer_load_dword v55, v12, s[20:23], s14 offen
    s_add_u32 s14, s3, 14336
    buffer_load_dword v28, v12, s[16:19], s14 offen
    buffer_load_dword v56, v12, s[20:23], s14 offen
    s_add_u32 s14, s3, 17920
    buffer_load_dword v29, v12, s[16:19], s14 offen
    buffer_load_dword v57, v12, s[20:23], s14 offen
    s_add_u32 s14, s3, 21504
    buffer_load_dword v30, v12, s[16:19], s14 offen
    buffer_load_dword v58, v12, s[20:23], s14 offen
    s_add_u32 s14, s3, 25088
    buffer_load_dword v31, v12, s[16:19], s14 offen
    buffer_load_dword v59, v12, s[20:23], s14 offen
    s_add_u32 s14, s3, 28672
    buffer_load_dword v32, v12, s[16:19], s14 offen
    buffer_load_dword v60, v12, s[20:23], s14 offen
    s_add_u32 s14, s3, 32256
    buffer_load_dword v33, v12, s[16:19], s14 offen
    buffer_load_dword v61, v12, s[20:23], s14 offen
    s_add_u32 s14, s3, 35840
    buffer_load_dword v34, v12, s[16:19], s14 offen
    buffer_load_dword v62, v12, s[20:23], s14 offen
    s_add_u32 s14, s3, 39424
    buffer_load_dword v35, v12, s[16:19], s14 offen
    buffer_load_dword v63, v12, s[20:23], s14 offen
    s_add_u32 s14, s3, 43008
    buffer_load_dword v36, v12, s[16:19], s14 offen
    buffer_load_dword v64, v12, s[20:23], s14 offen
    s_add_u32 s14, s3, 46592
    buffer_load_dword v37, v12, s[16:19], s14 offen
    buffer_load_dword v65, v12, s[20:23], s14 offen
    s_add_u32 s14, s3, 50176
    buffer_load_dword v38, v12, s[16:19], s14 offen
    buffer_load_dword v66, v12, s[20:23], s14 offen
    s_add_u32 s14, s3, 53760
    buffer_load_dword v39, v12, s[16:19], s14 offen
    buffer_load_dword v67, v12, s[20:23], s14 offen
    s_add_u32 s14, s3, 57344
    buffer_load_dword v40, v12, s[16:19], s14 offen
    buffer_load_dword v68, v12, s[20:23], s14 offen
    s_add_u32 s14, s3, 60928
    buffer_load_dword v41, v12, s[16:19], s14 offen
    buffer_load_dword v69, v12, s[20:23], s14 offen
    s_add_u32 s14, s3, 64512
    buffer_load_dword v42, v12, s[16:19], s14 offen
    buffer_load_dword v70, v12, s[20:23], s14 offen
    s_add_u32 s14, s3, 68096
    buffer_load_dword v43, v12, s[16:19], s14 offen
    buffer_load_dword v71, v12, s[20:23], s14 offen
    s_add_u32 s14, s3, 71680
    buffer_load_dword v44, v12, s[16:19], s14 offen
    buffer_load_dword v72, v12, s[20:23], s14 offen
    s_add_u32 s14, s3, 75264
    buffer_load_dword v45, v12, s[16:19], s14 offen
    buffer_load_dword v73, v12, s[20:23], s14 offen
    s_add_u32 s14, s3, 78848
    buffer_load_dword v46, v12, s[16:19], s14 offen
    buffer_load_dword v74, v12, s[20:23], s14 offen
    s_add_u32 s14, s3, 82432
    buffer_load_dword v47, v12, s[16:19], s14 offen
    buffer_load_dword v75, v12, s[20:23], s14 offen
    s_add_u32 s14, s3, 86016
    buffer_load_dword v48, v12, s[16:19], s14 offen
    buffer_load_dword v76, v12, s[20:23], s14 offen
    s_add_u32 s14, s3, 89600
    buffer_load_dword v49, v12, s[16:19], s14 offen
    buffer_load_dword v77, v12, s[20:23], s14 offen
    s_add_u32 s14, s3, 93184
    buffer_load_dword v50, v12, s[16:19], s14 offen
    buffer_load_dword v78, v12, s[20:23], s14 offen
    s_add_u32 s14, s3, 96768
    buffer_load_dword v51, v12, s[16:19], s14 offen
    buffer_load_dword v79, v12, s[20:23], s14 offen
    s_mov_b32 s14, 8960
    buffer_load_dwordx2 v[16:17], v14, s[56:59], s14 offen
    s_waitcnt vmcnt(57)
    v_max_u32 v4, v6, v7
    s_nop 1
    v_max_u32_dpp v4, v4, v4 quad_perm:[1,0,3,2] row_mask:0xf bank_mask:0xf
    s_nop 1
    v_max_u32_dpp v4, v4, v4 quad_perm:[2,3,0,1] row_mask:0xf bank_mask:0xf
    s_nop 1
    v_max_u32_dpp v4, v4, v4 row_half_mirror row_mask:0xf bank_mask:0xf
    s_nop 1
    v_max_u32_dpp v4, v4, v4 row_mirror row_mask:0xf bank_mask:0xf
    v_mov_b32 v6, v4
    s_nop 1
    v_permlane16_swap_b32 v4, v6
    s_nop 1
    v_max_u32 v4, v4, v6
    v_mov_b32 v6, v4
    s_nop 1
    v_permlane32_swap_b32 v4, v6
    s_nop 1
    v_max_u32 v4, v4, v6
    v_lshrrev_b32 v6, 6, v0
    v_lshlrev_b32 v6, 2, v6
    ds_write_b32 v6, v4
    s_waitcnt lgkmcnt(0)
    s_barrier
    v_mov_b32 v6, 0
    ds_read_b128 v[112:115], v6
    s_waitcnt lgkmcnt(0)
    v_max3_u32 v4, v112, v113, v114
    v_max_u32 v4, v4, v115
    s_nop 0
    v_readfirstlane_b32 s60, v4
    s_nop 3
    s_and_b32 s61, s60, 0x7ff
    s_sub_u32 s61, 2047, s61
    s_mul_i32 s62, s61, 896
    buffer_load_dword v6, v5, s[32:35], s62 offen sc1
    buffer_load_dword v13, v5, s[52:55], s62 offen sc1
    s_waitcnt vmcnt(30)
    s_add_u32 s14, s15, 0
    buffer_load_dword v80, v5, s[24:27], s14 offen
    s_add_u32 s14, s15, 896
    buffer_load_dword v81, v5, s[24:27], s14 offen
    s_add_u32 s14, s15, 1792
    buffer_load_dword v82, v5, s[24:27], s14 offen
    s_add_u32 s14, s15, 2688
    buffer_load_dword v83, v5, s[24:27], s14 offen
    s_add_u32 s14, s15, 3584
    buffer_load_dword v84, v5, s[24:27], s14 offen
    s_add_u32 s14, s15, 4480
    buffer_load_dword v85, v5, s[24:27], s14 offen
    s_add_u32 s14, s15, 5376
    buffer_load_dword v86, v5, s[24:27], s14 offen
    s_add_u32 s14, s15, 6272
    buffer_load_dword v87, v5, s[24:27], s14 offen
    s_add_u32 s14, s15, 7168
    buffer_load_dword v88, v5, s[24:27], s14 offen
    s_add_u32 s14, s15, 8064
    buffer_load_dword v89, v5, s[24:27], s14 offen
    s_add_u32 s14, s15, 8960
    buffer_load_dword v90, v5, s[24:27], s14 offen
    s_add_u32 s14, s15, 9856
    buffer_load_dword v91, v5, s[24:27], s14 offen
    s_add_u32 s14, s15, 10752
    buffer_load_dword v92, v5, s[24:27], s14 offen
    s_add_u32 s14, s15, 11648
    buffer_load_dword v93, v5, s[24:27], s14 offen
    s_add_u32 s14, s15, 12544
    buffer_load_dword v94, v5, s[24:27], s14 offen
    s_add_u32 s14, s15, 13440
    buffer_load_dword v95, v5, s[24:27], s14 offen
    s_add_u32 s14, s15, 14336
    buffer_load_dword v96, v5, s[24:27], s14 offen
    s_add_u32 s14, s15, 15232
    buffer_load_dword v97, v5, s[24:27], s14 offen
    s_add_u32 s14, s15, 16128
    buffer_load_dword v98, v5, s[24:27], s14 offen
    s_add_u32 s14, s15, 17024
    buffer_load_dword v99, v5, s[24:27], s14 offen
    s_add_u32 s14, s15, 17920
    buffer_load_dword v100, v5, s[24:27], s14 offen
    s_add_u32 s14, s15, 18816
    buffer_load_dword v101, v5, s[24:27], s14 offen
    s_add_u32 s14, s15, 19712
    buffer_load_dword v102, v5, s[24:27], s14 offen
    s_add_u32 s14, s15, 20608
    buffer_load_dword v103, v5, s[24:27], s14 offen
    s_add_u32 s14, s15, 21504
    buffer_load_dword v104, v5, s[24:27], s14 offen
    s_add_u32 s14, s15, 22400
    buffer_load_dword v105, v5, s[24:27], s14 offen
    s_add_u32 s14, s15, 23296
    buffer_load_dword v106, v5, s[24:27], s14 offen
    s_add_u32 s14, s15, 24192
    buffer_load_dword v107, v5, s[24:27], s14 offen
    s_add_u32 s14, s15, 25088
    buffer_load_dword v108, v5, s[24:27], s14 offen
    s_add_u32 s14, s15, 25984
    buffer_load_dword v109, v5, s[24:27], s14 offen
    s_add_u32 s14, s15, 26880
    buffer_load_dword v110, v5, s[24:27], s14 offen
    s_add_u32 s14, s15, 27776
    buffer_load_dword v111, v5, s[24:27], s14 offen
    s_waitcnt vmcnt(33)
    v_lshlrev_b32 v8, 16, v6
    v_and_b32 v9, 0xffff0000, v6
    ds_write_b64 v14, v[8:9] offset:64
    s_waitcnt lgkmcnt(0)
    s_barrier
    v_mul_u32_u24 v7, 112, v3
    v_mov_b32 v20, 0
    v_mov_b32 v21, 0
    v_mov_b32 v22, 0
    v_mov_b32 v23, 0
    ds_read_b128 v[112:115], v7 offset:64
    ds_read_b128 v[116:119], v7 offset:80
    ds_read_b128 v[120:123], v7 offset:96
    ds_read_b128 v[124:127], v7 offset:112
    s_waitcnt lgkmcnt(0)
    v_lshlrev_b32 v10, 16, v24
    v_and_b32 v11, 0xffff0000, v24
    v_fmac_f32 v20, v10, v112
    v_fmac_f32 v21, v11, v112
    v_lshlrev_b32 v10, 16, v52
    v_and_b32 v11, 0xffff0000, v52
    v_fmac_f32 v22, v10, v112
    v_fmac_f32 v23, v11, v112
    v_lshlrev_b32 v10, 16, v25
    v_and_b32 v11, 0xffff0000, v25
    v_fmac_f32 v20, v10, v113
    v_fmac_f32 v21, v11, v113
    v_lshlrev_b32 v10, 16, v53
    v_and_b32 v11, 0xffff0000, v53
    v_fmac_f32 v22, v10, v113
    v_fmac_f32 v23, v11, v113
    v_lshlrev_b32 v10, 16, v26
    v_and_b32 v11, 0xffff0000, v26
    v_fmac_f32 v20, v10, v114
    v_fmac_f32 v21, v11, v114
    v_lshlrev_b32 v10, 16, v54
    v_and_b32 v11, 0xffff0000, v54
    v_fmac_f32 v22, v10, v114
    v_fmac_f32 v23, v11, v114
    v_lshlrev_b32 v10, 16, v27
    v_and_b32 v11, 0xffff0000, v27
    v_fmac_f32 v20, v10, v115
    v_fmac_f32 v21, v11, v115
    v_lshlrev_b32 v10, 16, v55
    v_and_b32 v11, 0xffff0000, v55
    v_fmac_f32 v22, v10, v115
    v_fmac_f32 v23, v11, v115
    v_lshlrev_b32 v10, 16, v28
    v_and_b32 v11, 0xffff0000, v28
    v_fmac_f32 v20, v10, v116
    v_fmac_f32 v21, v11, v116
    v_lshlrev_b32 v10, 16, v56
    v_and_b32 v11, 0xffff0000, v56
    v_fmac_f32 v22, v10, v116
    v_fmac_f32 v23, v11, v116
    v_lshlrev_b32 v10, 16, v29
    v_and_b32 v11, 0xffff0000, v29
    v_fmac_f32 v20, v10, v117
    v_fmac_f32 v21, v11, v117
    v_lshlrev_b32 v10, 16, v57
    v_and_b32 v11, 0xffff0000, v57
    v_fmac_f32 v22, v10, v117
    v_fmac_f32 v23, v11, v117
    v_lshlrev_b32 v10, 16, v30
    v_and_b32 v11, 0xffff0000, v30
    v_fmac_f32 v20, v10, v118
    v_fmac_f32 v21, v11, v118
    v_lshlrev_b32 v10, 16, v58
    v_and_b32 v11, 0xffff0000, v58
    v_fmac_f32 v22, v10, v118
    v_fmac_f32 v23, v11, v118
    v_lshlrev_b32 v10, 16, v31
    v_and_b32 v11, 0xffff0000, v31
    v_fmac_f32 v20, v10, v119
    v_fmac_f32 v21, v11, v119
    v_lshlrev_b32 v10, 16, v59
    v_and_b32 v11, 0xffff0000, v59
    v_fmac_f32 v22, v10, v119
    v_fmac_f32 v23, v11, v119
    v_lshlrev_b32 v10, 16, v32
    v_and_b32 v11, 0xffff0000, v32
    v_fmac_f32 v20, v10, v120
    v_fmac_f32 v21, v11, v120
    v_lshlrev_b32 v10, 16, v60
    v_and_b32 v11, 0xffff0000, v60
    v_fmac_f32 v22, v10, v120
    v_fmac_f32 v23, v11, v120
    v_lshlrev_b32 v10, 16, v33
    v_and_b32 v11, 0xffff0000, v33
    v_fmac_f32 v20, v10, v121
    v_fmac_f32 v21, v11, v121
    v_lshlrev_b32 v10, 16, v61
    v_and_b32 v11, 0xffff0000, v61
    v_fmac_f32 v22, v10, v121
    v_fmac_f32 v23, v11, v121
    v_lshlrev_b32 v10, 16, v34
    v_and_b32 v11, 0xffff0000, v34
    v_fmac_f32 v20, v10, v122
    v_fmac_f32 v21, v11, v122
    v_lshlrev_b32 v10, 16, v62
    v_and_b32 v11, 0xffff0000, v62
    v_fmac_f32 v22, v10, v122
    v_fmac_f32 v23, v11, v122
    v_lshlrev_b32 v10, 16, v35
    v_and_b32 v11, 0xffff0000, v35
    v_fmac_f32 v20, v10, v123
    v_fmac_f32 v21, v11, v123
    v_lshlrev_b32 v10, 16, v63
    v_and_b32 v11, 0xffff0000, v63
    v_fmac_f32 v22, v10, v123
    v_fmac_f32 v23, v11, v123
    v_lshlrev_b32 v10, 16, v36
    v_and_b32 v11, 0xffff0000, v36
    v_fmac_f32 v20, v10, v124
    v_fmac_f32 v21, v11, v124
    v_lshlrev_b32 v10, 16, v64
    v_and_b32 v11, 0xffff0000, v64
    v_fmac_f32 v22, v10, v124
    v_fmac_f32 v23, v11, v124
    v_lshlrev_b32 v10, 16, v37
    v_and_b32 v11, 0xffff0000, v37
    v_fmac_f32 v20, v10, v125
    v_fmac_f32 v21, v11, v125
    v_lshlrev_b32 v10, 16, v65
    v_and_b32 v11, 0xffff0000, v65
    v_fmac_f32 v22, v10, v125
    v_fmac_f32 v23, v11, v125
    v_lshlrev_b32 v10, 16, v38
    v_and_b32 v11, 0xffff0000, v38
    v_fmac_f32 v20, v10, v126
    v_fmac_f32 v21, v11, v126
    v_lshlrev_b32 v10, 16, v66
    v_and_b32 v11, 0xffff0000, v66
    v_fmac_f32 v22, v10, v126
    v_fmac_f32 v23, v11, v126
    v_lshlrev_b32 v10, 16, v39
    v_and_b32 v11, 0xffff0000, v39
    v_fmac_f32 v20, v10, v127
    v_fmac_f32 v21, v11, v127
    v_lshlrev_b32 v10, 16, v67
    v_and_b32 v11, 0xffff0000, v67
    v_fmac_f32 v22, v10, v127
    v_fmac_f32 v23, v11, v127
    ds_read_b128 v[112:115], v7 offset:128
    ds_read_b128 v[116:119], v7 offset:144
    ds_read_b128 v[120:123], v7 offset:160
    s_waitcnt lgkmcnt(0)
    v_lshlrev_b32 v10, 16, v40
    v_and_b32 v11, 0xffff0000, v40
    v_fmac_f32 v20, v10, v112
    v_fmac_f32 v21, v11, v112
    v_lshlrev_b32 v10, 16, v68
    v_and_b32 v11, 0xffff0000, v68
    v_fmac_f32 v22, v10, v112
    v_fmac_f32 v23, v11, v112
    v_lshlrev_b32 v10, 16, v41
    v_and_b32 v11, 0xffff0000, v41
    v_fmac_f32 v20, v10, v113
    v_fmac_f32 v21, v11, v113
    v_lshlrev_b32 v10, 16, v69
    v_and_b32 v11, 0xffff0000, v69
    v_fmac_f32 v22, v10, v113
    v_fmac_f32 v23, v11, v113
    v_lshlrev_b32 v10, 16, v42
    v_and_b32 v11, 0xffff0000, v42
    v_fmac_f32 v20, v10, v114
    v_fmac_f32 v21, v11, v114
    v_lshlrev_b32 v10, 16, v70
    v_and_b32 v11, 0xffff0000, v70
    v_fmac_f32 v22, v10, v114
    v_fmac_f32 v23, v11, v114
    v_lshlrev_b32 v10, 16, v43
    v_and_b32 v11, 0xffff0000, v43
    v_fmac_f32 v20, v10, v115
    v_fmac_f32 v21, v11, v115
    v_lshlrev_b32 v10, 16, v71
    v_and_b32 v11, 0xffff0000, v71
    v_fmac_f32 v22, v10, v115
    v_fmac_f32 v23, v11, v115
    v_lshlrev_b32 v10, 16, v44
    v_and_b32 v11, 0xffff0000, v44
    v_fmac_f32 v20, v10, v116
    v_fmac_f32 v21, v11, v116
    v_lshlrev_b32 v10, 16, v72
    v_and_b32 v11, 0xffff0000, v72
    v_fmac_f32 v22, v10, v116
    v_fmac_f32 v23, v11, v116
    v_lshlrev_b32 v10, 16, v45
    v_and_b32 v11, 0xffff0000, v45
    v_fmac_f32 v20, v10, v117
    v_fmac_f32 v21, v11, v117
    v_lshlrev_b32 v10, 16, v73
    v_and_b32 v11, 0xffff0000, v73
    v_fmac_f32 v22, v10, v117
    v_fmac_f32 v23, v11, v117
    v_lshlrev_b32 v10, 16, v46
    v_and_b32 v11, 0xffff0000, v46
    v_fmac_f32 v20, v10, v118
    v_fmac_f32 v21, v11, v118
    v_lshlrev_b32 v10, 16, v74
    v_and_b32 v11, 0xffff0000, v74
    v_fmac_f32 v22, v10, v118
    v_fmac_f32 v23, v11, v118
    v_lshlrev_b32 v10, 16, v47
    v_and_b32 v11, 0xffff0000, v47
    v_fmac_f32 v20, v10, v119
    v_fmac_f32 v21, v11, v119
    v_lshlrev_b32 v10, 16, v75
    v_and_b32 v11, 0xffff0000, v75
    v_fmac_f32 v22, v10, v119
    v_fmac_f32 v23, v11, v119
    v_lshlrev_b32 v10, 16, v48
    v_and_b32 v11, 0xffff0000, v48
    v_fmac_f32 v20, v10, v120
    v_fmac_f32 v21, v11, v120
    v_lshlrev_b32 v10, 16, v76
    v_and_b32 v11, 0xffff0000, v76
    v_fmac_f32 v22, v10, v120
    v_fmac_f32 v23, v11, v120
    v_lshlrev_b32 v10, 16, v49
    v_and_b32 v11, 0xffff0000, v49
    v_fmac_f32 v20, v10, v121
    v_fmac_f32 v21, v11, v121
    v_lshlrev_b32 v10, 16, v77
    v_and_b32 v11, 0xffff0000, v77
    v_fmac_f32 v22, v10, v121
    v_fmac_f32 v23, v11, v121
    v_lshlrev_b32 v10, 16, v50
    v_and_b32 v11, 0xffff0000, v50
    v_fmac_f32 v20, v10, v122
    v_fmac_f32 v21, v11, v122
    v_lshlrev_b32 v10, 16, v78
    v_and_b32 v11, 0xffff0000, v78
    v_fmac_f32 v22, v10, v122
    v_fmac_f32 v23, v11, v122
    v_lshlrev_b32 v10, 16, v51
    v_and_b32 v11, 0xffff0000, v51
    v_fmac_f32 v20, v10, v123
    v_fmac_f32 v21, v11, v123
    v_lshlrev_b32 v10, 16, v79
    v_and_b32 v11, 0xffff0000, v79
    v_fmac_f32 v22, v10, v123
    v_fmac_f32 v23, v11, v123
    v_lshlrev_b32 v7, 4, v0
    ds_write_b128 v7, v[20:23] offset:4096
    s_waitcnt lgkmcnt(0)
    s_barrier
    v_lshlrev_b32 v7, 4, v2
    ds_read_b128 v[20:23], v7 offset:4096
    ds_read_b128 v[24:27], v7 offset:4352
    ds_read_b128 v[28:31], v7 offset:4608
    ds_read_b128 v[32:35], v7 offset:4864
    ds_read_b128 v[36:39], v7 offset:5120
    ds_read_b128 v[40:43], v7 offset:5376
    ds_read_b128 v[44:47], v7 offset:5632
    ds_read_b128 v[48:51], v7 offset:5888
    ds_read_b128 v[52:55], v7 offset:6144
    ds_read_b128 v[56:59], v7 offset:6400
    ds_read_b128 v[60:63], v7 offset:6656
    ds_read_b128 v[64:67], v7 offset:6912
    ds_read_b128 v[68:71], v7 offset:7168
    ds_read_b128 v[72:75], v7 offset:7424
    ds_read_b128 v[76:79], v7 offset:7680
    ds_read_b128 v[112:115], v7 offset:7936
    s_waitcnt lgkmcnt(0)
    v_add_f32 v20, v20, v24
    v_add_f32 v21, v21, v25
    v_add_f32 v22, v22, v26
    v_add_f32 v23, v23, v27
    v_add_f32 v20, v20, v28
    v_add_f32 v21, v21, v29
    v_add_f32 v22, v22, v30
    v_add_f32 v23, v23, v31
    v_add_f32 v20, v20, v32
    v_add_f32 v21, v21, v33
    v_add_f32 v22, v22, v34
    v_add_f32 v23, v23, v35
    v_add_f32 v20, v20, v36
    v_add_f32 v21, v21, v37
    v_add_f32 v22, v22, v38
    v_add_f32 v23, v23, v39
    v_add_f32 v20, v20, v40
    v_add_f32 v21, v21, v41
    v_add_f32 v22, v22, v42
    v_add_f32 v23, v23, v43
    v_add_f32 v20, v20, v44
    v_add_f32 v21, v21, v45
    v_add_f32 v22, v22, v46
    v_add_f32 v23, v23, v47
    v_add_f32 v20, v20, v48
    v_add_f32 v21, v21, v49
    v_add_f32 v22, v22, v50
    v_add_f32 v23, v23, v51
    v_add_f32 v20, v20, v52
    v_add_f32 v21, v21, v53
    v_add_f32 v22, v22, v54
    v_add_f32 v23, v23, v55
    v_add_f32 v20, v20, v56
    v_add_f32 v21, v21, v57
    v_add_f32 v22, v22, v58
    v_add_f32 v23, v23, v59
    v_add_f32 v20, v20, v60
    v_add_f32 v21, v21, v61
    v_add_f32 v22, v22, v62
    v_add_f32 v23, v23, v63
    v_add_f32 v20, v20, v64
    v_add_f32 v21, v21, v65
    v_add_f32 v22, v22, v66
    v_add_f32 v23, v23, v67
    v_add_f32 v20, v20, v68
    v_add_f32 v21, v21, v69
    v_add_f32 v22, v22, v70
    v_add_f32 v23, v23, v71
    v_add_f32 v20, v20, v72
    v_add_f32 v21, v21, v73
    v_add_f32 v22, v22, v74
    v_add_f32 v23, v23, v75
    v_add_f32 v20, v20, v76
    v_add_f32 v21, v21, v77
    v_add_f32 v22, v22, v78
    v_add_f32 v23, v23, v79
    v_add_f32 v20, v20, v112
    v_add_f32 v21, v21, v113
    v_add_f32 v22, v22, v114
    v_add_f32 v23, v23, v115
    v_cvt_pk_bf16_f32 v20, 0, v20
    v_cvt_pk_bf16_f32 v21, 0, v21
    v_cvt_pk_bf16_f32 v22, 0, v22
    v_cvt_pk_bf16_f32 v23, 0, v23
    v_mul_f32 v10, 0xbfb8aa3b, v20
    v_exp_f32 v10, v10
    s_nop 0
    v_add_f32 v10, 1.0, v10
    v_rcp_f32 v10, v10
    s_nop 0
    v_mul_f32 v20, v20, v10
    v_cvt_pk_bf16_f32 v20, 0, v20
    v_mul_f32 v10, 0xbfb8aa3b, v21
    v_exp_f32 v10, v10
    s_nop 0
    v_add_f32 v10, 1.0, v10
    v_rcp_f32 v10, v10
    s_nop 0
    v_mul_f32 v21, v21, v10
    v_cvt_pk_bf16_f32 v21, 0, v21
    v_mul_f32 v20, v20, v22
    v_mul_f32 v21, v21, v23
    v_cvt_pk_bf16_f32 v20, 0, v20
    v_cvt_pk_bf16_f32 v21, 0, v21
    v_lshlrev_b32 v7, 3, v2
    ds_write_b64 v7, v[20:21] offset:8192
    s_waitcnt lgkmcnt(0)
    s_barrier
    v_mov_b32 v7, 0
    ds_read_b128 v[24:27], v7 offset:8192
    ds_read_b128 v[28:31], v7 offset:8208
    ds_read_b128 v[32:35], v7 offset:8224
    ds_read_b128 v[36:39], v7 offset:8240
    ds_read_b128 v[40:43], v7 offset:8256
    ds_read_b128 v[44:47], v7 offset:8272
    ds_read_b128 v[48:51], v7 offset:8288
    ds_read_b128 v[52:55], v7 offset:8304
    v_mov_b32 v20, 0
    v_mov_b32 v21, 0
    s_waitcnt vmcnt(0) lgkmcnt(0)
    v_lshlrev_b32 v10, 16, v80
    v_and_b32 v11, 0xffff0000, v80
    v_fmac_f32 v20, v10, v24
    v_fmac_f32 v21, v11, v24
    v_lshlrev_b32 v10, 16, v81
    v_and_b32 v11, 0xffff0000, v81
    v_fmac_f32 v20, v10, v25
    v_fmac_f32 v21, v11, v25
    v_lshlrev_b32 v10, 16, v82
    v_and_b32 v11, 0xffff0000, v82
    v_fmac_f32 v20, v10, v26
    v_fmac_f32 v21, v11, v26
    v_lshlrev_b32 v10, 16, v83
    v_and_b32 v11, 0xffff0000, v83
    v_fmac_f32 v20, v10, v27
    v_fmac_f32 v21, v11, v27
    v_lshlrev_b32 v10, 16, v84
    v_and_b32 v11, 0xffff0000, v84
    v_fmac_f32 v20, v10, v28
    v_fmac_f32 v21, v11, v28
    v_lshlrev_b32 v10, 16, v85
    v_and_b32 v11, 0xffff0000, v85
    v_fmac_f32 v20, v10, v29
    v_fmac_f32 v21, v11, v29
    v_lshlrev_b32 v10, 16, v86
    v_and_b32 v11, 0xffff0000, v86
    v_fmac_f32 v20, v10, v30
    v_fmac_f32 v21, v11, v30
    v_lshlrev_b32 v10, 16, v87
    v_and_b32 v11, 0xffff0000, v87
    v_fmac_f32 v20, v10, v31
    v_fmac_f32 v21, v11, v31
    v_lshlrev_b32 v10, 16, v88
    v_and_b32 v11, 0xffff0000, v88
    v_fmac_f32 v20, v10, v32
    v_fmac_f32 v21, v11, v32
    v_lshlrev_b32 v10, 16, v89
    v_and_b32 v11, 0xffff0000, v89
    v_fmac_f32 v20, v10, v33
    v_fmac_f32 v21, v11, v33
    v_lshlrev_b32 v10, 16, v90
    v_and_b32 v11, 0xffff0000, v90
    v_fmac_f32 v20, v10, v34
    v_fmac_f32 v21, v11, v34
    v_lshlrev_b32 v10, 16, v91
    v_and_b32 v11, 0xffff0000, v91
    v_fmac_f32 v20, v10, v35
    v_fmac_f32 v21, v11, v35
    v_lshlrev_b32 v10, 16, v92
    v_and_b32 v11, 0xffff0000, v92
    v_fmac_f32 v20, v10, v36
    v_fmac_f32 v21, v11, v36
    v_lshlrev_b32 v10, 16, v93
    v_and_b32 v11, 0xffff0000, v93
    v_fmac_f32 v20, v10, v37
    v_fmac_f32 v21, v11, v37
    v_lshlrev_b32 v10, 16, v94
    v_and_b32 v11, 0xffff0000, v94
    v_fmac_f32 v20, v10, v38
    v_fmac_f32 v21, v11, v38
    v_lshlrev_b32 v10, 16, v95
    v_and_b32 v11, 0xffff0000, v95
    v_fmac_f32 v20, v10, v39
    v_fmac_f32 v21, v11, v39
    v_lshlrev_b32 v10, 16, v96
    v_and_b32 v11, 0xffff0000, v96
    v_fmac_f32 v20, v10, v40
    v_fmac_f32 v21, v11, v40
    v_lshlrev_b32 v10, 16, v97
    v_and_b32 v11, 0xffff0000, v97
    v_fmac_f32 v20, v10, v41
    v_fmac_f32 v21, v11, v41
    v_lshlrev_b32 v10, 16, v98
    v_and_b32 v11, 0xffff0000, v98
    v_fmac_f32 v20, v10, v42
    v_fmac_f32 v21, v11, v42
    v_lshlrev_b32 v10, 16, v99
    v_and_b32 v11, 0xffff0000, v99
    v_fmac_f32 v20, v10, v43
    v_fmac_f32 v21, v11, v43
    v_lshlrev_b32 v10, 16, v100
    v_and_b32 v11, 0xffff0000, v100
    v_fmac_f32 v20, v10, v44
    v_fmac_f32 v21, v11, v44
    v_lshlrev_b32 v10, 16, v101
    v_and_b32 v11, 0xffff0000, v101
    v_fmac_f32 v20, v10, v45
    v_fmac_f32 v21, v11, v45
    v_lshlrev_b32 v10, 16, v102
    v_and_b32 v11, 0xffff0000, v102
    v_fmac_f32 v20, v10, v46
    v_fmac_f32 v21, v11, v46
    v_lshlrev_b32 v10, 16, v103
    v_and_b32 v11, 0xffff0000, v103
    v_fmac_f32 v20, v10, v47
    v_fmac_f32 v21, v11, v47
    v_lshlrev_b32 v10, 16, v104
    v_and_b32 v11, 0xffff0000, v104
    v_fmac_f32 v20, v10, v48
    v_fmac_f32 v21, v11, v48
    v_lshlrev_b32 v10, 16, v105
    v_and_b32 v11, 0xffff0000, v105
    v_fmac_f32 v20, v10, v49
    v_fmac_f32 v21, v11, v49
    v_lshlrev_b32 v10, 16, v106
    v_and_b32 v11, 0xffff0000, v106
    v_fmac_f32 v20, v10, v50
    v_fmac_f32 v21, v11, v50
    v_lshlrev_b32 v10, 16, v107
    v_and_b32 v11, 0xffff0000, v107
    v_fmac_f32 v20, v10, v51
    v_fmac_f32 v21, v11, v51
    v_lshlrev_b32 v10, 16, v108
    v_and_b32 v11, 0xffff0000, v108
    v_fmac_f32 v20, v10, v52
    v_fmac_f32 v21, v11, v52
    v_lshlrev_b32 v10, 16, v109
    v_and_b32 v11, 0xffff0000, v109
    v_fmac_f32 v20, v10, v53
    v_fmac_f32 v21, v11, v53
    v_lshlrev_b32 v10, 16, v110
    v_and_b32 v11, 0xffff0000, v110
    v_fmac_f32 v20, v10, v54
    v_fmac_f32 v21, v11, v54
    v_lshlrev_b32 v10, 16, v111
    v_and_b32 v11, 0xffff0000, v111
    v_fmac_f32 v20, v10, v55
    v_fmac_f32 v21, v11, v55
    s_mul_i32 s14, s2, 1792
    v_cmp_gt_u32 vcc, 224, v0
    s_and_saveexec_b64 s[64:65], vcc
    s_cbranch_execz K6_S1
    buffer_store_dwordx2 v[20:21], v14, s[36:39], s14 offen sc1
K6_S1:
    s_mov_b64 exec, s[64:65]
    s_waitcnt vmcnt(0)
    s_barrier
    v_cmp_eq_u32 vcc, 0, v0
    s_and_saveexec_b64 s[64:65], vcc
    s_cbranch_execz K6_S2
    v_mov_b32 v10, 1
    buffer_atomic_add v10, v0, s[40:43], 0 offen offset:32 sc0
    s_waitcnt vmcnt(0)
    ds_write_b32 v0, v10
K6_S2:
    s_mov_b64 exec, s[64:65]
    s_waitcnt lgkmcnt(0)
    s_barrier
    ds_read_b32 v10, v7
    s_waitcnt lgkmcnt(0)
    v_readfirstlane_b32 s14, v10
    s_nop 3
    s_cmp_lg_u32 s14, 55
    s_cbranch_scc1 K6_END
    v_cmp_gt_u32 vcc, 224, v0
    s_and_saveexec_b64 s[64:65], vcc
    s_cbranch_execz K6_END
    s_mov_b32 s14, 0
    buffer_load_dwordx2 v[24:25], v14, s[36:39], s14 offen sc1
    s_mov_b32 s14, 1792
    buffer_load_dwordx2 v[26:27], v14, s[36:39], s14 offen sc1
    s_mov_b32 s14, 3584
    buffer_load_dwordx2 v[28:29], v14, s[36:39], s14 offen sc1
    s_mov_b32 s14, 5376
    buffer_load_dwordx2 v[30:31], v14, s[36:39], s14 offen sc1
    s_mov_b32 s14, 7168
    buffer_load_dwordx2 v[32:33], v14, s[36:39], s14 offen sc1
    s_mov_b32 s14, 8960
    buffer_load_dwordx2 v[34:35], v14, s[36:39], s14 offen sc1
    s_mov_b32 s14, 10752
    buffer_load_dwordx2 v[36:37], v14, s[36:39], s14 offen sc1
    s_mov_b32 s14, 12544
    buffer_load_dwordx2 v[38:39], v14, s[36:39], s14 offen sc1
    s_mov_b32 s14, 14336
    buffer_load_dwordx2 v[40:41], v14, s[36:39], s14 offen sc1
    s_mov_b32 s14, 16128
    buffer_load_dwordx2 v[42:43], v14, s[36:39], s14 offen sc1
    s_mov_b32 s14, 17920
    buffer_load_dwordx2 v[44:45], v14, s[36:39], s14 offen sc1
    s_mov_b32 s14, 19712
    buffer_load_dwordx2 v[46:47], v14, s[36:39], s14 offen sc1
    s_mov_b32 s14, 21504
    buffer_load_dwordx2 v[48:49], v14, s[36:39], s14 offen sc1
    s_mov_b32 s14, 23296
    buffer_load_dwordx2 v[50:51], v14, s[36:39], s14 offen sc1
    s_mov_b32 s14, 25088
    buffer_load_dwordx2 v[52:53], v14, s[36:39], s14 offen sc1
    s_mov_b32 s14, 26880
    buffer_load_dwordx2 v[54:55], v14, s[36:39], s14 offen sc1
    s_mov_b32 s14, 28672
    buffer_load_dwordx2 v[56:57], v14, s[36:39], s14 offen sc1
    s_mov_b32 s14, 30464
    buffer_load_dwordx2 v[58:59], v14, s[36:39], s14 offen sc1
    s_mov_b32 s14, 32256
    buffer_load_dwordx2 v[60:61], v14, s[36:39], s14 offen sc1
    s_mov_b32 s14, 34048
    buffer_load_dwordx2 v[62:63], v14, s[36:39], s14 offen sc1
    s_mov_b32 s14, 35840
    buffer_load_dwordx2 v[64:65], v14, s[36:39], s14 offen sc1
    s_mov_b32 s14, 37632
    buffer_load_dwordx2 v[66:67], v14, s[36:39], s14 offen sc1
    s_mov_b32 s14, 39424
    buffer_load_dwordx2 v[68:69], v14, s[36:39], s14 offen sc1
    s_mov_b32 s14, 41216
    buffer_load_dwordx2 v[70:71], v14, s[36:39], s14 offen sc1
    s_mov_b32 s14, 43008
    buffer_load_dwordx2 v[72:73], v14, s[36:39], s14 offen sc1
    s_mov_b32 s14, 44800
    buffer_load_dwordx2 v[74:75], v14, s[36:39], s14 offen sc1
    s_mov_b32 s14, 46592
    buffer_load_dwordx2 v[76:77], v14, s[36:39], s14 offen sc1
    s_mov_b32 s14, 48384
    buffer_load_dwordx2 v[78:79], v14, s[36:39], s14 offen sc1
    s_mov_b32 s14, 50176
    buffer_load_dwordx2 v[80:81], v14, s[36:39], s14 offen sc1
    s_mov_b32 s14, 51968
    buffer_load_dwordx2 v[82:83], v14, s[36:39], s14 offen sc1
    s_mov_b32 s14, 53760
    buffer_load_dwordx2 v[84:85], v14, s[36:39], s14 offen sc1
    s_mov_b32 s14, 55552
    buffer_load_dwordx2 v[86:87], v14, s[36:39], s14 offen sc1
    s_mov_b32 s14, 57344
    buffer_load_dwordx2 v[88:89], v14, s[36:39], s14 offen sc1
    s_mov_b32 s14, 59136
    buffer_load_dwordx2 v[90:91], v14, s[36:39], s14 offen sc1
    s_mov_b32 s14, 60928
    buffer_load_dwordx2 v[92:93], v14, s[36:39], s14 offen sc1
    s_mov_b32 s14, 62720
    buffer_load_dwordx2 v[94:95], v14, s[36:39], s14 offen sc1
    s_mov_b32 s14, 64512
    buffer_load_dwordx2 v[96:97], v14, s[36:39], s14 offen sc1
    s_mov_b32 s14, 66304
    buffer_load_dwordx2 v[98:99], v14, s[36:39], s14 offen sc1
    s_mov_b32 s14, 68096
    buffer_load_dwordx2 v[100:101], v14, s[36:39], s14 offen sc1
    s_mov_b32 s14, 69888
    buffer_load_dwordx2 v[102:103], v14, s[36:39], s14 offen sc1
    s_mov_b32 s14, 71680
    buffer_load_dwordx2 v[104:105], v14, s[36:39], s14 offen sc1
    s_mov_b32 s14, 73472
    buffer_load_dwordx2 v[106:107], v14, s[36:39], s14 offen sc1
    s_mov_b32 s14, 75264
    buffer_load_dwordx2 v[108:109], v14, s[36:39], s14 offen sc1
    s_mov_b32 s14, 77056
    buffer_load_dwordx2 v[110:111], v14, s[36:39], s14 offen sc1
    s_mov_b32 s14, 78848
    buffer_load_dwordx2 v[112:113], v14, s[36:39], s14 offen sc1
    s_mov_b32 s14, 80640
    buffer_load_dwordx2 v[114:115], v14, s[36:39], s14 offen sc1
    s_mov_b32 s14, 82432
    buffer_load_dwordx2 v[116:117], v14, s[36:39], s14 offen sc1
    s_mov_b32 s14, 84224
    buffer_load_dwordx2 v[118:119], v14, s[36:39], s14 offen sc1
    s_mov_b32 s14, 86016
    buffer_load_dwordx2 v[120:121], v14, s[36:39], s14 offen sc1
    s_mov_b32 s14, 87808
    buffer_load_dwordx2 v[122:123], v14, s[36:39], s14 offen sc1
    s_mov_b32 s14, 89600
    buffer_load_dwordx2 v[124:125], v14, s[36:39], s14 offen sc1
    s_mov_b32 s14, 91392
    buffer_load_dwordx2 v[126:127], v14, s[36:39], s14 offen sc1
    s_mov_b32 s14, 93184
    buffer_load_dwordx2 v[2:3], v14, s[36:39], s14 offen sc1
    s_mov_b32 s14, 94976
    buffer_load_dwordx2 v[6:7], v14, s[36:39], s14 offen sc1
    s_mov_b32 s14, 96768
    buffer_load_dwordx2 v[20:21], v14, s[36:39], s14 offen sc1
    s_mov_b32 s14, 98560
    buffer_load_dwordx2 v[22:23], v14, s[36:39], s14 offen sc1
    s_and_b32 s14, s60, 0xffff0000
    v_mov_b32 v18, s14
    v_ashrrev_i32 v19, 31, v18
    v_not_b32 v19, v19
    v_or_b32 v19, 0x80000000, v19
    v_xor_b32 v18, v18, v19
    v_and_b32 v18, 0xffff0000, v18
    v_mul_f32 v10, 0xbfb8aa3b, v18
    v_exp_f32 v10, v10
    s_nop 0
    v_add_f32 v10, 1.0, v10
    v_rcp_f32 v10, v10
    s_nop 0
    v_mov_b32 v18, v10
    v_cvt_pk_bf16_f32 v18, 0, v18
    s_waitcnt vmcnt(0)
    v_add_f32 v24, v24, v26
    v_add_f32 v25, v25, v27
    v_add_f32 v24, v24, v28
    v_add_f32 v25, v25, v29
    v_add_f32 v24, v24, v30
    v_add_f32 v25, v25, v31
    v_add_f32 v24, v24, v32
    v_add_f32 v25, v25, v33
    v_add_f32 v24, v24, v34
    v_add_f32 v25, v25, v35
    v_add_f32 v24, v24, v36
    v_add_f32 v25, v25, v37
    v_add_f32 v24, v24, v38
    v_add_f32 v25, v25, v39
    v_add_f32 v24, v24, v40
    v_add_f32 v25, v25, v41
    v_add_f32 v24, v24, v42
    v_add_f32 v25, v25, v43
    v_add_f32 v24, v24, v44
    v_add_f32 v25, v25, v45
    v_add_f32 v24, v24, v46
    v_add_f32 v25, v25, v47
    v_add_f32 v24, v24, v48
    v_add_f32 v25, v25, v49
    v_add_f32 v24, v24, v50
    v_add_f32 v25, v25, v51
    v_add_f32 v24, v24, v52
    v_add_f32 v25, v25, v53
    v_add_f32 v24, v24, v54
    v_add_f32 v25, v25, v55
    v_add_f32 v24, v24, v56
    v_add_f32 v25, v25, v57
    v_add_f32 v24, v24, v58
    v_add_f32 v25, v25, v59
    v_add_f32 v24, v24, v60
    v_add_f32 v25, v25, v61
    v_add_f32 v24, v24, v62
    v_add_f32 v25, v25, v63
    v_add_f32 v24, v24, v64
    v_add_f32 v25, v25, v65
    v_add_f32 v24, v24, v66
    v_add_f32 v25, v25, v67
    v_add_f32 v24, v24, v68
    v_add_f32 v25, v25, v69
    v_add_f32 v24, v24, v70
    v_add_f32 v25, v25, v71
    v_add_f32 v24, v24, v72
    v_add_f32 v25, v25, v73
    v_add_f32 v24, v24, v74
    v_add_f32 v25, v25, v75
    v_add_f32 v24, v24, v76
    v_add_f32 v25, v25, v77
    v_add_f32 v24, v24, v78
    v_add_f32 v25, v25, v79
    v_add_f32 v24, v24, v80
    v_add_f32 v25, v25, v81
    v_add_f32 v24, v24, v82
    v_add_f32 v25, v25, v83
    v_add_f32 v24, v24, v84
    v_add_f32 v25, v25, v85
    v_add_f32 v24, v24, v86
    v_add_f32 v25, v25, v87
    v_add_f32 v24, v24, v88
    v_add_f32 v25, v25, v89
    v_add_f32 v24, v24, v90
    v_add_f32 v25, v25, v91
    v_add_f32 v24, v24, v92
    v_add_f32 v25, v25, v93
    v_add_f32 v24, v24, v94
    v_add_f32 v25, v25, v95
    v_add_f32 v24, v24, v96
    v_add_f32 v25, v25, v97
    v_add_f32 v24, v24, v98
    v_add_f32 v25, v25, v99
    v_add_f32 v24, v24, v100
    v_add_f32 v25, v25, v101
    v_add_f32 v24, v24, v102
    v_add_f32 v25, v25, v103
    v_add_f32 v24, v24, v104
    v_add_f32 v25, v25, v105
    v_add_f32 v24, v24, v106
    v_add_f32 v25, v25, v107
    v_add_f32 v24, v24, v108
    v_add_f32 v25, v25, v109
    v_add_f32 v24, v24, v110
    v_add_f32 v25, v25, v111
    v_add_f32 v24, v24, v112
    v_add_f32 v25, v25, v113
    v_add_f32 v24, v24, v114
    v_add_f32 v25, v25, v115
    v_add_f32 v24, v24, v116
    v_add_f32 v25, v25, v117
    v_add_f32 v24, v24, v118
    v_add_f32 v25, v25, v119
    v_add_f32 v24, v24, v120
    v_add_f32 v25, v25, v121
    v_add_f32 v24, v24, v122
    v_add_f32 v25, v25, v123
    v_add_f32 v24, v24, v124
    v_add_f32 v25, v25, v125
    v_add_f32 v24, v24, v126
    v_add_f32 v25, v25, v127
    v_add_f32 v24, v24, v2
    v_add_f32 v25, v25, v3
    v_add_f32 v24, v24, v6
    v_add_f32 v25, v25, v7
    v_add_f32 v24, v24, v20
    v_add_f32 v25, v25, v21
    v_add_f32 v24, v24, v22
    v_add_f32 v25, v25, v23
    v_lshlrev_b32 v10, 16, v13
    v_and_b32 v11, 0xffff0000, v13
    v_cvt_pk_bf16_f32 v24, 0, v24
    v_mul_f32 v24, v24, v18
    v_cvt_pk_bf16_f32 v24, 0, v24
    v_add_f32 v24, v24, v8
    v_cvt_pk_bf16_f32 v24, 0, v24
    v_mul_f32 v24, v24, v16
    v_cvt_pk_bf16_f32 v24, 0, v24
    v_add_f32 v24, v24, v10
    v_cvt_pk_bf16_f32 v25, 0, v25
    v_mul_f32 v25, v25, v18
    v_cvt_pk_bf16_f32 v25, 0, v25
    v_add_f32 v25, v25, v9
    v_cvt_pk_bf16_f32 v25, 0, v25
    v_mul_f32 v25, v25, v17
    v_cvt_pk_bf16_f32 v25, 0, v25
    v_add_f32 v25, v25, v11
    v_cvt_pk_bf16_f32 v24, v24, v25
    buffer_store_dword v24, v5, s[44:47], s62 offen
K6_END:
    s_endpgm
.section .rodata,"a"
.p2align 6
.amdhsa_kernel k1_kernel
  .amdhsa_next_free_vgpr 80
  .amdhsa_next_free_sgpr 48
  .amdhsa_accum_offset 80
  .amdhsa_group_segment_fixed_size 0
  .amdhsa_kernarg_size 120
  .amdhsa_user_sgpr_count 2
  .amdhsa_user_sgpr_kernarg_segment_ptr 1
  .amdhsa_system_sgpr_workgroup_id_x 1
.end_amdhsa_kernel
.p2align 6
.amdhsa_kernel k3_kernel
  .amdhsa_next_free_vgpr 512
  .amdhsa_next_free_sgpr 80
  .amdhsa_accum_offset 256
  .amdhsa_group_segment_fixed_size 0
  .amdhsa_kernarg_size 120
  .amdhsa_user_sgpr_count 2
  .amdhsa_user_sgpr_kernarg_segment_ptr 1
  .amdhsa_system_sgpr_workgroup_id_x 1
.end_amdhsa_kernel
.p2align 6
.amdhsa_kernel k5_kernel
  .amdhsa_next_free_vgpr 128
  .amdhsa_next_free_sgpr 72
  .amdhsa_accum_offset 128
  .amdhsa_group_segment_fixed_size 0
  .amdhsa_kernarg_size 120
  .amdhsa_user_sgpr_count 2
  .amdhsa_user_sgpr_kernarg_segment_ptr 1
  .amdhsa_system_sgpr_workgroup_id_x 1
.end_amdhsa_kernel
.p2align 6
.amdhsa_kernel k6_kernel
  .amdhsa_next_free_vgpr 128
  .amdhsa_next_free_sgpr 72
  .amdhsa_accum_offset 128
  .amdhsa_group_segment_fixed_size 0
  .amdhsa_kernarg_size 120
  .amdhsa_user_sgpr_count 2
  .amdhsa_user_sgpr_kernarg_segment_ptr 1
  .amdhsa_system_sgpr_workgroup_id_x 1
.end_amdhsa_kernel
.p2align 6
```
